```python
import torch

def _softmax(x, axis=-1):
    return torch.softmax(x, dim=axis)
def _gelu(x):
    return torch.nn.functional.gelu(x, approximate="tanh")
def _silu(x):
    return torch.nn.functional.silu(x)
def _sigmoid(x):
    return torch.sigmoid(x)
def _layernorm(x, axis=-1, eps=1e-5):
    m = x.mean(dim=axis, keepdim=True)
    v = x.var(dim=axis, keepdim=True, unbiased=False)
    return (x - m) / torch.sqrt(v + eps)
def _scatter_add(tgt, idx, src, axis=0):
    return tgt.clone().index_add_(axis, idx, src)
def _segment_sum(src, seg, n):
    out = torch.zeros((n,) + src.shape[1:], dtype=src.dtype)
    return out.index_add_(0, seg, src)
def _pad(x, pw):
    flat = tuple(v for pair in reversed(pw) for v in pair)
    return torch.nn.functional.pad(x, flat)

kernel_name = 'gated_mix__linear_attn_block__geglu_ffn__prompt'

def setup_inputs():

    _w = (lambda a: (lambda t: t.to(torch.bfloat16) if t.is_floating_point() else t)(torch.as_tensor(a)))
    def _A_setup():
        B, S, D = 1, 2048, 512
        return {
            "x": _w((lambda *s: torch.randn(*s, dtype=torch.bfloat16) * 0.05)(B, S, D)),
            "wqkv": _w((lambda *s: torch.randn(*s, dtype=torch.bfloat16) * 0.8)(D, 3 * D)),
            "wo": _w((lambda *s: torch.randn(*s, dtype=torch.bfloat16) * 0.05)(D, D)),
        }
    _A_in = _A_setup()

    def _B_setup():
        B, S, D, F = 1, 2048, 512, 1792
        return {
            "x": _w((lambda *s: torch.randn(*s, dtype=torch.bfloat16) * 0.05)(B, S, D)),
            "w_gate": _w((lambda *s: torch.randn(*s, dtype=torch.bfloat16) * 0.05)(D, F)),
            "w_up": _w((lambda *s: torch.randn(*s, dtype=torch.bfloat16) * 0.05)(D, F)),
            "w_down": _w((lambda *s: torch.randn(*s, dtype=torch.bfloat16) * 0.05)(F, D)),
        }
    _B_in = _B_setup()

    return {
        "A_x": _A_in["x"],
        "A_wqkv": _A_in["wqkv"],
        "A_wo": _A_in["wo"],
        "B_x": _B_in["x"],
        "B_w_gate": _B_in["w_gate"],
        "B_w_up": _B_in["w_up"],
        "B_w_down": _B_in["w_down"],
        "gate_w": _w((lambda *s: torch.randn(*s, dtype=torch.bfloat16) * 0.05)(512) * 16.0),
    }

def reference(A_x, A_wqkv, A_wo, B_x, B_w_gate, B_w_up, B_w_down, gate_w):
    def _A_ref(x, wqkv, wo):
        B, S, D = x.shape
        H = 32; Dh = D // H
        qkv = (lambda x, *d: x.permute(*d))((x @ wqkv).reshape(B, S, 3, H, Dh), 2, 0, 3, 1, 4)
        q, k, v = qkv[0], qkv[1], qkv[2]
        phi = lambda t: torch.where(t > 0, t + 1, torch.exp(t)) + 1e-6
        pq, pk = phi(q), phi(k)
        kv = torch.einsum("bhsd,bhse->bhde", pk, v)
        z = torch.einsum("bhsd->bhd", pk)
        num = torch.einsum("bhqd,bhde->bhqe", pq, kv)
        den = torch.einsum("bhqd,bhd->bhq", pq, z)[..., None] + 1e-6
        o = num / den
        return (lambda x, *d: x.permute(*d))(o, 0, 2, 1, 3).reshape(B, S, D) @ wo

    def _B_ref(x, w_gate, w_up, w_down):
        return (_gelu(x @ w_gate) * (x @ w_up)) @ w_down

    x = A_x
    g = _sigmoid((x * gate_w).sum(-1, keepdims=True))
    a = _A_ref(x, A_wqkv, A_wo)
    b = _B_ref(x, B_w_gate, B_w_up, B_w_down)
    return g * a + (1 - g) * b
```

```asm
; @launch grid=(256,1,1) block=(256,1,1) lds=163840
.amdgcn_target "amdgcn-amd-amdhsa--gfx950"
.text
.globl gated_mix__linear_attn_block__geglu_ffn__prompt_kernel
.p2align 8
.type gated_mix__linear_attn_block__geglu_ffn__prompt_kernel,@function
gated_mix__linear_attn_block__geglu_ffn__prompt_kernel:
    s_cmp_ge_u32 s2, 0x100
    s_cbranch_scc1 L_end
    s_load_dwordx4 s[44:47], s[0:1], 0
    s_load_dwordx4 s[48:51], s[0:1], 32
    s_getpc_b64 s[82:83]
L_pc:
    s_bitcmp1_b32 s2, 6
    s_cselect_b32 s54, L_pathB-L_pathA, 0
    s_add_u32 s54, s54, L_pathA-L_pc
    s_bfe_u32 s52, s2, 0x30003
    s_lshr_b32 s53, s2, 7
    s_lshl3_add_u32 s52, s53, s52
    s_mul_i32 s52, s52, 1536
    s_add_u32 s54, s54, s52
    v_min_u32 v1, 11, v0
    v_lshl_add_u32 v1, v1, 7, s54
    v_min_u32 v1, L_endB-L_pc-4, v1
    global_load_dword v255, v1, s[82:83]
    v_lshrrev_b32 v2, 6, v0
    s_lshr_b32 s52, s2, 3
    s_and_b32 s53, s2, 1
    s_bfe_u32 s54, s2, 0x20001
    v_lshl_add_u32 v2, s52, 2, v2
    v_and_b32 v1, 63, v0
    s_lshl2_add_u32 s52, s53, s54
    s_lshl_b32 s52, s52, 18
    v_lshlrev_b32 v3, 11, v2
    v_lshl_add_u32 v3, v1, 7, v3
    v_add_u32 v3, s52, v3
    s_lshl_b32 s53, s53, 8
    v_lshl_add_u32 v2, v2, 1, s53
    v_bfe_u32 v4, v1, 1, 1
    v_add_u32 v2, v2, v4
    v_and_b32 v4, 1, v1
    v_lshl_add_u32 v4, s54, 1, v4
    v_lshlrev_b32 v4, 7, v4
    v_lshrrev_b32 v1, 2, v1
    v_lshl_add_u32 v5, v1, 10, v4
    s_movk_i32 s52, 0xc00
    s_movk_i32 s53, 0xe00
    v_mad_u32_u24 v5, v2, s52, v5
    v_mad_u32_u24 v4, v2, s53, v4
    s_mov_b64 exec, 0xffff
    s_waitcnt lgkmcnt(0)
    global_load_dword v254, v3, s[44:45]
    s_mov_b64 exec, 0xff
    global_load_dword v253, v5, s[46:47] offset:1024
    s_mov_b64 exec, 15
    global_load_dword v252, v4, s[48:49]
    global_load_dword v251, v4, s[50:51]
    s_mov_b64 exec, -1
    s_bitcmp1_b32 s2, 6
    s_cselect_b32 s52, 32, 8
    s_cselect_b32 s53, 40, 8
    s_load_dwordx2 s[84:85], s[0:1], s52
    s_load_dwordx2 s[88:89], s[0:1], s53
    s_load_dwordx2 s[8:9], s[0:1], 0
    s_load_dwordx2 s[16:17], s[0:1], 32
    s_load_dwordx2 s[20:21], s[0:1], 40
    s_load_dwordx2 s[12:13], s[0:1], 8
    s_load_dwordx2 s[40:41], s[0:1], 56
    s_load_dwordx2 s[32:33], s[0:1], 80
    s_load_dwordx2 s[24:25], s[0:1], 48
    s_load_dwordx2 s[28:29], s[0:1], 16
    s_load_dwordx2 s[36:37], s[0:1], 64
    s_mov_b32 s10, 2097152
    s_mov_b32 s11, 0x20000
    s_mov_b32 s14, 1572864
    s_mov_b32 s15, 0x20000
    s_mov_b32 s18, 1835008
    s_mov_b32 s19, 0x20000
    s_mov_b32 s22, 1835008
    s_mov_b32 s23, 0x20000
    s_mov_b32 s26, 1835008
    s_mov_b32 s27, 0x20000
    s_mov_b32 s30, 524288
    s_mov_b32 s31, 0x20000
    s_mov_b32 s34, 268435456
    s_mov_b32 s35, 0x20000
    s_mov_b32 s38, 2097152
    s_mov_b32 s39, 0x20000
    s_mov_b32 s42, 1024
    s_mov_b32 s43, 0x20000
    v_lshrrev_b32 v2, 6, v0
    v_and_b32 v192, 63, v0
    s_and_b32 s52, s2, 1
    v_readfirstlane_b32 s44, v2
    s_bfe_u32 s54, s2, 0x30003
    s_lshl3_add_u32 s47, s52, s54
    s_bfe_u32 s53, s2, 0x20001
    s_lshr_b32 s77, s2, 7
    s_lshl1_add_u32 s48, s53, s77
    s_lshl2_add_u32 s92, s52, s53
    s_lshl_b32 s92, s92, 5
    s_lshr_b32 s77, s2, 3
    s_add_u32 s92, s92, s77
    s_lshl2_add_u32 s92, s92, s44
    v_lshrrev_b32 v193, 3, v192
    v_and_b32 v194, 7, v192
    v_lshrrev_b32 v195, 4, v192
    v_lshlrev_b32 v246, 7, v192
    s_lshl2_add_u32 s52, s47, s44
    s_lshl_b32 s52, s52, 15
    v_xor_b32 v2, v194, v195
    v_lshlrev_b32 v2, 4, v2
    v_lshl_add_u32 v2, v193, 10, v2
    v_add_u32 v198, s52, v2
    v_xor_b32 v3, 64, v198
    v_add_u32 v199, 7168, v3
    v_add_u32 v200, 14336, v198
    v_add_u32 v201, 14336, v199
    v_and_b32 v196, 1, v195
    v_lshlrev_b32 v2, 2, v196
    v_xor_b32 v2, v2, v194
    v_lshlrev_b32 v197, 4, v2
    s_lshl_b32 s62, s48, 7
    s_bitcmp1_b32 s2, 6
    s_cselect_b32 s64, 7, 6
    s_cselect_b32 s53, 0, 1024
    s_cselect_b32 s54, 32, 0
    s_cselect_b32 s76, 8, 0
    s_lshl_b32 s86, s64, 18
    s_lshl_b32 s64, s64, 9
    s_mov_b32 s90, s86
    s_mov_b32 s87, 0x20000
    s_mov_b32 s91, 0x20000
    v_lshl_add_u32 v202, s44, 4, v193
    v_add_u32_e64 v203, s62, v197
    v_mad_u32_u24 v2, v202, s64, v203
    v_add_u32 v204, s53, v2
    v_add_u32 v3, s53, v204
    v_xor_b32_e64 v205, s54, v3
    s_lshl3_add_u32 s53, s64, -1024
    v_add_u32 v206, s53, v204
    v_add_u32 v207, s53, v205
    s_lshl_b32 s64, s64, 6
    s_lshl_b32 s59, s44, 12
    s_lshl_b32 s60, s44, 11
    s_add_u32 s76, s76, s48
    s_lshl4_add_u32 s76, s47, s76
    s_lshl2_add_u32 s76, s76, s44
    s_lshl_b32 s76, s76, 1
    v_lshlrev_b32 v208, 4, v192
    s_waitcnt lgkmcnt(0)
    s_mov_b32 s57, 0
    s_add_u32 m0, s59, 0
    s_nop 0
    buffer_load_dwordx4 v198, s[8:11], s57 offen offset:0  lds
    buffer_load_dwordx4 v199, s[8:11], s57 offen offset:1024  lds
    buffer_load_dwordx4 v200, s[8:11], s57 offen offset:2048  lds
    buffer_load_dwordx4 v201, s[8:11], s57 offen offset:3072  lds
    s_mul_i32 s57, s64, 0
    s_add_u32 m0, s60, 16384
    s_nop 0
    buffer_load_dwordx4 v204, s[84:87], s57 offen offset:0  lds
    buffer_load_dwordx4 v206, s[84:87], s57 offen offset:1024  lds
    s_add_u32 m0, s60, 24576
    s_nop 0
    buffer_load_dwordx4 v205, s[88:91], s57 offen offset:0  lds
    buffer_load_dwordx4 v207, s[88:91], s57 offen offset:1024  lds
    s_bitcmp1_b32 s2, 6
    s_cbranch_scc1 L_pathB
L_pathA:
    buffer_load_dword v55, off, s[32:35], 0 offset:0 sc1
    s_and_b32 s52, s2, 7
    s_lshr_b32 s53, s2, 3
    s_and_b32 s54, s53, 7
    s_lshr_b32 s45, s44, 1
    s_and_b32 s46, s44, 1
    s_and_b32 s101, s53, 3
    s_lshl_b32 s61, s44, 10
    v_lshrrev_b32_e64 v209, 5, v192
    v_bfe_u32 v210, v192, 2, 2
    v_and_b32 v211, 3, v192
    v_and_b32 v212, 31, v192
    s_lshr_b32 s50, s52, 1
    s_lshl3_add_u32 s50, s50, s54
    s_and_b32 s51, s52, 1
    s_lshr_b32 s77, s53, 3
    s_lshl2_add_u32 s51, s51, s77
    v_bfe_u32 v2, v192, 1, 3
    v_xor_b32 v2, v2, v209
    v_lshlrev_b32_e64 v2, 4, v2
    v_lshl_add_u32 v2, v212, 7, v2
    s_lshl_b32 s52, s45, 13
    v_add_u32 v226, s52, v2
    v_xor_b32 v227, 32, v226
    v_xor_b32 v228, 64, v226
    v_xor_b32 v229, 0x60, v226
    v_and_b32 v2, 2, v210
    v_xor_b32 v2, v2, v196
    s_lshl_b32 s52, s46, 1
    v_xor_b32 v2, s52, v2
    v_lshlrev_b32_e64 v2, 5, v2
    v_lshl_add_u32 v2, v211, 3, v2
    v_lshl_add_u32 v3, v209, 3, v210
    v_lshl_add_u32 v4, v3, 7, v2
    v_lshl_add_u32 v16, v196, 13, v4
    v_xor_b32_e64 v17, 32, v16
    v_lshl_add_u32 v5, v209, 2, v210
    v_lshl_add_u32 v5, v5, 7, v2
    v_add_u32 v18, s60, v5
    v_xor_b32 v19, 64, v18
    v_mov_b32_e64 v20, v4
    v_mul_u32_u24 v3, 3584, v202
    v_add_u32 v10, v3, v203
    v_xor_b32 v11, 32, v10
    v_add_u32 v12, 27648, v10
    v_add_u32 v13, 27648, v11
    v_add_u32 v14, -1024, v204
    v_add_u32 v15, -1024, v206
    v_lshl_add_u32 v2, v193, 10, v197
    s_lshl_b32 s52, s51, 7
    s_lshl_b32 s53, s44, 16
    s_add_u32 s52, s52, s53
    v_add_u32 v21, s52, v2
    v_add_u32_e64 v22, s53, v21
    v_add_u32 v23, 7168, v21
    v_add_u32 v24, 7168, v22
    s_mul_i32 s52, s50, 294912
    s_add_u32 s52, s52, 1048576
    s_add_u32 s52, s52, s59
    v_add_u32 v2, s52, v208
    s_mul_i32 s73, s45, 147456
    s_sub_u32 s54, 147456, s73
    v_add_u32 v25, s73, v2
    v_add_u32 v26, s54, v2
    v_add_u32 v27, s59, v25
    v_add_u32 v28, s59, v26
    s_lshl_b32 s52, s47, 1
    s_add_u32 s52, s52, s45
    s_mul_i32 s53, s52, 294912
    s_add_u32 s53, s53, 1048576
    v_add_u32_e64 v29, s53, v208
    v_add_u32 v30, 147456, v29
    s_lshl_b32 s53, s52, 9
    s_add_u32 s53, s53, 81920
    v_lshlrev_b32 v2, 3, v212
    v_add_u32 v230, s53, v2
    s_lshl_b32 s52, s52, 2
    s_lshr_b32 s53, s48, 1
    s_add_u32 s52, s52, s53
    s_lshl_b32 s52, s52, 9
    s_and_b32 s53, s48, 1
    s_lshl_b32 s53, s53, 1
    s_add_u32 s53, s53, s46
    s_lshl_b32 s53, s53, 2
    s_add_u32 s52, s52, s53
    s_add_u32 s69, s52, 4096
    s_lshl_b32 s52, s50, 2
    s_add_u32 s52, s52, s44
    s_lshl_b32 s52, s52, 9
    s_add_u32 s52, s52, 4096
    v_lshlrev_b32 v2, 2, v211
    v_add_u32 v31, s52, v2
    s_lshl_b32 s52, s48, 2
    s_lshl_b32 s53, s46, 1
    s_add_u32 s52, s52, s53
    s_lshl_b32 s65, s52, 10
    s_add_u32 s67, s65, 81920
    v_mov_b32 v32, 0xc0135761
    v_mov_b32 v33, 0xbdd2d3e8
    s_add_u32 s68, s65, 114688
    s_add_u32 s52, s52, s45
    s_lshl_b32 s53, s52, 7
    s_add_u32 s53, s53, 73728
    s_lshl_b32 s54, s47, 2
    s_add_u32 s70, s53, s54
    v_and_b32 v2, 15, v192
    v_lshlrev_b32 v2, 2, v2
    v_add_u32 v34, s53, v2
    s_lshl_b32 s53, s52, 14
    s_add_u32 s53, s53, 163840
    v_add_u32 v35, s53, v208
    s_lshl_b32 s71, s47, 6
    s_add_u32 s55, s53, s71
    s_lshr_b32 s58, s52, 1
    s_lshl_b32 s58, s58, 11
    s_add_u32 s58, s58, 688128
    s_lshl_b32 s71, s47, 10
    s_lshl_b32 s53, s52, 11
    s_add_u32 s53, s53, 98304
    v_lshlrev_b32 v2, 2, v192
    v_add_u32 v36, s53, v2
    s_lshl1_add_u32 s56, s47, s45
    s_lshl2_add_u32 s56, s56, s53
    s_lshl_b32 s72, s47, 7
    s_mov_b32 s78, 0xffff0000
    s_mov_b32 s79, 0xffff0000
    s_sub_u32 s80, 0, s45
    s_mov_b32 s81, s80
    v_lshlrev_b32 v2, 4, v209
    v_xor_b32_e64 v3, 1, v196
    v_lshl_add_u32 v2, v3, 5, v2
    s_lshl_b32 s53, s44, 6
    s_add_u32 s53, s53, 162816
    v_add_u32 v37, s53, v2
    v_and_b32_e64 v2, 0x24, v192
    v_bfe_u32 v3, v192, 3, 1
    v_lshl_add_u32 v2, v3, 4, v2
    v_lshl_add_u32 v2, v196, 3, v2
    v_add_u32_e64 v38, s53, v2
    s_add_u32 s53, s61, 155648
    v_add_u32 v39, s53, v208
    s_mov_b32 s75, 0
    s_mul_i32 s52, s51, 2
    s_mul_i32 s53, s50, 1
    s_add_u32 s52, s52, s53
    s_add_u32 s53, s52, 0
    s_and_b32 s53, s53, 7
    s_lshl_b32 s93, s53, 10
    s_add_u32 s53, s52, 1
    s_and_b32 s53, s53, 7
    s_lshl_b32 s94, s53, 10
    s_add_u32 s53, s52, 2
    s_and_b32 s53, s53, 7
    s_lshl_b32 s95, s53, 10
    s_add_u32 s53, s52, 3
    s_and_b32 s53, s53, 7
    s_lshl_b32 s96, s53, 10
    s_add_u32 s53, s52, 4
    s_and_b32 s53, s53, 7
    s_lshl_b32 s97, s53, 10
    s_add_u32 s53, s52, 5
    s_and_b32 s53, s53, 7
    s_lshl_b32 s98, s53, 10
    s_add_u32 s53, s52, 6
    s_and_b32 s53, s53, 7
    s_lshl_b32 s99, s53, 10
    s_add_u32 s53, s52, 7
    s_and_b32 s53, s53, 7
    s_lshl_b32 s100, s53, 10
    s_nop 0
    v_add_u32 v231, 65536, v226
    v_add_u32 v40, 65536, v20
    v_add_u32 v232, 65536, v227
    v_add_u32 v233, 65536, v228
    v_add_u32 v234, 65536, v229
    v_add_u32 v41, 131072, v20
    v_add_u32 v42, 65536, v16
    v_add_u32 v43, 65536, v17
    v_add_u32 v56, 131072, v18
    v_add_u32 v57, 131072, v19
    v_add_u32 v58, 65536, v18
    v_add_u32 v59, 65536, v19
    s_mov_b64 exec, 0
    s_cmp_eq_u32 s44, 0
    s_cbranch_scc1 L_islA1
    s_cmp_eq_u32 s44, 1
    s_cbranch_scc1 L_islA2
    s_cmp_eq_u32 s44, 2
    s_cbranch_scc1 L_islA3
    s_branch L_islA4
L_retA:
    s_mov_b64 exec, -1
    s_lshl_b32 s77, s76, 10
    buffer_load_dwordx4 v[214:217], v208, s[8:11], s77 offen
    buffer_load_dwordx4 v[218:221], v208, s[8:11], s77 offen offset:1024
    buffer_load_dwordx4 v[222:225], v208, s[40:43], 0 offen
    s_mov_b32 s57, 128
    s_add_u32 m0, s59, 32768
    s_nop 0
    buffer_load_dwordx4 v198, s[8:11], s57 offen offset:0  lds
    buffer_load_dwordx4 v199, s[8:11], s57 offen offset:1024  lds
    buffer_load_dwordx4 v200, s[8:11], s57 offen offset:2048  lds
    buffer_load_dwordx4 v201, s[8:11], s57 offen offset:3072  lds
    s_mul_i32 s57, s64, 1
    s_add_u32 m0, s60, 49152
    s_nop 0
    buffer_load_dwordx4 v204, s[84:87], s57 offen offset:0  lds
    buffer_load_dwordx4 v206, s[84:87], s57 offen offset:1024  lds
    s_add_u32 m0, s60, 57344
    s_nop 0
    buffer_load_dwordx4 v205, s[88:91], s57 offen offset:0  lds
    buffer_load_dwordx4 v207, s[88:91], s57 offen offset:1024  lds
    s_waitcnt vmcnt(12)
    s_barrier
    ds_read_b128 a[0:3], v226 offset:0
    ds_read_b64_tr_b16 v[64:65], v20 offset:16384
    ds_read_b64_tr_b16 v[66:67], v20 offset:16896
    ds_read_b128 a[4:7], v226 offset:4096
    ds_read_b64_tr_b16 v[68:69], v20 offset:24576
    ds_read_b64_tr_b16 v[70:71], v20 offset:25088
    ds_read_b128 a[8:11], v227 offset:0
    ds_read_b64_tr_b16 v[72:73], v20 offset:18432
    ds_read_b64_tr_b16 v[74:75], v20 offset:18944
    ds_read_b128 a[12:15], v227 offset:4096
    ds_read_b64_tr_b16 v[76:77], v20 offset:26624
    ds_read_b64_tr_b16 v[78:79], v20 offset:27136
    s_waitcnt lgkmcnt(0)
    v_mfma_f32_32x32x16_bf16 v[96:111], a[0:3], v[64:67], 0
    s_waitcnt vmcnt(11)
    v_add_u32 v55, 0x9e3779b9, v55
    s_nop 0
    v_readfirstlane_b32 s49, v55
    ds_read_b128 a[16:19], v228 offset:0
    ds_read_b64_tr_b16 v[80:81], v20 offset:20480
    v_mfma_f32_32x32x16_bf16 v[112:127], a[4:7], v[64:67], 0
    s_mov_b32 s57, 256
    s_add_u32 m0, s59, 65536
    ds_read_b64_tr_b16 v[82:83], v20 offset:20992
    ds_read_b128 a[20:23], v228 offset:4096
    buffer_load_dwordx4 v198, s[8:11], s57 offen offset:0  lds
    buffer_load_dwordx4 v199, s[8:11], s57 offen offset:1024  lds
    v_mfma_f32_32x32x16_bf16 v[128:143], a[0:3], v[68:71], 0
    ds_read_b64_tr_b16 v[84:85], v20 offset:28672
    ds_read_b64_tr_b16 v[86:87], v20 offset:29184
    buffer_load_dwordx4 v200, s[8:11], s57 offen offset:2048  lds
    v_mfma_f32_32x32x16_bf16 v[144:159], a[4:7], v[68:71], 0
    ds_read_b128 a[24:27], v229 offset:0
    ds_read_b64_tr_b16 v[88:89], v20 offset:22528
    buffer_load_dwordx4 v201, s[8:11], s57 offen offset:3072  lds
    v_mfma_f32_32x32x16_bf16 v[96:111], a[8:11], v[72:75], v[96:111]
    s_mul_i32 s57, s64, 2
    s_add_u32 m0, s60, 81920
    ds_read_b64_tr_b16 v[90:91], v20 offset:23040
    ds_read_b128 a[28:31], v229 offset:4096
    buffer_load_dwordx4 v204, s[84:87], s57 offen offset:0  lds
    v_mfma_f32_32x32x16_bf16 v[112:127], a[12:15], v[72:75], v[112:127]
    ds_read_b64_tr_b16 v[92:93], v20 offset:30720
    ds_read_b64_tr_b16 v[94:95], v20 offset:31232
    buffer_load_dwordx4 v206, s[84:87], s57 offen offset:1024  lds
    v_mfma_f32_32x32x16_bf16 v[128:143], a[8:11], v[76:79], v[128:143]
    s_add_u32 m0, s60, 90112
    s_nop 0
    buffer_load_dwordx4 v205, s[88:91], s57 offen offset:0  lds
    v_mfma_f32_32x32x16_bf16 v[144:159], a[12:15], v[76:79], v[144:159]
    buffer_load_dwordx4 v207, s[88:91], s57 offen offset:1024  lds
    s_waitcnt lgkmcnt(0)
    v_mfma_f32_32x32x16_bf16 v[96:111], a[16:19], v[80:83], v[96:111]
    s_waitcnt vmcnt(8)
    s_barrier
    ds_read_b128 a[32:35], v226 offset:32768
    ds_read_b64_tr_b16 v[64:65], v20 offset:49152
    v_mov_b32 v238, 0x3f803f80
    v_mov_b32 v236, 0
    v_mov_b32_e64 v237, 0
    v_mfma_f32_32x32x16_bf16 v[112:127], a[20:23], v[80:83], v[112:127]
    s_mov_b32 s57, 384
    s_add_u32 m0, s59, 0
    ds_read_b64_tr_b16 v[66:67], v20 offset:49664
    ds_read_b128 a[36:39], v226 offset:36864
    buffer_load_dwordx4 v198, s[8:11], s57 offen offset:0  lds
    v_lshlrev_b32 v2, 16, v222
    v_mfma_f32_32x32x16_bf16 v[128:143], a[16:19], v[84:87], v[128:143]
    ds_read_b64_tr_b16 v[68:69], v20 offset:57344
    ds_read_b64_tr_b16 v[70:71], v20 offset:57856
    buffer_load_dwordx4 v199, s[8:11], s57 offen offset:1024  lds
    v_and_b32 v3, 0xffff0000, v222
    v_lshlrev_b32_e64 v4, 16, v214
    v_mfma_f32_32x32x16_bf16 v[144:159], a[20:23], v[84:87], v[144:159]
    ds_read_b128 a[40:43], v227 offset:32768
    ds_read_b64_tr_b16 v[72:73], v20 offset:51200
    v_and_b32 v5, 0xffff0000, v214
    v_mul_f32 v4, v4, v2
    v_mul_f32 v5, v5, v3
    v_cvt_pk_bf16_f32 v4, v4, v5
    v_lshlrev_b32_e64 v8, 16, v4
    v_mfma_f32_32x32x16_bf16 v[96:111], a[24:27], v[88:91], v[96:111]
    ds_read_b64_tr_b16 v[74:75], v20 offset:51712
    ds_read_b128 a[44:47], v227 offset:36864
    buffer_load_dwordx4 v200, s[8:11], s57 offen offset:2048  lds
    v_and_b32 v9, 0xffff0000, v4
    v_add_f32_e64 v236, v236, v8
    v_mfma_f32_32x32x16_bf16 v[112:127], a[28:31], v[88:91], v[112:127]
    ds_read_b64_tr_b16 v[76:77], v20 offset:59392
    ds_read_b64_tr_b16 v[78:79], v20 offset:59904
    v_add_f32 v236, v236, v9
    v_lshlrev_b32 v6, 16, v218
    v_and_b32 v7, 0xffff0000, v218
    v_mul_f32 v6, v6, v2
    v_mul_f32 v7, v7, v3
    v_mfma_f32_32x32x16_bf16 v[128:143], a[24:27], v[92:95], v[128:143]
    buffer_load_dwordx4 v201, s[8:11], s57 offen offset:3072  lds
    v_cvt_pk_bf16_f32 v6, v6, v7
    v_lshlrev_b32_e64 v8, 16, v6
    v_and_b32 v9, 0xffff0000, v6
    v_add_f32_e64 v237, v237, v8
    v_mfma_f32_32x32x16_bf16 v[144:159], a[28:31], v[92:95], v[144:159]
    s_mul_i32 s57, s64, 3
    v_add_f32 v237, v237, v9
    v_lshlrev_b32_e64 v2, 16, v223
    v_and_b32 v3, 0xffff0000, v223
    v_lshlrev_b32_e64 v4, 16, v215
    v_and_b32 v5, 0xffff0000, v215
    v_mul_f32 v4, v4, v2
    v_mul_f32 v5, v5, v3
    s_waitcnt lgkmcnt(0)
    v_mfma_f32_32x32x16_bf16 v[96:111], a[32:35], v[64:67], v[96:111]
    s_add_u32 m0, s60, 16384
    ds_read_b128 a[48:51], v228 offset:32768
    ds_read_b64_tr_b16 v[80:81], v20 offset:53248
    buffer_load_dwordx4 v204, s[84:87], s57 offen offset:0  lds
    v_cvt_pk_bf16_f32 v4, v4, v5
    v_lshlrev_b32 v8, 16, v4
    v_mfma_f32_32x32x16_bf16 v[112:127], a[36:39], v[64:67], v[112:127]
    ds_read_b64_tr_b16 v[82:83], v20 offset:53760
    ds_read_b128 a[52:55], v228 offset:36864
    v_and_b32 v9, 0xffff0000, v4
    v_add_f32 v236, v236, v8
    v_add_f32 v236, v236, v9
    v_lshlrev_b32_e64 v6, 16, v219
    v_and_b32 v7, 0xffff0000, v219
    v_mfma_f32_32x32x16_bf16 v[128:143], a[32:35], v[68:71], v[128:143]
    ds_read_b64_tr_b16 v[84:85], v20 offset:61440
    ds_read_b64_tr_b16 v[86:87], v20 offset:61952
    buffer_load_dwordx4 v206, s[84:87], s57 offen offset:1024  lds
    v_mul_f32 v6, v6, v2
    v_mul_f32 v7, v7, v3
    v_mfma_f32_32x32x16_bf16 v[144:159], a[36:39], v[68:71], v[144:159]
    ds_read_b128 a[56:59], v229 offset:32768
    ds_read_b64_tr_b16 v[88:89], v20 offset:55296
    v_cvt_pk_bf16_f32 v6, v6, v7
    v_lshlrev_b32_e64 v8, 16, v6
    v_and_b32 v9, 0xffff0000, v6
    v_add_f32 v237, v237, v8
    v_add_f32 v237, v237, v9
    v_mfma_f32_32x32x16_bf16 v[96:111], a[40:43], v[72:75], v[96:111]
    s_add_u32 m0, s60, 24576
    ds_read_b64_tr_b16 v[90:91], v20 offset:55808
    ds_read_b128 a[60:63], v229 offset:36864
    buffer_load_dwordx4 v205, s[88:91], s57 offen offset:0  lds
    v_lshlrev_b32_e64 v2, 16, v224
    v_and_b32 v3, 0xffff0000, v224
    v_mfma_f32_32x32x16_bf16 v[112:127], a[44:47], v[72:75], v[112:127]
    ds_read_b64_tr_b16 v[92:93], v20 offset:63488
    ds_read_b64_tr_b16 v[94:95], v20 offset:64000
    v_lshlrev_b32_e64 v4, 16, v216
    v_and_b32 v5, 0xffff0000, v216
    v_mul_f32 v4, v4, v2
    v_mul_f32 v5, v5, v3
    v_cvt_pk_bf16_f32 v4, v4, v5
    v_mfma_f32_32x32x16_bf16 v[128:143], a[40:43], v[76:79], v[128:143]
    buffer_load_dwordx4 v207, s[88:91], s57 offen offset:1024  lds
    v_lshlrev_b32_e64 v8, 16, v4
    v_and_b32 v9, 0xffff0000, v4
    v_add_f32 v236, v236, v8
    v_add_f32 v236, v236, v9
    v_mfma_f32_32x32x16_bf16 v[144:159], a[44:47], v[76:79], v[144:159]
    v_lshlrev_b32_e64 v6, 16, v220
    v_and_b32 v7, 0xffff0000, v220
    v_mul_f32 v6, v6, v2
    v_mul_f32 v7, v7, v3
    v_cvt_pk_bf16_f32 v6, v6, v7
L_islA1:
    s_cbranch_execz L_islA5
    v_lshlrev_b32 v8, 16, v6
    v_and_b32 v9, 0xffff0000, v6
    s_waitcnt lgkmcnt(0)
    v_mfma_f32_32x32x16_bf16 v[96:111], a[48:51], v[80:83], v[96:111]
    s_waitcnt vmcnt(8)
    s_barrier
    ds_read_b128 a[64:67], v231 offset:0
    ds_read_b64_tr_b16 v[64:65], v40 offset:16384
    v_add_f32 v237, v237, v8
    v_add_f32 v237, v237, v9
    v_lshlrev_b32 v2, 16, v225
    v_mfma_f32_32x32x16_bf16 v[112:127], a[52:55], v[80:83], v[112:127]
    s_mov_b32 s57, 512
    s_add_u32 m0, s59, 32768
    ds_read_b64_tr_b16 v[66:67], v40 offset:16896
    ds_read_b128 a[68:71], v231 offset:4096
    buffer_load_dwordx4 v198, s[8:11], s57 offen offset:0  lds
    v_and_b32 v3, 0xffff0000, v225
    v_mfma_f32_32x32x16_bf16 v[128:143], a[48:51], v[84:87], v[128:143]
    ds_read_b64_tr_b16 v[68:69], v40 offset:24576
    ds_read_b64_tr_b16 v[70:71], v40 offset:25088
    buffer_load_dwordx4 v199, s[8:11], s57 offen offset:1024  lds
    v_lshlrev_b32_e64 v4, 16, v217
    v_and_b32 v5, 0xffff0000, v217
    v_mfma_f32_32x32x16_bf16 v[144:159], a[52:55], v[84:87], v[144:159]
    ds_read_b128 a[72:75], v232 offset:0
    ds_read_b64_tr_b16 v[72:73], v40 offset:18432
    v_mul_f32 v4, v4, v2
    v_mul_f32 v5, v5, v3
    v_cvt_pk_bf16_f32 v4, v4, v5
    v_lshlrev_b32_e64 v8, 16, v4
    v_and_b32 v9, 0xffff0000, v4
    v_mfma_f32_32x32x16_bf16 v[96:111], a[56:59], v[88:91], v[96:111]
    ds_read_b64_tr_b16 v[74:75], v40 offset:18944
    ds_read_b128 a[76:79], v232 offset:4096
    buffer_load_dwordx4 v200, s[8:11], s57 offen offset:2048  lds
    v_add_f32 v236, v236, v8
    v_add_f32 v236, v236, v9
    v_mfma_f32_32x32x16_bf16 v[112:127], a[60:63], v[88:91], v[112:127]
    ds_read_b64_tr_b16 v[76:77], v40 offset:26624
    ds_read_b64_tr_b16 v[78:79], v40 offset:27136
    v_lshlrev_b32_e64 v6, 16, v221
    v_and_b32 v7, 0xffff0000, v221
    v_mul_f32 v6, v6, v2
    v_mul_f32 v7, v7, v3
    v_cvt_pk_bf16_f32 v6, v6, v7
    v_mfma_f32_32x32x16_bf16 v[128:143], a[56:59], v[92:95], v[128:143]
    buffer_load_dwordx4 v201, s[8:11], s57 offen offset:3072  lds
    v_lshlrev_b32_e64 v8, 16, v6
    v_and_b32 v9, 0xffff0000, v6
    v_add_f32 v237, v237, v8
    v_add_f32 v237, v237, v9
    v_mfma_f32_32x32x16_bf16 v[144:159], a[60:63], v[92:95], v[144:159]
    s_mul_i32 s57, s64, 4
    v_permlane32_swap_b32 v236, v237
    v_add_f32 v236, v236, v237
    s_nop 1
    v_add_f32_dpp v236, v236, v236 quad_perm:[1,0,3,2] row_mask:0xf bank_mask:0xf
    s_nop 1
    v_add_f32_dpp v236, v236, v236 quad_perm:[2,3,0,1] row_mask:0xf bank_mask:0xf
    s_nop 1
    v_add_f32_dpp v236, v236, v236 row_half_mirror row_mask:0xf bank_mask:0xf
    s_nop 1
    v_add_f32_dpp v236, v236, v236 row_mirror row_mask:0xf bank_mask:0xf
    v_mov_b32 v237, v236
    s_waitcnt lgkmcnt(0)
    v_mfma_f32_32x32x16_bf16 v[96:111], a[64:67], v[64:67], v[96:111]
    s_add_u32 m0, s60, 49152
    ds_read_b128 a[80:83], v233 offset:0
    ds_read_b64_tr_b16 v[80:81], v40 offset:20480
    buffer_load_dwordx4 v204, s[84:87], s57 offen offset:0  lds
    v_permlane16_swap_b32 v236, v237
    v_add_f32_e64 v236, v236, v237
    v_mfma_f32_32x32x16_bf16 v[112:127], a[68:71], v[64:67], v[112:127]
    ds_read_b64_tr_b16 v[82:83], v40 offset:20992
    ds_read_b128 a[84:87], v233 offset:4096
    v_cvt_pk_bf16_f32 v236, v236, v236
    v_and_b32 v236, 0xffff0000, v236
    v_mul_f32 v236, 0xbfb8aa3b, v236
    v_exp_f32_e64 v236, v236
    v_mfma_f32_32x32x16_bf16 v[128:143], a[64:67], v[68:71], v[128:143]
    ds_read_b64_tr_b16 v[84:85], v40 offset:28672
    ds_read_b64_tr_b16 v[86:87], v40 offset:29184
    buffer_load_dwordx4 v206, s[84:87], s57 offen offset:1024  lds
    v_add_f32_e64 v236, 1.0, v236
    v_mfma_f32_32x32x16_bf16 v[144:159], a[68:71], v[68:71], v[144:159]
    ds_read_b128 a[88:91], v234 offset:0
    ds_read_b64_tr_b16 v[88:89], v40 offset:22528
    v_rcp_f32 v236, v236
    s_nop 0
    v_cvt_pk_bf16_f32 v236, v236, v236
    v_and_b32 v236, 0xffff0000, v236
    v_mov_b32_e64 v237, s49
    v_mfma_f32_32x32x16_bf16 v[96:111], a[72:75], v[72:75], v[96:111]
    s_add_u32 m0, s60, 57344
    ds_read_b64_tr_b16 v[90:91], v40 offset:23040
    ds_read_b128 a[92:95], v234 offset:4096
    buffer_load_dwordx4 v205, s[88:91], s57 offen offset:0  lds
    v_mfma_f32_32x32x16_bf16 v[112:127], a[76:79], v[72:75], v[112:127]
    ds_read_b64_tr_b16 v[92:93], v40 offset:30720
    ds_read_b64_tr_b16 v[94:95], v40 offset:31232
    v_lshlrev_b32 v2, 3, v209
    s_lshl_b32 s77, s76, 3
    s_add_u32 s77, s77, 81920
    s_mov_b32 exec_lo, 1
    s_mov_b32 exec_hi, 1
    buffer_store_dwordx2 v[236:237], v2, s[32:35], s77 offen sc1
    s_mov_b64 exec, -1
    v_mfma_f32_32x32x16_bf16 v[128:143], a[72:75], v[76:79], v[128:143]
    buffer_load_dwordx4 v207, s[88:91], s57 offen offset:1024  lds
    v_mfma_f32_32x32x16_bf16 v[144:159], a[76:79], v[76:79], v[144:159]
    s_and_b32 s52, s101, 3
    s_cmp_lg_u32 s52, 0
    s_cbranch_scc1 L_A_t2_1
    v_lshrrev_b32_e64 v239, 7, v246
    s_and_b32 s52, s92, 127
    s_bfe_u32 s53, s2, 0x10000
    s_lshl_b32 s54, s53, 7
    s_add_u32 s54, s54, s52
    s_lshl_b32 s54, s54, 1
    s_bfe_u32 s77, s2, 0x20001
    v_bfe_u32 v240, v239, 1, 1
    v_add_u32 v240, s54, v240
    v_and_b32_e64 v241, 1, v239
    v_lshl_add_u32 v241, s77, 1, v241
    v_lshlrev_b32_e64 v241, 7, v241
    v_mul_u32_u24 v242, 3072, v240
    v_add_u32 v242, v242, v241
    s_mov_b64 exec, 15
    buffer_load_dword v248, v242, s[12:15], 0 offen
    s_mov_b64 exec, -1
    v_lshrrev_b32 v242, 2, v239
    v_lshl_add_u32 v241, v242, 10, v241
    v_add_u32 v241, 1536, v241
    v_lshlrev_b32 v242, 7, s77
    v_add_u32 v242, 1024, v242
    v_cmp_gt_u32 vcc, 8, v239
    s_nop 1
    v_cndmask_b32 v241, v242, v241, vcc
    v_mul_u32_u24 v240, 3584, v240
    v_add_u32 v241, v241, v240
    s_mov_b64 exec, 0x5ff
    buffer_load_dword v250, v241, s[16:19], 0 offen
    buffer_load_dword v249, v241, s[20:23], 0 offen
    s_mov_b64 exec, -1
    v_lshrrev_b32 v240, 2, v239
    v_and_b32 v241, 3, v239
    v_lshlrev_b32 v241, 7, v241
    v_lshl_add_u32 v241, v240, 10, v241
    s_lshl_b32 s53, s53, 9
    s_lshl_b32 s54, s77, 7
    s_add_u32 s54, s54, s52
    s_lshl_b32 s77, s54, 10
    s_add_u32 s77, s77, s53
    s_mov_b64 exec, 15
    buffer_load_dword v247, v241, s[28:31], s77 offen
    s_lshl_b32 s77, s54, 12
    s_add_u32 s77, s77, s53
    s_mov_b64 exec, 0xffff
    buffer_load_dword v245, v241, s[24:27], s77 offen
    s_mov_b64 exec, -1
L_A_t2_1:
    s_waitcnt lgkmcnt(0)
    v_mfma_f32_32x32x16_bf16 v[96:111], a[80:83], v[80:83], v[96:111]
    s_waitcnt vmcnt(9)
    s_barrier
    ds_read_b128 a[96:99], v226 offset:0
    ds_read_b64_tr_b16 v[64:65], v20 offset:16384
    v_mfma_f32_32x32x16_bf16 v[112:127], a[84:87], v[80:83], v[112:127]
    s_mov_b32 s57, 640
    s_add_u32 m0, s59, 65536
    ds_read_b64_tr_b16 v[66:67], v20 offset:16896
    ds_read_b128 a[100:103], v226 offset:4096
    buffer_load_dwordx4 v198, s[8:11], s57 offen offset:0  lds
    v_mfma_f32_32x32x16_bf16 v[128:143], a[80:83], v[84:87], v[128:143]
    ds_read_b64_tr_b16 v[68:69], v20 offset:24576
    ds_read_b64_tr_b16 v[70:71], v20 offset:25088
    buffer_load_dwordx4 v199, s[8:11], s57 offen offset:1024  lds
    v_mfma_f32_32x32x16_bf16 v[144:159], a[84:87], v[84:87], v[144:159]
    ds_read_b128 a[104:107], v227 offset:0
    ds_read_b64_tr_b16 v[72:73], v20 offset:18432
    v_mfma_f32_32x32x16_bf16 v[96:111], a[88:91], v[88:91], v[96:111]
    ds_read_b64_tr_b16 v[74:75], v20 offset:18944
    ds_read_b128 a[108:111], v227 offset:4096
    buffer_load_dwordx4 v200, s[8:11], s57 offen offset:2048  lds
    v_mfma_f32_32x32x16_bf16 v[112:127], a[92:95], v[88:91], v[112:127]
    ds_read_b64_tr_b16 v[76:77], v20 offset:26624
    ds_read_b64_tr_b16 v[78:79], v20 offset:27136
    v_mfma_f32_32x32x16_bf16 v[128:143], a[88:91], v[92:95], v[128:143]
    buffer_load_dwordx4 v201, s[8:11], s57 offen offset:3072  lds
    v_mfma_f32_32x32x16_bf16 v[144:159], a[92:95], v[92:95], v[144:159]
    s_mul_i32 s57, s64, 5
    s_waitcnt lgkmcnt(0)
    v_mfma_f32_32x32x16_bf16 v[96:111], a[96:99], v[64:67], v[96:111]
    s_add_u32 m0, s60, 81920
    ds_read_b128 a[112:115], v228 offset:0
    ds_read_b64_tr_b16 v[80:81], v20 offset:20480
    buffer_load_dwordx4 v204, s[84:87], s57 offen offset:0  lds
    v_mfma_f32_32x32x16_bf16 v[112:127], a[100:103], v[64:67], v[112:127]
    ds_read_b64_tr_b16 v[82:83], v20 offset:20992
    ds_read_b128 a[116:119], v228 offset:4096
    v_mfma_f32_32x32x16_bf16 v[128:143], a[96:99], v[68:71], v[128:143]
    ds_read_b64_tr_b16 v[84:85], v20 offset:28672
    ds_read_b64_tr_b16 v[86:87], v20 offset:29184
    buffer_load_dwordx4 v206, s[84:87], s57 offen offset:1024  lds
    v_mfma_f32_32x32x16_bf16 v[144:159], a[100:103], v[68:71], v[144:159]
    ds_read_b128 a[120:123], v229 offset:0
    ds_read_b64_tr_b16 v[88:89], v20 offset:22528
    v_mfma_f32_32x32x16_bf16 v[96:111], a[104:107], v[72:75], v[96:111]
    s_add_u32 m0, s60, 90112
    ds_read_b64_tr_b16 v[90:91], v20 offset:23040
    ds_read_b128 a[124:127], v229 offset:4096
    buffer_load_dwordx4 v205, s[88:91], s57 offen offset:0  lds
    v_mfma_f32_32x32x16_bf16 v[112:127], a[108:111], v[72:75], v[112:127]
    ds_read_b64_tr_b16 v[92:93], v20 offset:30720
    ds_read_b64_tr_b16 v[94:95], v20 offset:31232
    v_mfma_f32_32x32x16_bf16 v[128:143], a[104:107], v[76:79], v[128:143]
    buffer_load_dwordx4 v207, s[88:91], s57 offen offset:1024  lds
    v_mfma_f32_32x32x16_bf16 v[144:159], a[108:111], v[76:79], v[144:159]
    s_and_b32 s52, s101, 3
    s_cmp_lg_u32 s52, 1
    s_cbranch_scc1 L_A_t2_2
    v_lshrrev_b32 v239, 7, v246
    s_and_b32 s52, s92, 127
    s_bfe_u32 s53, s2, 0x10000
    s_lshl_b32 s54, s53, 7
    s_add_u32 s54, s54, s52
    s_lshl_b32 s54, s54, 1
    s_bfe_u32 s77, s2, 0x20001
    v_bfe_u32 v240, v239, 1, 1
    v_add_u32 v240, s54, v240
    v_and_b32_e64 v241, 1, v239
    v_lshl_add_u32 v241, s77, 1, v241
    v_lshlrev_b32_e64 v241, 7, v241
    v_mul_u32_u24 v242, 3072, v240
    v_add_u32 v242, v242, v241
    s_mov_b64 exec, 15
    buffer_load_dword v248, v242, s[12:15], 0 offen
    s_mov_b64 exec, -1
    v_lshrrev_b32 v242, 2, v239
    v_lshl_add_u32 v241, v242, 10, v241
    v_add_u32 v241, 1536, v241
    v_lshlrev_b32 v242, 7, s77
    v_add_u32 v242, 1024, v242
    v_cmp_gt_u32 vcc, 8, v239
    s_nop 1
    v_cndmask_b32 v241, v242, v241, vcc
    v_mul_u32_u24 v240, 3584, v240
    v_add_u32 v241, v241, v240
    s_mov_b64 exec, 0x5ff
    buffer_load_dword v250, v241, s[16:19], 0 offen
    buffer_load_dword v249, v241, s[20:23], 0 offen
    s_mov_b64 exec, -1
    v_lshrrev_b32 v240, 2, v239
    v_and_b32 v241, 3, v239
    v_lshlrev_b32 v241, 7, v241
    v_lshl_add_u32 v241, v240, 10, v241
    s_lshl_b32 s53, s53, 9
    s_lshl_b32 s54, s77, 7
    s_add_u32 s54, s54, s52
    s_lshl_b32 s77, s54, 10
    s_add_u32 s77, s77, s53
    s_mov_b64 exec, 15
    buffer_load_dword v247, v241, s[28:31], s77 offen
    s_lshl_b32 s77, s54, 12
    s_add_u32 s77, s77, s53
    s_mov_b64 exec, 0xffff
    buffer_load_dword v245, v241, s[24:27], s77 offen
    s_mov_b64 exec, -1
L_A_t2_2:
    s_waitcnt lgkmcnt(0)
    v_mfma_f32_32x32x16_bf16 v[96:111], a[112:115], v[80:83], v[96:111]
    s_waitcnt vmcnt(8)
    s_barrier
    ds_read_b128 a[128:131], v226 offset:32768
    ds_read_b64_tr_b16 v[64:65], v20 offset:49152
    v_mfma_f32_32x32x16_bf16 v[112:127], a[116:119], v[80:83], v[112:127]
    s_mov_b32 s57, 768
    s_add_u32 m0, s59, 0
    ds_read_b64_tr_b16 v[66:67], v20 offset:49664
    ds_read_b128 a[132:135], v226 offset:36864
    buffer_load_dwordx4 v198, s[8:11], s57 offen offset:0  lds
    v_mfma_f32_32x32x16_bf16 v[128:143], a[112:115], v[84:87], v[128:143]
    ds_read_b64_tr_b16 v[68:69], v20 offset:57344
    ds_read_b64_tr_b16 v[70:71], v20 offset:57856
    buffer_load_dwordx4 v199, s[8:11], s57 offen offset:1024  lds
    v_mfma_f32_32x32x16_bf16 v[144:159], a[116:119], v[84:87], v[144:159]
    ds_read_b128 a[136:139], v227 offset:32768
    ds_read_b64_tr_b16 v[72:73], v20 offset:51200
    v_mfma_f32_32x32x16_bf16 v[96:111], a[120:123], v[88:91], v[96:111]
    ds_read_b64_tr_b16 v[74:75], v20 offset:51712
    ds_read_b128 a[140:143], v227 offset:36864
    buffer_load_dwordx4 v200, s[8:11], s57 offen offset:2048  lds
    v_mfma_f32_32x32x16_bf16 v[112:127], a[124:127], v[88:91], v[112:127]
    ds_read_b64_tr_b16 v[76:77], v20 offset:59392
    ds_read_b64_tr_b16 v[78:79], v20 offset:59904
    v_mfma_f32_32x32x16_bf16 v[128:143], a[120:123], v[92:95], v[128:143]
    buffer_load_dwordx4 v201, s[8:11], s57 offen offset:3072  lds
    v_mfma_f32_32x32x16_bf16 v[144:159], a[124:127], v[92:95], v[144:159]
    s_mul_i32 s57, s64, 6
    s_waitcnt lgkmcnt(0)
    v_mfma_f32_32x32x16_bf16 v[96:111], a[128:131], v[64:67], v[96:111]
    s_add_u32 m0, s60, 16384
    ds_read_b128 a[144:147], v228 offset:32768
    ds_read_b64_tr_b16 v[80:81], v20 offset:53248
    buffer_load_dwordx4 v204, s[84:87], s57 offen offset:0  lds
    v_mfma_f32_32x32x16_bf16 v[112:127], a[132:135], v[64:67], v[112:127]
    ds_read_b64_tr_b16 v[82:83], v20 offset:53760
    ds_read_b128 a[148:151], v228 offset:36864
    v_mfma_f32_32x32x16_bf16 v[128:143], a[128:131], v[68:71], v[128:143]
    ds_read_b64_tr_b16 v[84:85], v20 offset:61440
    ds_read_b64_tr_b16 v[86:87], v20 offset:61952
    buffer_load_dwordx4 v206, s[84:87], s57 offen offset:1024  lds
    v_mfma_f32_32x32x16_bf16 v[144:159], a[132:135], v[68:71], v[144:159]
    ds_read_b128 a[152:155], v229 offset:32768
    ds_read_b64_tr_b16 v[88:89], v20 offset:55296
    v_mfma_f32_32x32x16_bf16 v[96:111], a[136:139], v[72:75], v[96:111]
    s_add_u32 m0, s60, 24576
    ds_read_b64_tr_b16 v[90:91], v20 offset:55808
    ds_read_b128 a[156:159], v229 offset:36864
    buffer_load_dwordx4 v205, s[88:91], s57 offen offset:0  lds
    v_mfma_f32_32x32x16_bf16 v[112:127], a[140:143], v[72:75], v[112:127]
    ds_read_b64_tr_b16 v[92:93], v20 offset:63488
    ds_read_b64_tr_b16 v[94:95], v20 offset:64000
    v_mfma_f32_32x32x16_bf16 v[128:143], a[136:139], v[76:79], v[128:143]
    buffer_load_dwordx4 v207, s[88:91], s57 offen offset:1024  lds
    v_mfma_f32_32x32x16_bf16 v[144:159], a[140:143], v[76:79], v[144:159]
    s_and_b32 s52, s101, 3
    s_cmp_lg_u32 s52, 2
    s_cbranch_scc1 L_A_t2_3
    v_lshrrev_b32_e64 v239, 7, v246
    s_and_b32 s52, s92, 127
    s_bfe_u32 s53, s2, 0x10000
    s_lshl_b32 s54, s53, 7
    s_add_u32 s54, s54, s52
    s_lshl_b32 s54, s54, 1
    s_bfe_u32 s77, s2, 0x20001
    v_bfe_u32 v240, v239, 1, 1
    v_add_u32 v240, s54, v240
    v_and_b32_e64 v241, 1, v239
    v_lshl_add_u32 v241, s77, 1, v241
    v_lshlrev_b32_e64 v241, 7, v241
    v_mul_u32_u24 v242, 3072, v240
    v_add_u32 v242, v242, v241
    s_mov_b64 exec, 15
    buffer_load_dword v248, v242, s[12:15], 0 offen
    s_mov_b64 exec, -1
    v_lshrrev_b32 v242, 2, v239
    v_lshl_add_u32 v241, v242, 10, v241
    v_add_u32 v241, 1536, v241
    v_lshlrev_b32 v242, 7, s77
    v_add_u32 v242, 1024, v242
    v_cmp_gt_u32 vcc, 8, v239
    s_nop 1
    v_cndmask_b32 v241, v242, v241, vcc
    v_mul_u32_u24 v240, 3584, v240
    v_add_u32 v241, v241, v240
    s_mov_b64 exec, 0x5ff
    buffer_load_dword v250, v241, s[16:19], 0 offen
    buffer_load_dword v249, v241, s[20:23], 0 offen
    s_mov_b64 exec, -1
    v_lshrrev_b32 v240, 2, v239
    v_and_b32 v241, 3, v239
    v_lshlrev_b32 v241, 7, v241
    v_lshl_add_u32 v241, v240, 10, v241
    s_lshl_b32 s53, s53, 9
    s_lshl_b32 s54, s77, 7
    s_add_u32 s54, s54, s52
    s_lshl_b32 s77, s54, 10
    s_add_u32 s77, s77, s53
    s_mov_b64 exec, 15
    buffer_load_dword v247, v241, s[28:31], s77 offen
    s_lshl_b32 s77, s54, 12
    s_add_u32 s77, s77, s53
    s_mov_b64 exec, 0xffff
    buffer_load_dword v245, v241, s[24:27], s77 offen
    s_mov_b64 exec, -1
L_A_t2_3:
    s_waitcnt lgkmcnt(0)
    v_mfma_f32_32x32x16_bf16 v[96:111], a[144:147], v[80:83], v[96:111]
    s_waitcnt vmcnt(8)
    s_barrier
    ds_read_b128 a[160:163], v231 offset:0
    ds_read_b64_tr_b16 v[64:65], v40 offset:16384
    v_mfma_f32_32x32x16_bf16 v[112:127], a[148:151], v[80:83], v[112:127]
    s_mov_b32 s57, 896
    s_add_u32 m0, s59, 32768
    ds_read_b64_tr_b16 v[66:67], v40 offset:16896
    ds_read_b128 a[164:167], v231 offset:4096
    buffer_load_dwordx4 v198, s[8:11], s57 offen offset:0  lds
    v_mfma_f32_32x32x16_bf16 v[128:143], a[144:147], v[84:87], v[128:143]
    ds_read_b64_tr_b16 v[68:69], v40 offset:24576
    ds_read_b64_tr_b16 v[70:71], v40 offset:25088
    buffer_load_dwordx4 v199, s[8:11], s57 offen offset:1024  lds
    v_mfma_f32_32x32x16_bf16 v[144:159], a[148:151], v[84:87], v[144:159]
    ds_read_b128 a[168:171], v232 offset:0
    ds_read_b64_tr_b16 v[72:73], v40 offset:18432
    v_mfma_f32_32x32x16_bf16 v[96:111], a[152:155], v[88:91], v[96:111]
    ds_read_b64_tr_b16 v[74:75], v40 offset:18944
    ds_read_b128 a[172:175], v232 offset:4096
    buffer_load_dwordx4 v200, s[8:11], s57 offen offset:2048  lds
    v_mfma_f32_32x32x16_bf16 v[112:127], a[156:159], v[88:91], v[112:127]
    ds_read_b64_tr_b16 v[76:77], v40 offset:26624
    ds_read_b64_tr_b16 v[78:79], v40 offset:27136
    v_mfma_f32_32x32x16_bf16 v[128:143], a[152:155], v[92:95], v[128:143]
    buffer_load_dwordx4 v201, s[8:11], s57 offen offset:3072  lds
    v_mfma_f32_32x32x16_bf16 v[144:159], a[156:159], v[92:95], v[144:159]
    s_mul_i32 s57, s64, 7
    s_waitcnt lgkmcnt(0)
    v_mfma_f32_32x32x16_bf16 v[96:111], a[160:163], v[64:67], v[96:111]
    s_add_u32 m0, s60, 49152
    ds_read_b128 a[176:179], v233 offset:0
    ds_read_b64_tr_b16 v[80:81], v40 offset:20480
    buffer_load_dwordx4 v204, s[84:87], s57 offen offset:0  lds
    v_mfma_f32_32x32x16_bf16 v[112:127], a[164:167], v[64:67], v[112:127]
    ds_read_b64_tr_b16 v[82:83], v40 offset:20992
    ds_read_b128 a[180:183], v233 offset:4096
    v_mfma_f32_32x32x16_bf16 v[128:143], a[160:163], v[68:71], v[128:143]
    ds_read_b64_tr_b16 v[84:85], v40 offset:28672
    ds_read_b64_tr_b16 v[86:87], v40 offset:29184
    buffer_load_dwordx4 v206, s[84:87], s57 offen offset:1024  lds
    v_mfma_f32_32x32x16_bf16 v[144:159], a[164:167], v[68:71], v[144:159]
    ds_read_b128 a[184:187], v234 offset:0
    ds_read_b64_tr_b16 v[88:89], v40 offset:22528
    v_mfma_f32_32x32x16_bf16 v[96:111], a[168:171], v[72:75], v[96:111]
    s_add_u32 m0, s60, 57344
    ds_read_b64_tr_b16 v[90:91], v40 offset:23040
    ds_read_b128 a[188:191], v234 offset:4096
    buffer_load_dwordx4 v205, s[88:91], s57 offen offset:0  lds
    v_mfma_f32_32x32x16_bf16 v[112:127], a[172:175], v[72:75], v[112:127]
    ds_read_b64_tr_b16 v[92:93], v40 offset:30720
    ds_read_b64_tr_b16 v[94:95], v40 offset:31232
    v_mfma_f32_32x32x16_bf16 v[128:143], a[168:171], v[76:79], v[128:143]
    buffer_load_dwordx4 v207, s[88:91], s57 offen offset:1024  lds
    v_mfma_f32_32x32x16_bf16 v[144:159], a[172:175], v[76:79], v[144:159]
    s_and_b32 s52, s101, 3
    s_cmp_lg_u32 s52, 3
    s_cbranch_scc1 L_A_t2_4
    v_lshrrev_b32 v239, 7, v246
    s_and_b32 s52, s92, 127
    s_bfe_u32 s53, s2, 0x10000
    s_lshl_b32 s54, s53, 7
    s_add_u32 s54, s54, s52
    s_lshl_b32 s54, s54, 1
    s_bfe_u32 s77, s2, 0x20001
    v_bfe_u32 v240, v239, 1, 1
    v_add_u32 v240, s54, v240
    v_and_b32_e64 v241, 1, v239
    v_lshl_add_u32 v241, s77, 1, v241
    v_lshlrev_b32_e64 v241, 7, v241
    v_mul_u32_u24 v242, 3072, v240
    v_add_u32 v242, v242, v241
    s_mov_b64 exec, 15
    buffer_load_dword v248, v242, s[12:15], 0 offen
    s_mov_b64 exec, -1
    v_lshrrev_b32 v242, 2, v239
    v_lshl_add_u32 v241, v242, 10, v241
    v_add_u32 v241, 1536, v241
    v_lshlrev_b32 v242, 7, s77
    v_add_u32 v242, 1024, v242
    v_cmp_gt_u32 vcc, 8, v239
    s_nop 1
    v_cndmask_b32 v241, v242, v241, vcc
    v_mul_u32_u24 v240, 3584, v240
    v_add_u32 v241, v241, v240
    s_mov_b64 exec, 0x5ff
    buffer_load_dword v250, v241, s[16:19], 0 offen
    buffer_load_dword v249, v241, s[20:23], 0 offen
    s_mov_b64 exec, -1
    v_lshrrev_b32 v240, 2, v239
    v_and_b32 v241, 3, v239
    v_lshlrev_b32 v241, 7, v241
    v_lshl_add_u32 v241, v240, 10, v241
    s_lshl_b32 s53, s53, 9
    s_lshl_b32 s54, s77, 7
    s_add_u32 s54, s54, s52
    s_lshl_b32 s77, s54, 10
    s_add_u32 s77, s77, s53
    s_mov_b64 exec, 15
    buffer_load_dword v247, v241, s[28:31], s77 offen
    s_lshl_b32 s77, s54, 12
    s_add_u32 s77, s77, s53
    s_mov_b64 exec, 0xffff
    buffer_load_dword v245, v241, s[24:27], s77 offen
    s_mov_b64 exec, -1
L_A_t2_4:
    s_waitcnt lgkmcnt(0)
    v_mfma_f32_32x32x16_bf16 v[96:111], a[176:179], v[80:83], v[96:111]
    s_waitcnt vmcnt(8)
    s_barrier
    ds_read_b128 a[192:195], v226 offset:0
    ds_read_b64_tr_b16 v[64:65], v20 offset:16384
    v_mfma_f32_32x32x16_bf16 v[112:127], a[180:183], v[80:83], v[112:127]
    ds_read_b64_tr_b16 v[66:67], v20 offset:16896
    ds_read_b128 a[196:199], v226 offset:4096
    buffer_load_dwordx2 v[46:47], v230, s[32:35], 0 offen offset:0 sc1
    v_mfma_f32_32x32x16_bf16 v[128:143], a[176:179], v[84:87], v[128:143]
    ds_read_b64_tr_b16 v[68:69], v20 offset:24576
    ds_read_b64_tr_b16 v[70:71], v20 offset:25088
    buffer_load_dwordx2 v[48:49], v230, s[32:35], 0 offen offset:256 sc1
    v_mfma_f32_32x32x16_bf16 v[144:159], a[180:183], v[84:87], v[144:159]
    s_mov_b32 s57, 2560
    ds_read_b128 a[200:203], v227 offset:0
    ds_read_b64_tr_b16 v[72:73], v20 offset:18432
    v_mfma_f32_32x32x16_bf16 v[96:111], a[184:187], v[88:91], v[96:111]
    s_add_u32 m0, s60, 65536
    ds_read_b64_tr_b16 v[74:75], v20 offset:18944
    ds_read_b128 a[204:207], v227 offset:4096
    buffer_load_dwordx4 v10, s[16:19], s57 offen offset:0  lds
    v_mfma_f32_32x32x16_bf16 v[112:127], a[188:191], v[88:91], v[112:127]
    ds_read_b64_tr_b16 v[76:77], v20 offset:26624
    ds_read_b64_tr_b16 v[78:79], v20 offset:27136
    buffer_load_dwordx4 v12, s[16:19], s57 offen offset:1024  lds
    v_mfma_f32_32x32x16_bf16 v[128:143], a[184:187], v[92:95], v[128:143]
    v_mfma_f32_32x32x16_bf16 v[144:159], a[188:191], v[92:95], v[144:159]
    s_add_u32 m0, s60, 73728
    s_nop 0
    buffer_load_dwordx4 v11, s[20:23], s57 offen offset:0  lds
    s_waitcnt lgkmcnt(0)
    v_mfma_f32_32x32x16_bf16 v[96:111], a[192:195], v[64:67], v[96:111]
    ds_read_b128 a[208:211], v228 offset:0
    ds_read_b64_tr_b16 v[80:81], v20 offset:20480
    buffer_load_dwordx4 v13, s[20:23], s57 offen offset:1024  lds
    v_mfma_f32_32x32x16_bf16 v[112:127], a[196:199], v[64:67], v[112:127]
    s_mov_b32 s57, 0
    ds_read_b64_tr_b16 v[82:83], v20 offset:20992
    ds_read_b128 a[212:215], v228 offset:4096
    v_mfma_f32_32x32x16_bf16 v[128:143], a[192:195], v[68:71], v[128:143]
    s_add_u32 m0, s60, 147456
    ds_read_b64_tr_b16 v[84:85], v20 offset:28672
    ds_read_b64_tr_b16 v[86:87], v20 offset:29184
    buffer_load_dwordx4 v14, s[12:15], s57 offen offset:0  lds
    v_mfma_f32_32x32x16_bf16 v[144:159], a[196:199], v[68:71], v[144:159]
    ds_read_b128 a[216:219], v229 offset:0
    ds_read_b64_tr_b16 v[88:89], v20 offset:22528
    buffer_load_dwordx4 v15, s[12:15], s57 offen offset:1024  lds
    v_mfma_f32_32x32x16_bf16 v[96:111], a[200:203], v[72:75], v[96:111]
    s_mov_b32 s57, 196608
    ds_read_b64_tr_b16 v[90:91], v20 offset:23040
    ds_read_b128 a[220:223], v229 offset:4096
    v_mfma_f32_32x32x16_bf16 v[112:127], a[204:207], v[72:75], v[112:127]
    s_add_u32 m0, s60, 81920
    ds_read_b64_tr_b16 v[92:93], v20 offset:30720
    ds_read_b64_tr_b16 v[94:95], v20 offset:31232
    buffer_load_dwordx4 v14, s[12:15], s57 offen offset:0  lds
    v_mfma_f32_32x32x16_bf16 v[128:143], a[200:203], v[76:79], v[128:143]
    buffer_load_dwordx4 v15, s[12:15], s57 offen offset:1024  lds
    v_mfma_f32_32x32x16_bf16 v[144:159], a[204:207], v[76:79], v[144:159]
    s_waitcnt lgkmcnt(0)
    v_mfma_f32_32x32x16_bf16 v[96:111], a[208:211], v[80:83], v[96:111]
    s_waitcnt vmcnt(10)
    s_barrier
    ds_read_b128 a[224:227], v226 offset:32768
    ds_read_b64_tr_b16 v[64:65], v20 offset:49152
    v_mfma_f32_32x32x16_bf16 v[112:127], a[212:215], v[80:83], v[112:127]
    s_mov_b32 s57, 231936
    s_add_u32 m0, s60, 0
    ds_read_b64_tr_b16 v[66:67], v20 offset:49664
    ds_read_b128 a[228:231], v226 offset:36864
    buffer_load_dwordx4 v10, s[16:19], s57 offen offset:0  lds
    v_mfma_f32_32x32x16_bf16 v[128:143], a[208:211], v[84:87], v[128:143]
    ds_read_b64_tr_b16 v[68:69], v20 offset:57344
    ds_read_b64_tr_b16 v[70:71], v20 offset:57856
    buffer_load_dwordx4 v12, s[16:19], s57 offen offset:1024  lds
    v_mfma_f32_32x32x16_bf16 v[144:159], a[212:215], v[84:87], v[144:159]
    ds_read_b128 a[232:235], v227 offset:32768
    ds_read_b64_tr_b16 v[72:73], v20 offset:51200
    v_mfma_f32_32x32x16_bf16 v[96:111], a[216:219], v[88:91], v[96:111]
    s_add_u32 m0, s60, 8192
    ds_read_b64_tr_b16 v[74:75], v20 offset:51712
    ds_read_b128 a[236:239], v227 offset:36864
    buffer_load_dwordx4 v11, s[20:23], s57 offen offset:0  lds
    v_mfma_f32_32x32x16_bf16 v[112:127], a[220:223], v[88:91], v[112:127]
    ds_read_b64_tr_b16 v[76:77], v20 offset:59392
    ds_read_b64_tr_b16 v[78:79], v20 offset:59904
    v_mfma_f32_32x32x16_bf16 v[128:143], a[216:219], v[92:95], v[128:143]
    buffer_load_dwordx4 v13, s[20:23], s57 offen offset:1024  lds
    v_mfma_f32_32x32x16_bf16 v[144:159], a[220:223], v[92:95], v[144:159]
    s_mov_b32 s57, 393216
    s_waitcnt lgkmcnt(0)
    v_mfma_f32_32x32x16_bf16 v[96:111], a[224:227], v[64:67], v[96:111]
    s_add_u32 m0, s60, 90112
    ds_read_b128 a[240:243], v228 offset:32768
    ds_read_b64_tr_b16 v[80:81], v20 offset:53248
    buffer_load_dwordx4 v14, s[12:15], s57 offen offset:0  lds
    v_mfma_f32_32x32x16_bf16 v[112:127], a[228:231], v[64:67], v[112:127]
    ds_read_b64_tr_b16 v[82:83], v20 offset:53760
    ds_read_b128 a[244:247], v228 offset:36864
    s_waitcnt vmcnt(14)
    v_cmp_ne_u32 vcc, s49, v47
    s_cbranch_vccnz L_A_again_6
L_A_ok_5:
    v_sub_f32 v47, 1.0, v46
    v_cvt_pk_bf16_f32 v47, v47, v47
    v_mfma_f32_32x32x16_bf16 v[128:143], a[224:227], v[68:71], v[128:143]
    ds_read_b64_tr_b16 v[84:85], v20 offset:61440
    ds_read_b64_tr_b16 v[86:87], v20 offset:61952
    buffer_load_dwordx4 v15, s[12:15], s57 offen offset:1024  lds
    v_and_b32 v47, 0xffff0000, v47
    v_mfma_f32_32x32x16_bf16 v[144:159], a[228:231], v[68:71], v[144:159]
    s_mov_b32 s57, 589824
    ds_read_b128 a[248:251], v229 offset:32768
    ds_read_b64_tr_b16 v[88:89], v20 offset:55296
    v_max_f32 v47, 0x0da24260, v47
    v_rcp_f32 v47, v47
    v_mfma_f32_32x32x16_bf16 v[96:111], a[232:235], v[72:75], v[96:111]
L_islA2:
    s_cbranch_execz L_retA
    s_add_u32 m0, s60, 16384
    ds_read_b64_tr_b16 v[90:91], v20 offset:55808
    ds_read_b128 a[252:255], v229 offset:36864
    buffer_load_dwordx4 v14, s[12:15], s57 offen offset:0  lds
    v_mfma_f32_32x32x16_bf16 v[112:127], a[236:239], v[72:75], v[112:127]
    ds_read_b64_tr_b16 v[92:93], v20 offset:63488
    ds_read_b64_tr_b16 v[94:95], v20 offset:64000
    s_waitcnt vmcnt(15)
    v_cmp_ne_u32 vcc, s49, v49
    s_cbranch_vccnz L_A_again_8
L_A_ok_7:
    v_sub_f32 v49, 1.0, v48
    v_cvt_pk_bf16_f32 v49, v49, v49
    v_mfma_f32_32x32x16_bf16 v[128:143], a[232:235], v[76:79], v[128:143]
    buffer_load_dwordx4 v15, s[12:15], s57 offen offset:1024  lds
    v_and_b32 v49, 0xffff0000, v49
    v_max_f32 v49, 0x0da24260, v49
    v_mfma_f32_32x32x16_bf16 v[144:159], a[236:239], v[76:79], v[144:159]
    v_rcp_f32 v49, v49
    s_waitcnt lgkmcnt(0)
    v_mfma_f32_32x32x16_bf16 v[96:111], a[240:243], v[80:83], v[96:111]
    s_waitcnt vmcnt(8)
    s_barrier
    ds_read_b64_tr_b16 v[64:65], v41 offset:16384
    ds_read_b64_tr_b16 v[66:67], v41 offset:16896
    v_mfma_f32_32x32x16_bf16 v[112:127], a[244:247], v[80:83], v[112:127]
    s_mov_b32 s57, 461312
    s_add_u32 m0, s60, 32768
    ds_read_b64_tr_b16 v[68:69], v42 offset:0
    buffer_load_dwordx4 v10, s[16:19], s57 offen offset:0  lds
    v_mfma_f32_32x32x16_bf16 v[128:143], a[240:243], v[84:87], v[128:143]
    ds_read_b64_tr_b16 v[70:71], v42 offset:512
    v_mfma_f32_32x32x16_bf16 v[144:159], a[244:247], v[84:87], v[144:159]
    ds_read_b64_tr_b16 v[72:73], v43 offset:0
    ds_read_b64_tr_b16 v[74:75], v43 offset:512
    v_mfma_f32_32x32x16_bf16 v[96:111], a[248:251], v[88:91], v[96:111]
    ds_read_b64_tr_b16 v[76:77], v41 offset:18432
    buffer_load_dwordx4 v12, s[16:19], s57 offen offset:1024  lds
    v_mfma_f32_32x32x16_bf16 v[112:127], a[252:255], v[88:91], v[112:127]
    ds_read_b64_tr_b16 v[78:79], v41 offset:18944
    v_mfma_f32_32x32x16_bf16 v[128:143], a[248:251], v[92:95], v[128:143]
    v_mfma_f32_32x32x16_bf16 v[144:159], a[252:255], v[92:95], v[144:159]
    s_add_u32 m0, s60, 40960
    s_nop 0
    buffer_load_dwordx4 v11, s[20:23], s57 offen offset:0  lds
    s_waitcnt lgkmcnt(0)
    v_mfma_f32_32x32x16_bf16 v[160:175], v[64:67], a[0:3], 0
    ds_read_b64_tr_b16 v[80:81], v41 offset:20480
    ds_read_b64_tr_b16 v[82:83], v41 offset:20992
    v_mfma_f32_32x32x16_bf16 v[176:191], v[64:67], a[4:7], 0
    ds_read_b64_tr_b16 v[84:85], v42 offset:2048
    v_mov_b32 v50, 0x3f803f80
    v_mov_b32 v51, 0x3f803f80
    v_mov_b32 v52, 0x3f803f80
    v_mov_b32 v53, 0x3f803f80
    v_mul_f32 v2, 0x3fb8aa3b, v96
    v_mul_f32 v3, 0x3fb8aa3b, v97
    v_mfma_f32_32x32x16_bf16 v[192:207], v[68:71], a[0:3], 0
    ds_read_b64_tr_b16 v[86:87], v42 offset:2560
    buffer_load_dwordx4 v13, s[20:23], s57 offen offset:1024  lds
    v_mul_f32 v4, 0x3fb8aa3b, v98
    v_mul_f32 v5, 0x3fb8aa3b, v99
    v_mfma_f32_32x32x16_bf16 v[208:223], v[68:71], a[4:7], 0
    ds_read_b64_tr_b16 v[88:89], v43 offset:2048
    ds_read_b64_tr_b16 v[90:91], v43 offset:2560
    v_exp_f32_e64 v2, v2 clamp
    v_exp_f32_e64 v3, v3 clamp
    v_mfma_f32_32x32x16_bf16 v[224:239], v[72:75], a[0:3], 0
    s_mov_b32 s57, 786432
    ds_read_b64_tr_b16 v[92:93], v41 offset:22528
    v_exp_f32_e64 v4, v4 clamp
    v_exp_f32_e64 v5, v5 clamp
    v_max_f32 v96, 0x358637bd, v96
    v_max_f32 v97, 0x358637bd, v97
    v_mfma_f32_32x32x16_bf16 v[240:255], v[72:75], a[4:7], 0
    s_add_u32 m0, s60, 24576
    ds_read_b64_tr_b16 v[94:95], v41 offset:23040
    buffer_load_dwordx4 v14, s[12:15], s57 offen offset:0  lds
    v_max_f32 v98, 0x358637bd, v98
    v_max_f32 v99, 0x358637bd, v99
    v_add_f32_e64 v2, v2, v96
    v_mfma_f32_32x32x16_bf16 v[160:175], v[76:79], a[8:11], v[160:175]
    v_add_f32 v3, v3, v97
    v_add_f32 v4, v4, v98
    v_add_f32_e64 v5, v5, v99
    v_cvt_pk_bf16_f32 v96, v2, v3
    v_cvt_pk_bf16_f32 v97, v4, v5
    v_mul_f32 v2, 0x3fb8aa3b, v100
    v_mul_f32 v3, 0x3fb8aa3b, v101
    v_mfma_f32_32x32x16_bf16 v[176:191], v[76:79], a[12:15], v[176:191]
    v_mul_f32 v4, 0x3fb8aa3b, v102
    v_mul_f32 v5, 0x3fb8aa3b, v103
    v_exp_f32_e64 v2, v2 clamp
    v_exp_f32_e64 v3, v3 clamp
    s_waitcnt lgkmcnt(0)
    v_mfma_f32_32x32x16_bf16 v[160:175], v[80:83], a[16:19], v[160:175]
    ds_read_b64_tr_b16 v[64:65], v40 offset:16384
    ds_read_b64_tr_b16 v[66:67], v40 offset:16896
    buffer_load_dwordx4 v15, s[12:15], s57 offen offset:1024  lds
    v_exp_f32_e64 v4, v4 clamp
    v_mfma_f32_32x32x16_bf16 v[176:191], v[80:83], a[20:23], v[176:191]
    s_nop 0
    ds_read_b64_tr_b16 v[68:69], v42 offset:4096
    v_exp_f32_e64 v5, v5 clamp
    v_max_f32 v100, 0x358637bd, v100
    v_max_f32 v101, 0x358637bd, v101
    v_max_f32 v102, 0x358637bd, v102
    v_max_f32 v103, 0x358637bd, v103
    v_mfma_f32_32x32x16_bf16 v[192:207], v[84:87], a[8:11], v[192:207]
    s_mov_b32 s57, 983040
    ds_read_b64_tr_b16 v[70:71], v42 offset:4608
    v_add_f32 v2, v2, v100
    v_add_f32 v3, v3, v101
    v_add_f32 v4, v4, v102
    v_add_f32 v5, v5, v103
    v_cvt_pk_bf16_f32 v98, v2, v3
    v_cvt_pk_bf16_f32 v99, v4, v5
    v_mfma_f32_32x32x16_bf16 v[208:223], v[84:87], a[12:15], v[208:223]
    s_add_u32 m0, s60, 49152
    ds_read_b64_tr_b16 v[72:73], v43 offset:4096
    ds_read_b64_tr_b16 v[74:75], v43 offset:4608
    buffer_load_dwordx4 v14, s[12:15], s57 offen offset:0  lds
    v_mul_f32 v2, 0x3fb8aa3b, v104
    v_mul_f32 v3, 0x3fb8aa3b, v105
    v_mfma_f32_32x32x16_bf16 v[224:239], v[88:91], a[8:11], v[224:239]
    ds_read_b64_tr_b16 v[76:77], v40 offset:18432
    v_mul_f32 v4, 0x3fb8aa3b, v106
    v_mul_f32 v5, 0x3fb8aa3b, v107
    v_exp_f32_e64 v2, v2 clamp
    v_exp_f32_e64 v3, v3 clamp
    v_mfma_f32_32x32x16_bf16 v[240:255], v[88:91], a[12:15], v[240:255]
    ds_read_b64_tr_b16 v[78:79], v40 offset:18944
    v_exp_f32_e64 v4, v4 clamp
    v_exp_f32_e64 v5, v5 clamp
    v_max_f32 v104, 0x358637bd, v104
    v_max_f32 v105, 0x358637bd, v105
    v_mfma_f32_32x32x16_bf16 v[160:175], v[92:95], a[24:27], v[160:175]
    buffer_load_dwordx4 v15, s[12:15], s57 offen offset:1024  lds
    v_max_f32 v106, 0x358637bd, v106
    v_max_f32 v107, 0x358637bd, v107
    v_add_f32 v2, v2, v104
    v_add_f32 v3, v3, v105
    v_mfma_f32_32x32x16_bf16 v[176:191], v[92:95], a[28:31], v[176:191]
    v_add_f32 v4, v4, v106
    v_add_f32 v5, v5, v107
    v_cvt_pk_bf16_f32 v100, v2, v3
    v_cvt_pk_bf16_f32 v101, v4, v5
    v_mul_f32 v2, 0x3fb8aa3b, v108
    v_mul_f32 v3, 0x3fb8aa3b, v109
    v_mul_f32 v4, 0x3fb8aa3b, v110
    s_waitcnt lgkmcnt(0)
    v_mfma_f32_32x32x16_bf16 v[160:175], v[64:67], a[32:35], v[160:175]
    s_lshl4_add_u32 s57, s93, 0
    ds_read_b64_tr_b16 v[80:81], v40 offset:20480
    ds_read_b64_tr_b16 v[82:83], v40 offset:20992
    v_mul_f32 v5, 0x3fb8aa3b, v111
    v_exp_f32_e64 v2, v2 clamp
    v_exp_f32_e64 v3, v3 clamp
    v_mfma_f32_32x32x16_bf16 v[176:191], v[64:67], a[36:39], v[176:191]
    s_add_u32 m0, s60, 57344
    ds_read_b64_tr_b16 v[84:85], v42 offset:6144
    buffer_load_dwordx4 v22, s[24:27], s57 offen offset:0  lds
    v_exp_f32_e64 v4, v4 clamp
    v_mfma_f32_32x32x16_bf16 v[192:207], v[68:71], a[16:19], v[192:207]
    ds_read_b64_tr_b16 v[86:87], v42 offset:6656
    v_exp_f32_e64 v5, v5 clamp
    v_max_f32 v108, 0x358637bd, v108
    v_max_f32 v109, 0x358637bd, v109
    v_max_f32 v110, 0x358637bd, v110
    v_max_f32 v111, 0x358637bd, v111
    v_mfma_f32_32x32x16_bf16 v[208:223], v[68:71], a[20:23], v[208:223]
    ds_read_b64_tr_b16 v[88:89], v43 offset:6144
    ds_read_b64_tr_b16 v[90:91], v43 offset:6656
    v_add_f32 v2, v2, v108
    v_add_f32 v3, v3, v109
    v_add_f32 v4, v4, v110
    v_add_f32 v5, v5, v111
    v_cvt_pk_bf16_f32 v102, v2, v3
    v_mfma_f32_32x32x16_bf16 v[224:239], v[72:75], a[16:19], v[224:239]
    ds_read_b64_tr_b16 v[92:93], v40 offset:22528
    buffer_load_dwordx4 v24, s[24:27], s57 offen offset:1024  lds
    v_cvt_pk_bf16_f32 v103, v4, v5
    v_cvt_pk_bf16_f32 v128, v128, v129
    v_cvt_pk_bf16_f32 v129, v130, v131
    v_mfma_f32_32x32x16_bf16 v[240:255], v[72:75], a[20:23], v[240:255]
    ds_read_b64_tr_b16 v[94:95], v40 offset:23040
    v_cvt_pk_bf16_f32 v130, v132, v133
    v_cvt_pk_bf16_f32 v131, v134, v135
    v_cvt_pk_bf16_f32 v132, v136, v137
    v_cvt_pk_bf16_f32 v133, v138, v139
    v_cvt_pk_bf16_f32 v134, v140, v141
    v_cvt_pk_bf16_f32 v135, v142, v143
    v_mfma_f32_32x32x16_bf16 v[160:175], v[76:79], a[40:43], v[160:175]
    v_mul_f32 v2, 0x3fb8aa3b, v112
    v_mul_f32 v3, 0x3fb8aa3b, v113
    v_mul_f32 v4, 0x3fb8aa3b, v114
    v_mul_f32 v5, 0x3fb8aa3b, v115
    v_exp_f32_e64 v2, v2 clamp
    v_mfma_f32_32x32x16_bf16 v[176:191], v[76:79], a[44:47], v[176:191]
    v_exp_f32_e64 v3, v3 clamp
    v_exp_f32_e64 v4, v4 clamp
    v_exp_f32_e64 v5, v5 clamp
    v_max_f32 v112, 0x358637bd, v112
    s_waitcnt lgkmcnt(0)
    v_mfma_f32_32x32x16_bf16 v[160:175], v[80:83], a[48:51], v[160:175]
    s_waitcnt vmcnt(10)
    s_barrier
    ds_read_b64_tr_b16 v[64:65], v40 offset:24576
    ds_read_b64_tr_b16 v[66:67], v40 offset:25088
    v_max_f32 v113, 0x358637bd, v113
    v_max_f32 v114, 0x358637bd, v114
    v_max_f32 v115, 0x358637bd, v115
    v_mfma_f32_32x32x16_bf16 v[176:191], v[80:83], a[52:55], v[176:191]
    s_mov_b32 s57, 690688
    s_add_u32 m0, s60, 65536
    ds_read_b64_tr_b16 v[68:69], v16 offset:0
    buffer_load_dwordx4 v10, s[16:19], s57 offen offset:0  lds
    v_add_f32 v2, v2, v112
    v_add_f32_e64 v3, v3, v113
    v_mfma_f32_32x32x16_bf16 v[192:207], v[84:87], a[24:27], v[192:207]
    ds_read_b64_tr_b16 v[70:71], v16 offset:512
    v_add_f32 v4, v4, v114
    v_add_f32 v5, v5, v115
    v_cvt_pk_bf16_f32 v104, v2, v3
    v_cvt_pk_bf16_f32 v105, v4, v5
    v_mul_f32 v2, 0x3fb8aa3b, v116
    v_mul_f32 v3, 0x3fb8aa3b, v117
    v_mfma_f32_32x32x16_bf16 v[208:223], v[84:87], a[28:31], v[208:223]
    ds_read_b64_tr_b16 v[72:73], v17 offset:0
    ds_read_b64_tr_b16 v[74:75], v17 offset:512
    v_mul_f32 v4, 0x3fb8aa3b, v118
    v_mul_f32 v5, 0x3fb8aa3b, v119
    v_exp_f32_e64 v2, v2 clamp
    v_mfma_f32_32x32x16_bf16 v[224:239], v[88:91], a[24:27], v[224:239]
    ds_read_b64_tr_b16 v[76:77], v40 offset:26624
    buffer_load_dwordx4 v12, s[16:19], s57 offen offset:1024  lds
    v_exp_f32_e64 v3, v3 clamp
    v_mfma_f32_32x32x16_bf16 v[240:255], v[88:91], a[28:31], v[240:255]
    ds_read_b64_tr_b16 v[78:79], v40 offset:27136
    v_exp_f32_e64 v4, v4 clamp
    v_exp_f32_e64 v5, v5 clamp
    v_max_f32 v116, 0x358637bd, v116
    v_max_f32 v117, 0x358637bd, v117
    v_mfma_f32_32x32x16_bf16 v[160:175], v[92:95], a[56:59], v[160:175]
    v_max_f32 v118, 0x358637bd, v118
    v_max_f32 v119, 0x358637bd, v119
    v_add_f32 v2, v2, v116
    v_add_f32 v3, v3, v117
    v_add_f32 v4, v4, v118
    v_add_f32 v5, v5, v119
    v_cvt_pk_bf16_f32 v106, v2, v3
    v_mfma_f32_32x32x16_bf16 v[176:191], v[92:95], a[60:63], v[176:191]
    s_add_u32 m0, s60, 73728
    s_nop 0
    buffer_load_dwordx4 v11, s[20:23], s57 offen offset:0  lds
    v_cvt_pk_bf16_f32 v107, v4, v5
    v_mul_f32 v2, 0x3fb8aa3b, v120
    v_mul_f32 v3, 0x3fb8aa3b, v121
    v_mul_f32 v4, 0x3fb8aa3b, v122
    s_waitcnt lgkmcnt(0)
    v_mfma_f32_32x32x16_bf16 v[160:175], v[64:67], a[64:67], v[160:175]
    ds_read_b64_tr_b16 v[80:81], v40 offset:28672
    ds_read_b64_tr_b16 v[82:83], v40 offset:29184
    v_mul_f32 v5, 0x3fb8aa3b, v123
    v_exp_f32_e64 v2, v2 clamp
    v_exp_f32_e64 v3, v3 clamp
    v_mfma_f32_32x32x16_bf16 v[176:191], v[64:67], a[68:71], v[176:191]
    ds_read_b64_tr_b16 v[84:85], v16 offset:2048
    v_exp_f32_e64 v4, v4 clamp
    v_exp_f32_e64 v5, v5 clamp
    v_max_f32 v120, 0x358637bd, v120
    v_max_f32 v121, 0x358637bd, v121
    v_mfma_f32_32x32x16_bf16 v[192:207], v[68:71], a[32:35], v[192:207]
    ds_read_b64_tr_b16 v[86:87], v16 offset:2560
    buffer_load_dwordx4 v13, s[20:23], s57 offen offset:1024  lds
    v_max_f32 v122, 0x358637bd, v122
    v_max_f32 v123, 0x358637bd, v123
    v_add_f32_e64 v2, v2, v120
    v_mfma_f32_32x32x16_bf16 v[208:223], v[68:71], a[36:39], v[208:223]
    ds_read_b64_tr_b16 v[88:89], v17 offset:2048
    ds_read_b64_tr_b16 v[90:91], v17 offset:2560
    v_add_f32 v3, v3, v121
    v_add_f32 v4, v4, v122
    v_add_f32_e64 v5, v5, v123
    v_cvt_pk_bf16_f32 v108, v2, v3
    v_cvt_pk_bf16_f32 v109, v4, v5
    v_mfma_f32_32x32x16_bf16 v[224:239], v[72:75], a[32:35], v[224:239]
    s_mov_b32 s57, 1179648
    ds_read_b64_tr_b16 v[92:93], v40 offset:30720
    v_mul_f32 v2, 0x3fb8aa3b, v124
    v_mul_f32 v3, 0x3fb8aa3b, v125
    v_mul_f32 v4, 0x3fb8aa3b, v126
    v_mul_f32 v5, 0x3fb8aa3b, v127
    v_exp_f32_e64 v2, v2 clamp
    v_mfma_f32_32x32x16_bf16 v[240:255], v[72:75], a[36:39], v[240:255]
    s_add_u32 m0, s60, 81920
    ds_read_b64_tr_b16 v[94:95], v40 offset:31232
    buffer_load_dwordx4 v14, s[12:15], s57 offen offset:0  lds
    v_exp_f32_e64 v3, v3 clamp
    v_mfma_f32_32x32x16_bf16 v[160:175], v[76:79], a[72:75], v[160:175]
    v_exp_f32_e64 v4, v4 clamp
    v_exp_f32_e64 v5, v5 clamp
    v_max_f32 v124, 0x358637bd, v124
    v_max_f32 v125, 0x358637bd, v125
    v_max_f32 v126, 0x358637bd, v126
    v_mfma_f32_32x32x16_bf16 v[176:191], v[76:79], a[76:79], v[176:191]
    v_max_f32 v127, 0x358637bd, v127
    v_add_f32 v2, v2, v124
    v_add_f32 v3, v3, v125
    v_add_f32 v4, v4, v126
    v_add_f32 v5, v5, v127
    v_cvt_pk_bf16_f32 v110, v2, v3
    v_cvt_pk_bf16_f32 v111, v4, v5
    s_waitcnt lgkmcnt(0)
    v_mfma_f32_32x32x16_bf16 v[160:175], v[80:83], a[80:83], v[160:175]
    ds_read_b64_tr_b16 v[64:65], v20 offset:16384
    ds_read_b64_tr_b16 v[66:67], v20 offset:16896
    buffer_load_dwordx4 v15, s[12:15], s57 offen offset:1024  lds
    v_cvt_pk_bf16_f32 v136, v144, v145
    v_cvt_pk_bf16_f32 v137, v146, v147
    v_mfma_f32_32x32x16_bf16 v[176:191], v[80:83], a[84:87], v[176:191]
    s_nop 0
    ds_read_b64_tr_b16 v[68:69], v16 offset:4096
    v_cvt_pk_bf16_f32 v138, v148, v149
    v_cvt_pk_bf16_f32 v139, v150, v151
    v_cvt_pk_bf16_f32 v140, v152, v153
    v_cvt_pk_bf16_f32 v141, v154, v155
    v_cvt_pk_bf16_f32 v142, v156, v157
    v_cvt_pk_bf16_f32 v143, v158, v159
    v_mfma_f32_32x32x16_bf16 v[192:207], v[84:87], a[40:43], v[192:207]
    s_mov_b32 s57, 1376256
    ds_read_b64_tr_b16 v[70:71], v16 offset:4608
    v_mfma_f32_32x32x16_bf16 v[112:127], v[96:99], v[128:131], 0
    v_mfma_f32_32x32x16_bf16 v[144:159], v[50:53], v[96:99], 0
    v_mfma_f32_32x32x16_bf16 v[208:223], v[84:87], a[44:47], v[208:223]
    s_add_u32 m0, s60, 147456
    ds_read_b64_tr_b16 v[72:73], v17 offset:4096
    ds_read_b64_tr_b16 v[74:75], v17 offset:4608
    buffer_load_dwordx4 v14, s[12:15], s57 offen offset:0  lds
    v_mfma_f32_32x32x16_bf16 v[112:127], v[100:103], v[132:135], v[112:127]
    v_mfma_f32_32x32x16_bf16 v[144:159], v[50:53], v[100:103], v[144:159]
    v_mfma_f32_32x32x16_bf16 v[224:239], v[88:91], a[40:43], v[224:239]
    ds_read_b64_tr_b16 v[76:77], v20 offset:18432
    v_mfma_f32_32x32x16_bf16 v[112:127], v[104:107], v[136:139], v[112:127]
    v_mfma_f32_32x32x16_bf16 v[144:159], v[50:53], v[104:107], v[144:159]
    v_mfma_f32_32x32x16_bf16 v[240:255], v[88:91], a[44:47], v[240:255]
    ds_read_b64_tr_b16 v[78:79], v20 offset:18944
    v_mfma_f32_32x32x16_bf16 v[112:127], v[108:111], v[140:143], v[112:127]
    v_mfma_f32_32x32x16_bf16 v[144:159], v[50:53], v[108:111], v[144:159]
    v_mfma_f32_32x32x16_bf16 v[160:175], v[92:95], a[88:91], v[160:175]
    buffer_load_dwordx4 v15, s[12:15], s57 offen offset:1024  lds
    v_mfma_f32_32x32x16_bf16 v[176:191], v[92:95], a[92:95], v[176:191]
    s_waitcnt lgkmcnt(0)
    v_mfma_f32_32x32x16_bf16 v[160:175], v[64:67], a[96:99], v[160:175]
    s_lshl4_add_u32 s57, s94, 0
    ds_read_b64_tr_b16 v[80:81], v20 offset:20480
    ds_read_b64_tr_b16 v[82:83], v20 offset:20992
    s_nop 2
    v_cndmask_b32 v112, v112, v120, s[78:79]
    v_cndmask_b32 v113, v113, v121, s[78:79]
    v_cndmask_b32 v114, v114, v122, s[78:79]
    v_cndmask_b32 v115, v115, v123, s[78:79]
    v_mfma_f32_32x32x16_bf16 v[176:191], v[64:67], a[100:103], v[176:191]
    s_add_u32 m0, s60, 139264
    ds_read_b64_tr_b16 v[84:85], v16 offset:6144
    buffer_load_dwordx4 v22, s[24:27], s57 offen offset:0  lds
    v_cndmask_b32 v116, v116, v124, s[78:79]
    v_cndmask_b32 v117, v117, v125, s[78:79]
    v_mfma_f32_32x32x16_bf16 v[192:207], v[68:71], a[48:51], v[192:207]
    s_nop 0
    ds_read_b64_tr_b16 v[86:87], v16 offset:6656
    v_cndmask_b32 v118, v118, v126, s[78:79]
    v_cndmask_b32 v119, v119, v127, s[78:79]
    v_cndmask_b32 v120, v112, v116, s[80:81]
    v_cndmask_b32 v121, v113, v117, s[80:81]
    v_cndmask_b32 v122, v114, v118, s[80:81]
    v_mfma_f32_32x32x16_bf16 v[208:223], v[68:71], a[52:55], v[208:223]
    ds_read_b64_tr_b16 v[88:89], v17 offset:6144
    ds_read_b64_tr_b16 v[90:91], v17 offset:6656
    v_cndmask_b32 v123, v115, v119, s[80:81]
    v_cndmask_b32 v124, v116, v112, s[80:81]
    v_cndmask_b32 v125, v117, v113, s[80:81]
    v_cndmask_b32 v126, v118, v114, s[80:81]
    v_mfma_f32_32x32x16_bf16 v[224:239], v[72:75], a[48:51], v[224:239]
    ds_read_b64_tr_b16 v[92:93], v20 offset:22528
    buffer_load_dwordx4 v24, s[24:27], s57 offen offset:1024  lds
    v_cndmask_b32 v127, v119, v115, s[80:81]
    v_lshrrev_b32_e64 v54, 2, v39
    v_mfma_f32_32x32x16_bf16 v[240:255], v[72:75], a[52:55], v[240:255]
    ds_read_b64_tr_b16 v[94:95], v20 offset:23040
    v_add_u32 v54, 120832, v54
    v_mfma_f32_32x32x16_bf16 v[160:175], v[76:79], a[104:107], v[160:175]
    ds_write_b128 v39, v[124:127]
    ds_write_b32 v54, v144
    v_xor_b32 v54, 0x200, v54
    v_xor_b32 v6, 0x800, v39
    v_mfma_f32_32x32x16_bf16 v[176:191], v[76:79], a[108:111], v[176:191]
    s_waitcnt lgkmcnt(0)
    v_mfma_f32_32x32x16_bf16 v[160:175], v[80:83], a[112:115], v[160:175]
    s_waitcnt vmcnt(12)
    s_barrier
    ds_read_b64_tr_b16 v[64:65], v20 offset:24576
    ds_read_b64_tr_b16 v[66:67], v20 offset:25088
    v_mfma_f32_32x32x16_bf16 v[176:191], v[80:83], a[116:119], v[176:191]
    s_mov_b32 s57, 920064
    s_add_u32 m0, s60, 0
    ds_read_b64_tr_b16 v[68:69], v16 offset:32768
    ds_read_b128 v[124:127], v6
    ds_read_b32 v145, v54
    buffer_load_dwordx4 v10, s[16:19], s57 offen offset:0  lds
    v_mfma_f32_32x32x16_bf16 v[192:207], v[84:87], a[56:59], v[192:207]
    ds_read_b64_tr_b16 v[70:71], v16 offset:33280
    v_mfma_f32_32x32x16_bf16 v[208:223], v[84:87], a[60:63], v[208:223]
    ds_read_b64_tr_b16 v[72:73], v17 offset:32768
    ds_read_b64_tr_b16 v[74:75], v17 offset:33280
    v_mfma_f32_32x32x16_bf16 v[224:239], v[88:91], a[56:59], v[224:239]
    ds_read_b64_tr_b16 v[76:77], v20 offset:26624
    buffer_load_dwordx4 v12, s[16:19], s57 offen offset:1024  lds
    v_mfma_f32_32x32x16_bf16 v[240:255], v[88:91], a[60:63], v[240:255]
    ds_read_b64_tr_b16 v[78:79], v20 offset:27136
    s_waitcnt lgkmcnt(6)
    v_add_f32 v120, v120, v124
    v_add_f32 v121, v121, v125
    v_add_f32 v122, v122, v126
    v_add_f32 v123, v123, v127
    s_waitcnt lgkmcnt(5)
    v_add_f32_e64 v144, v144, v145
    v_mfma_f32_32x32x16_bf16 v[160:175], v[92:95], a[120:123], v[160:175]
    buffer_store_dwordx4 v[120:123], v35, s[32:35], s71 offen sc1
    v_mfma_f32_32x32x16_bf16 v[176:191], v[92:95], a[124:127], v[176:191]
    s_add_u32 m0, s60, 8192
    s_nop 0
    buffer_load_dwordx4 v11, s[20:23], s57 offen offset:0  lds
    s_mov_b32 exec_hi, 0
    buffer_store_dword v144, v36, s[32:35], s72 offen sc1
    s_mov_b32 exec_hi, -1
    s_waitcnt lgkmcnt(0)
    v_mfma_f32_32x32x16_bf16 v[160:175], v[64:67], a[128:131], v[160:175]
    ds_read_b64_tr_b16 v[80:81], v20 offset:28672
    ds_read_b64_tr_b16 v[82:83], v20 offset:29184
    v_mfma_f32_32x32x16_bf16 v[176:191], v[64:67], a[132:135], v[176:191]
    ds_read_b64_tr_b16 v[84:85], v16 offset:34816
    v_mfma_f32_32x32x16_bf16 v[192:207], v[68:71], a[64:67], v[192:207]
    ds_read_b64_tr_b16 v[86:87], v16 offset:35328
    buffer_load_dwordx4 v13, s[20:23], s57 offen offset:1024  lds
    v_mfma_f32_32x32x16_bf16 v[208:223], v[68:71], a[68:71], v[208:223]
    ds_read_b64_tr_b16 v[88:89], v17 offset:34816
    ds_read_b64_tr_b16 v[90:91], v17 offset:35328
    v_mfma_f32_32x32x16_bf16 v[224:239], v[72:75], a[64:67], v[224:239]
    s_lshl4_add_u32 s57, s95, 0
    ds_read_b64_tr_b16 v[92:93], v20 offset:30720
    v_mfma_f32_32x32x16_bf16 v[240:255], v[72:75], a[68:71], v[240:255]
    s_add_u32 m0, s60, 131072
    ds_read_b64_tr_b16 v[94:95], v20 offset:31232
    buffer_load_dwordx4 v22, s[24:27], s57 offen offset:0  lds
    v_mfma_f32_32x32x16_bf16 v[160:175], v[76:79], a[136:139], v[160:175]
    v_mfma_f32_32x32x16_bf16 v[176:191], v[76:79], a[140:143], v[176:191]
    s_waitcnt lgkmcnt(0)
    v_mfma_f32_32x32x16_bf16 v[160:175], v[80:83], a[144:147], v[160:175]
    ds_read_b64_tr_b16 v[64:65], v20 offset:49152
    ds_read_b64_tr_b16 v[66:67], v20 offset:49664
    buffer_load_dwordx4 v24, s[24:27], s57 offen offset:1024  lds
    v_mfma_f32_32x32x16_bf16 v[176:191], v[80:83], a[148:151], v[176:191]
    ds_read_b64_tr_b16 v[68:69], v16 offset:36864
    v_mfma_f32_32x32x16_bf16 v[192:207], v[84:87], a[72:75], v[192:207]
    s_lshl4_add_u32 s57, s96, 0
    ds_read_b64_tr_b16 v[70:71], v16 offset:37376
    v_mfma_f32_32x32x16_bf16 v[208:223], v[84:87], a[76:79], v[208:223]
    s_add_u32 m0, s60, 90112
    ds_read_b64_tr_b16 v[72:73], v17 offset:36864
    ds_read_b64_tr_b16 v[74:75], v17 offset:37376
    buffer_load_dwordx4 v22, s[24:27], s57 offen offset:0  lds
    v_mfma_f32_32x32x16_bf16 v[224:239], v[88:91], a[72:75], v[224:239]
    ds_read_b64_tr_b16 v[76:77], v20 offset:51200
    v_mfma_f32_32x32x16_bf16 v[240:255], v[88:91], a[76:79], v[240:255]
    ds_read_b64_tr_b16 v[78:79], v20 offset:51712
    v_mfma_f32_32x32x16_bf16 v[160:175], v[92:95], a[152:155], v[160:175]
    buffer_load_dwordx4 v24, s[24:27], s57 offen offset:1024  lds
    v_mfma_f32_32x32x16_bf16 v[176:191], v[92:95], a[156:159], v[176:191]
    s_waitcnt lgkmcnt(0)
    v_mfma_f32_32x32x16_bf16 v[160:175], v[64:67], a[160:163], v[160:175]
    s_lshl4_add_u32 s57, s97, 0
    ds_read_b64_tr_b16 v[80:81], v20 offset:53248
    ds_read_b64_tr_b16 v[82:83], v20 offset:53760
    v_mfma_f32_32x32x16_bf16 v[176:191], v[64:67], a[164:167], v[176:191]
    s_add_u32 m0, s60, 16384
    ds_read_b64_tr_b16 v[84:85], v16 offset:38912
    buffer_load_dwordx4 v22, s[24:27], s57 offen offset:0  lds
    v_mfma_f32_32x32x16_bf16 v[192:207], v[68:71], a[80:83], v[192:207]
    ds_read_b64_tr_b16 v[86:87], v16 offset:39424
    v_mfma_f32_32x32x16_bf16 v[208:223], v[68:71], a[84:87], v[208:223]
    ds_read_b64_tr_b16 v[88:89], v17 offset:38912
    ds_read_b64_tr_b16 v[90:91], v17 offset:39424
    v_mfma_f32_32x32x16_bf16 v[224:239], v[72:75], a[80:83], v[224:239]
    ds_read_b64_tr_b16 v[92:93], v20 offset:55296
    buffer_load_dwordx4 v24, s[24:27], s57 offen offset:1024  lds
    v_mfma_f32_32x32x16_bf16 v[240:255], v[72:75], a[84:87], v[240:255]
    ds_read_b64_tr_b16 v[94:95], v20 offset:55808
    v_mfma_f32_32x32x16_bf16 v[160:175], v[76:79], a[168:171], v[160:175]
    v_mfma_f32_32x32x16_bf16 v[176:191], v[76:79], a[172:175], v[176:191]
    s_waitcnt lgkmcnt(0)
    v_mfma_f32_32x32x16_bf16 v[160:175], v[80:83], a[176:179], v[160:175]
    s_waitcnt vmcnt(14)
    s_barrier
    ds_read_b64_tr_b16 v[64:65], v40 offset:16384
    ds_read_b64_tr_b16 v[66:67], v40 offset:16896
    v_mfma_f32_32x32x16_bf16 v[176:191], v[80:83], a[180:183], v[176:191]
    s_mov_b32 s57, 1149440
    s_add_u32 m0, s60, 32768
    ds_read_b64_tr_b16 v[68:69], v42 offset:0
    buffer_load_dwordx4 v10, s[16:19], s57 offen offset:0  lds
    v_mfma_f32_32x32x16_bf16 v[192:207], v[84:87], a[88:91], v[192:207]
    ds_read_b64_tr_b16 v[70:71], v42 offset:512
    s_waitcnt vmcnt(8)
    s_mov_b64 exec, 1
    buffer_store_dword v55, off, s[32:35], s70 offset:0 sc1
    s_mov_b64 exec, -1
    v_mfma_f32_32x32x16_bf16 v[208:223], v[84:87], a[92:95], v[208:223]
    ds_read_b64_tr_b16 v[72:73], v43 offset:0
    ds_read_b64_tr_b16 v[74:75], v43 offset:512
    v_mbcnt_lo_u32_b32 v110, -1, 0
    v_mbcnt_hi_u32_b32 v110, -1, v110
    v_lshrrev_b32 v108, 2, v110
    v_and_b32_e64 v109, 3, v110
    v_mfma_f32_32x32x16_bf16 v[224:239], v[88:91], a[88:91], v[224:239]
    ds_read_b64_tr_b16 v[76:77], v40 offset:18432
    buffer_load_dwordx4 v12, s[16:19], s57 offen offset:1024  lds
    v_lshlrev_b32_e64 v109, 4, v109
    v_lshl_add_u32 v109, v108, 10, v109
    v_mfma_f32_32x32x16_bf16 v[240:255], v[88:91], a[92:95], v[240:255]
    ds_read_b64_tr_b16 v[78:79], v40 offset:18944
    v_lshlrev_b32 v108, 7, v108
    v_lshlrev_b32 v110, 4, v110
    v_mfma_f32_32x32x16_bf16 v[160:175], v[92:95], a[184:187], v[160:175]
    v_mfma_f32_32x32x16_bf16 v[176:191], v[92:95], a[188:191], v[176:191]
    s_add_u32 m0, s60, 40960
    s_nop 0
    buffer_load_dwordx4 v11, s[20:23], s57 offen offset:0  lds
    s_waitcnt lgkmcnt(0)
    v_mfma_f32_32x32x16_bf16 v[160:175], v[64:67], a[192:195], v[160:175]
    ds_read_b64_tr_b16 v[80:81], v40 offset:20480
    ds_read_b64_tr_b16 v[82:83], v40 offset:20992
    v_mfma_f32_32x32x16_bf16 v[176:191], v[64:67], a[196:199], v[176:191]
    ds_read_b64_tr_b16 v[84:85], v42 offset:2048
    v_mfma_f32_32x32x16_bf16 v[192:207], v[68:71], a[96:99], v[192:207]
    ds_read_b64_tr_b16 v[86:87], v42 offset:2560
    buffer_load_dwordx4 v13, s[20:23], s57 offen offset:1024  lds
    v_mfma_f32_32x32x16_bf16 v[208:223], v[68:71], a[100:103], v[208:223]
    ds_read_b64_tr_b16 v[88:89], v43 offset:2048
    ds_read_b64_tr_b16 v[90:91], v43 offset:2560
    v_mfma_f32_32x32x16_bf16 v[224:239], v[72:75], a[96:99], v[224:239]
    s_lshl4_add_u32 s57, s98, 0
    ds_read_b64_tr_b16 v[92:93], v40 offset:22528
    v_mfma_f32_32x32x16_bf16 v[240:255], v[72:75], a[100:103], v[240:255]
L_islA3:
    s_cbranch_execz L_retA
    s_add_u32 m0, s60, 49152
    ds_read_b64_tr_b16 v[94:95], v40 offset:23040
    buffer_load_dwordx4 v22, s[24:27], s57 offen offset:0  lds
    v_mfma_f32_32x32x16_bf16 v[160:175], v[76:79], a[200:203], v[160:175]
    v_mfma_f32_32x32x16_bf16 v[176:191], v[76:79], a[204:207], v[176:191]
    s_waitcnt lgkmcnt(0)
    v_mfma_f32_32x32x16_bf16 v[160:175], v[80:83], a[208:211], v[160:175]
    ds_read_b64_tr_b16 v[64:65], v41 offset:16384
    ds_read_b64_tr_b16 v[66:67], v41 offset:16896
    buffer_load_dwordx4 v24, s[24:27], s57 offen offset:1024  lds
    v_mfma_f32_32x32x16_bf16 v[176:191], v[80:83], a[212:215], v[176:191]
    ds_read_b64_tr_b16 v[68:69], v42 offset:4096
    v_mfma_f32_32x32x16_bf16 v[192:207], v[84:87], a[104:107], v[192:207]
    s_lshl4_add_u32 s57, s99, 0
    ds_read_b64_tr_b16 v[70:71], v42 offset:4608
    v_mfma_f32_32x32x16_bf16 v[208:223], v[84:87], a[108:111], v[208:223]
    s_add_u32 m0, s60, 24576
    ds_read_b64_tr_b16 v[72:73], v43 offset:4096
    ds_read_b64_tr_b16 v[74:75], v43 offset:4608
    buffer_load_dwordx4 v22, s[24:27], s57 offen offset:0  lds
    v_mfma_f32_32x32x16_bf16 v[224:239], v[88:91], a[104:107], v[224:239]
    ds_read_b64_tr_b16 v[76:77], v41 offset:18432
    v_mfma_f32_32x32x16_bf16 v[240:255], v[88:91], a[108:111], v[240:255]
    ds_read_b64_tr_b16 v[78:79], v41 offset:18944
    v_mfma_f32_32x32x16_bf16 v[160:175], v[92:95], a[216:219], v[160:175]
    buffer_load_dwordx4 v24, s[24:27], s57 offen offset:1024  lds
    v_mfma_f32_32x32x16_bf16 v[176:191], v[92:95], a[220:223], v[176:191]
    s_waitcnt lgkmcnt(0)
    v_mfma_f32_32x32x16_bf16 v[160:175], v[64:67], a[224:227], v[160:175]
    s_lshl4_add_u32 s57, s100, 0
    ds_read_b64_tr_b16 v[80:81], v41 offset:20480
    ds_read_b64_tr_b16 v[82:83], v41 offset:20992
    v_mfma_f32_32x32x16_bf16 v[176:191], v[64:67], a[228:231], v[176:191]
    s_add_u32 m0, s60, 122880
    ds_read_b64_tr_b16 v[84:85], v42 offset:6144
    buffer_load_dwordx4 v22, s[24:27], s57 offen offset:0  lds
    v_mfma_f32_32x32x16_bf16 v[192:207], v[68:71], a[112:115], v[192:207]
    ds_read_b64_tr_b16 v[86:87], v42 offset:6656
    v_mfma_f32_32x32x16_bf16 v[208:223], v[68:71], a[116:119], v[208:223]
    ds_read_b64_tr_b16 v[88:89], v43 offset:6144
    ds_read_b64_tr_b16 v[90:91], v43 offset:6656
    v_mfma_f32_32x32x16_bf16 v[224:239], v[72:75], a[112:115], v[224:239]
    ds_read_b64_tr_b16 v[92:93], v41 offset:22528
    buffer_load_dwordx4 v24, s[24:27], s57 offen offset:1024  lds
    v_mfma_f32_32x32x16_bf16 v[240:255], v[72:75], a[116:119], v[240:255]
    ds_read_b64_tr_b16 v[94:95], v41 offset:23040
    v_mfma_f32_32x32x16_bf16 v[160:175], v[76:79], a[232:235], v[160:175]
    v_mfma_f32_32x32x16_bf16 v[176:191], v[76:79], a[236:239], v[176:191]
    s_waitcnt lgkmcnt(0)
    v_mfma_f32_32x32x16_bf16 v[160:175], v[80:83], a[240:243], v[160:175]
    s_waitcnt vmcnt(17)
    s_barrier
    ds_read_b64_tr_b16 v[64:65], v16 offset:0
    ds_read_b64_tr_b16 v[66:67], v16 offset:512
    v_mfma_f32_32x32x16_bf16 v[176:191], v[80:83], a[244:247], v[176:191]
    s_mov_b32 s57, 1378816
    s_add_u32 m0, s60, 65536
    ds_read_b64_tr_b16 v[68:69], v17 offset:0
    buffer_load_dwordx4 v10, s[16:19], s57 offen offset:0  lds
    v_mfma_f32_32x32x16_bf16 v[192:207], v[84:87], a[120:123], v[192:207]
    ds_read_b64_tr_b16 v[70:71], v17 offset:512
    buffer_load_dwordx4 v12, s[16:19], s57 offen offset:1024  lds
    v_mfma_f32_32x32x16_bf16 v[208:223], v[84:87], a[124:127], v[208:223]
    ds_read_b64_tr_b16 v[72:73], v16 offset:2048
    ds_read_b64_tr_b16 v[74:75], v16 offset:2560
    v_mfma_f32_32x32x16_bf16 v[224:239], v[88:91], a[120:123], v[224:239]
    s_add_u32 m0, s60, 73728
    ds_read_b64_tr_b16 v[76:77], v17 offset:2048
    buffer_load_dwordx4 v11, s[20:23], s57 offen offset:0  lds
    v_mfma_f32_32x32x16_bf16 v[240:255], v[88:91], a[124:127], v[240:255]
    ds_read_b64_tr_b16 v[78:79], v17 offset:2560
    v_mfma_f32_32x32x16_bf16 v[160:175], v[92:95], a[248:251], v[160:175]
    buffer_load_dwordx4 v13, s[20:23], s57 offen offset:1024  lds
    v_mfma_f32_32x32x16_bf16 v[176:191], v[92:95], a[252:255], v[176:191]
    s_lshl4_add_u32 s57, s93, 1310720
    s_waitcnt lgkmcnt(0)
    v_mfma_f32_32x32x16_bf16 v[192:207], v[64:67], a[128:131], v[192:207]
    s_add_u32 m0, s60, 147456
    ds_read_b64_tr_b16 v[80:81], v16 offset:4096
    ds_read_b64_tr_b16 v[82:83], v16 offset:4608
    buffer_load_dwordx4 v22, s[24:27], s57 offen offset:0  lds
    buffer_load_dword v44, v34, s[32:35], 0 offen offset:0 sc1
    v_mfma_f32_32x32x16_bf16 v[208:223], v[64:67], a[132:135], v[208:223]
    ds_read_b64_tr_b16 v[84:85], v17 offset:4096
    v_mfma_f32_32x32x16_bf16 v[224:239], v[68:71], a[128:131], v[224:239]
    ds_read_b64_tr_b16 v[86:87], v17 offset:4608
    buffer_load_dwordx4 v24, s[24:27], s57 offen offset:1024  lds
    v_mul_f32 v2, 0x3fb8aa3b, v160
    v_mul_f32 v3, 0x3fb8aa3b, v161
    v_mfma_f32_32x32x16_bf16 v[240:255], v[68:71], a[132:135], v[240:255]
    s_lshl4_add_u32 s57, s94, 1310720
    ds_read_b64_tr_b16 v[88:89], v16 offset:6144
    ds_read_b64_tr_b16 v[90:91], v16 offset:6656
    v_mul_f32 v4, 0x3fb8aa3b, v162
    v_mul_f32 v5, 0x3fb8aa3b, v163
    v_exp_f32_e64 v2, v2 clamp
    v_mfma_f32_32x32x16_bf16 v[192:207], v[72:75], a[136:139], v[192:207]
    s_add_u32 m0, s60, 114688
    ds_read_b64_tr_b16 v[92:93], v17 offset:6144
    buffer_load_dwordx4 v22, s[24:27], s57 offen offset:0  lds
    v_exp_f32_e64 v3, v3 clamp
    v_mfma_f32_32x32x16_bf16 v[208:223], v[72:75], a[140:143], v[208:223]
    ds_read_b64_tr_b16 v[94:95], v17 offset:6656
    v_exp_f32_e64 v4, v4 clamp
    v_exp_f32_e64 v5, v5 clamp
    v_max_f32 v160, 0x358637bd, v160
    v_mfma_f32_32x32x16_bf16 v[224:239], v[76:79], a[136:139], v[224:239]
    buffer_load_dwordx4 v24, s[24:27], s57 offen offset:1024  lds
    v_max_f32 v161, 0x358637bd, v161
    v_max_f32 v162, 0x358637bd, v162
    v_max_f32 v163, 0x358637bd, v163
    v_mfma_f32_32x32x16_bf16 v[240:255], v[76:79], a[140:143], v[240:255]
    v_add_f32 v2, v2, v160
    v_add_f32 v3, v3, v161
    v_add_f32 v4, v4, v162
    v_add_f32 v5, v5, v163
    v_cvt_pk_bf16_f32 v160, v2, v3
    v_cvt_pk_bf16_f32 v161, v4, v5
    s_waitcnt lgkmcnt(0)
    v_mfma_f32_32x32x16_bf16 v[192:207], v[80:83], a[144:147], v[192:207]
    s_waitcnt vmcnt(15)
    s_barrier
    ds_read_b64_tr_b16 v[64:65], v16 offset:32768
    ds_read_b64_tr_b16 v[66:67], v16 offset:33280
    v_mul_f32 v2, 0x3fb8aa3b, v164
    v_mul_f32 v3, 0x3fb8aa3b, v165
    v_mfma_f32_32x32x16_bf16 v[208:223], v[80:83], a[148:151], v[208:223]
    s_mov_b32 s57, 1608192
    s_add_u32 m0, s60, 0
    ds_read_b64_tr_b16 v[68:69], v17 offset:32768
    buffer_load_dwordx4 v10, s[16:19], s57 offen offset:0  lds
    v_mul_f32 v4, 0x3fb8aa3b, v166
    v_mfma_f32_32x32x16_bf16 v[224:239], v[84:87], a[144:147], v[224:239]
    ds_read_b64_tr_b16 v[70:71], v17 offset:33280
    buffer_load_dwordx4 v12, s[16:19], s57 offen offset:1024  lds
    v_mul_f32 v5, 0x3fb8aa3b, v167
    v_mfma_f32_32x32x16_bf16 v[240:255], v[84:87], a[148:151], v[240:255]
    ds_read_b64_tr_b16 v[72:73], v16 offset:34816
    ds_read_b64_tr_b16 v[74:75], v16 offset:35328
    v_exp_f32_e64 v2, v2 clamp
    v_exp_f32_e64 v3, v3 clamp
    v_mfma_f32_32x32x16_bf16 v[192:207], v[88:91], a[152:155], v[192:207]
    s_add_u32 m0, s60, 8192
    ds_read_b64_tr_b16 v[76:77], v17 offset:34816
    buffer_load_dwordx4 v11, s[20:23], s57 offen offset:0  lds
    v_exp_f32_e64 v4, v4 clamp
    v_mfma_f32_32x32x16_bf16 v[208:223], v[88:91], a[156:159], v[208:223]
    ds_read_b64_tr_b16 v[78:79], v17 offset:35328
    v_exp_f32_e64 v5, v5 clamp
    v_max_f32 v164, 0x358637bd, v164
    v_max_f32 v165, 0x358637bd, v165
    v_max_f32 v166, 0x358637bd, v166
    v_mfma_f32_32x32x16_bf16 v[224:239], v[92:95], a[152:155], v[224:239]
    buffer_load_dwordx4 v13, s[20:23], s57 offen offset:1024  lds
    v_max_f32 v167, 0x358637bd, v167
    v_add_f32 v2, v2, v164
    v_add_f32 v3, v3, v165
    v_mfma_f32_32x32x16_bf16 v[240:255], v[92:95], a[156:159], v[240:255]
    s_lshl4_add_u32 s57, s95, 1310720
    v_add_f32 v4, v4, v166
    v_add_f32 v5, v5, v167
    v_cvt_pk_bf16_f32 v162, v2, v3
    v_cvt_pk_bf16_f32 v163, v4, v5
    v_mul_f32 v2, 0x3fb8aa3b, v168
    v_mul_f32 v3, 0x3fb8aa3b, v169
    s_waitcnt lgkmcnt(0)
    v_mfma_f32_32x32x16_bf16 v[192:207], v[64:67], a[160:163], v[192:207]
    s_add_u32 m0, s60, 81920
    ds_read_b64_tr_b16 v[80:81], v16 offset:36864
    ds_read_b64_tr_b16 v[82:83], v16 offset:37376
    buffer_load_dwordx4 v22, s[24:27], s57 offen offset:0  lds
    v_mul_f32 v4, 0x3fb8aa3b, v170
    v_mfma_f32_32x32x16_bf16 v[208:223], v[64:67], a[164:167], v[208:223]
    ds_read_b64_tr_b16 v[84:85], v17 offset:36864
    v_mul_f32 v5, 0x3fb8aa3b, v171
    v_exp_f32_e64 v2, v2 clamp
    v_exp_f32_e64 v3, v3 clamp
    v_mfma_f32_32x32x16_bf16 v[224:239], v[68:71], a[160:163], v[224:239]
    ds_read_b64_tr_b16 v[86:87], v17 offset:37376
    buffer_load_dwordx4 v24, s[24:27], s57 offen offset:1024  lds
    v_exp_f32_e64 v4, v4 clamp
    v_mfma_f32_32x32x16_bf16 v[240:255], v[68:71], a[164:167], v[240:255]
    s_nop 0
    s_lshl4_add_u32 s57, s96, 1310720
    ds_read_b64_tr_b16 v[88:89], v16 offset:38912
    ds_read_b64_tr_b16 v[90:91], v16 offset:39424
    v_exp_f32_e64 v5, v5 clamp
    v_max_f32 v168, 0x358637bd, v168
    v_max_f32 v169, 0x358637bd, v169
    v_mfma_f32_32x32x16_bf16 v[192:207], v[72:75], a[168:171], v[192:207]
    s_add_u32 m0, s60, 106496
    ds_read_b64_tr_b16 v[92:93], v17 offset:38912
    buffer_load_dwordx4 v22, s[24:27], s57 offen offset:0  lds
    v_max_f32 v170, 0x358637bd, v170
    v_max_f32 v171, 0x358637bd, v171
    v_mfma_f32_32x32x16_bf16 v[208:223], v[72:75], a[172:175], v[208:223]
    ds_read_b64_tr_b16 v[94:95], v17 offset:39424
    v_add_f32 v2, v2, v168
    v_add_f32 v3, v3, v169
    v_add_f32 v4, v4, v170
    v_add_f32 v5, v5, v171
    v_cvt_pk_bf16_f32 v164, v2, v3
    v_mfma_f32_32x32x16_bf16 v[224:239], v[76:79], a[168:171], v[224:239]
    buffer_load_dwordx4 v24, s[24:27], s57 offen offset:1024  lds
    v_cvt_pk_bf16_f32 v165, v4, v5
    v_mul_f32 v2, 0x3fb8aa3b, v172
    v_mul_f32 v3, 0x3fb8aa3b, v173
    v_mfma_f32_32x32x16_bf16 v[240:255], v[76:79], a[172:175], v[240:255]
    v_mul_f32 v4, 0x3fb8aa3b, v174
    v_mul_f32 v5, 0x3fb8aa3b, v175
    v_exp_f32_e64 v2, v2 clamp
    v_exp_f32_e64 v3, v3 clamp
    s_waitcnt lgkmcnt(0)
    v_mfma_f32_32x32x16_bf16 v[192:207], v[80:83], a[176:179], v[192:207]
    s_waitcnt vmcnt(13)
    s_barrier
    ds_read_b64_tr_b16 v[64:65], v42 offset:0
    ds_read_b64_tr_b16 v[66:67], v42 offset:512
    s_waitcnt vmcnt(11)
    v_cmp_ne_u32 vcc, s49, v44
    s_cbranch_vccnz L_A_again_10
L_A_ok_9:
    v_mfma_f32_32x32x16_bf16 v[208:223], v[80:83], a[180:183], v[208:223]
    s_lshl4_add_u32 s57, s97, 1310720
    s_add_u32 m0, s60, 98304
    ds_read_b64_tr_b16 v[68:69], v43 offset:0
    buffer_load_dwordx4 v22, s[24:27], s57 offen offset:0  lds
    buffer_load_dwordx4 v[96:99], v109, s[32:35], s55 offen sc1
    v_mfma_f32_32x32x16_bf16 v[224:239], v[84:87], a[176:179], v[224:239]
    ds_read_b64_tr_b16 v[70:71], v43 offset:512
    buffer_load_dword v100, v108, s[32:35], s56 offen sc1
    v_exp_f32_e64 v4, v4 clamp
    v_mfma_f32_32x32x16_bf16 v[240:255], v[84:87], a[180:183], v[240:255]
    ds_read_b64_tr_b16 v[72:73], v42 offset:2048
    ds_read_b64_tr_b16 v[74:75], v42 offset:2560
    buffer_load_dwordx4 v24, s[24:27], s57 offen offset:1024  lds
    v_mfma_f32_32x32x16_bf16 v[192:207], v[88:91], a[184:187], v[192:207]
    ds_read_b64_tr_b16 v[76:77], v43 offset:2048
    v_exp_f32_e64 v5, v5 clamp
    v_max_f32 v172, 0x358637bd, v172
    v_max_f32 v173, 0x358637bd, v173
    v_max_f32 v174, 0x358637bd, v174
    v_mfma_f32_32x32x16_bf16 v[208:223], v[88:91], a[188:191], v[208:223]
    s_lshl4_add_u32 s57, s98, 1310720
    ds_read_b64_tr_b16 v[78:79], v43 offset:2560
    v_max_f32 v175, 0x358637bd, v175
    v_add_f32 v2, v2, v172
    v_add_f32 v3, v3, v173
    v_add_f32 v4, v4, v174
    v_add_f32 v5, v5, v175
    v_mfma_f32_32x32x16_bf16 v[224:239], v[92:95], a[184:187], v[224:239]
    s_add_u32 m0, s60, 40960
    s_nop 0
    buffer_load_dwordx4 v22, s[24:27], s57 offen offset:0  lds
    v_cvt_pk_bf16_f32 v166, v2, v3
    v_cvt_pk_bf16_f32 v167, v4, v5
    v_mul_f32 v2, 0x3fb8aa3b, v176
    v_mfma_f32_32x32x16_bf16 v[240:255], v[92:95], a[188:191], v[240:255]
    v_mul_f32 v3, 0x3fb8aa3b, v177
    v_mul_f32 v4, 0x3fb8aa3b, v178
    v_mul_f32 v5, 0x3fb8aa3b, v179
    v_exp_f32_e64 v2, v2 clamp
    s_waitcnt lgkmcnt(0)
    v_mfma_f32_32x32x16_bf16 v[192:207], v[64:67], a[192:195], v[192:207]
    ds_read_b64_tr_b16 v[80:81], v42 offset:4096
    ds_read_b64_tr_b16 v[82:83], v42 offset:4608
    buffer_load_dwordx4 v24, s[24:27], s57 offen offset:1024  lds
    v_mfma_f32_32x32x16_bf16 v[208:223], v[64:67], a[196:199], v[208:223]
    ds_read_b64_tr_b16 v[84:85], v43 offset:4096
    v_exp_f32_e64 v3, v3 clamp
    v_exp_f32_e64 v4, v4 clamp
    v_mfma_f32_32x32x16_bf16 v[224:239], v[68:71], a[192:195], v[224:239]
    s_lshl4_add_u32 s57, s99, 1310720
    ds_read_b64_tr_b16 v[86:87], v43 offset:4608
    v_exp_f32_e64 v5, v5 clamp
    v_max_f32 v176, 0x358637bd, v176
    v_max_f32 v177, 0x358637bd, v177
    v_max_f32 v178, 0x358637bd, v178
    v_mfma_f32_32x32x16_bf16 v[240:255], v[68:71], a[196:199], v[240:255]
    s_add_u32 m0, s60, 32768
    ds_read_b64_tr_b16 v[88:89], v42 offset:6144
    ds_read_b64_tr_b16 v[90:91], v42 offset:6656
    buffer_load_dwordx4 v22, s[24:27], s57 offen offset:0  lds
    v_max_f32 v179, 0x358637bd, v179
    v_mfma_f32_32x32x16_bf16 v[192:207], v[72:75], a[200:203], v[192:207]
    ds_read_b64_tr_b16 v[92:93], v43 offset:6144
    v_add_f32 v2, v2, v176
    v_add_f32 v3, v3, v177
    v_add_f32 v4, v4, v178
    v_add_f32 v5, v5, v179
    v_cvt_pk_bf16_f32 v168, v2, v3
    v_mfma_f32_32x32x16_bf16 v[208:223], v[72:75], a[204:207], v[208:223]
    ds_read_b64_tr_b16 v[94:95], v43 offset:6656
    buffer_load_dwordx4 v24, s[24:27], s57 offen offset:1024  lds
    v_cvt_pk_bf16_f32 v169, v4, v5
    v_mul_f32 v2, 0x3fb8aa3b, v180
    v_mfma_f32_32x32x16_bf16 v[224:239], v[76:79], a[200:203], v[224:239]
    v_mul_f32 v3, 0x3fb8aa3b, v181
    v_mul_f32 v4, 0x3fb8aa3b, v182
    v_mul_f32 v5, 0x3fb8aa3b, v183
    v_exp_f32_e64 v2, v2 clamp
    v_mfma_f32_32x32x16_bf16 v[240:255], v[76:79], a[204:207], v[240:255]
    v_exp_f32_e64 v3, v3 clamp
    v_exp_f32_e64 v4, v4 clamp
    v_exp_f32_e64 v5, v5 clamp
    s_waitcnt lgkmcnt(0)
    v_mfma_f32_32x32x16_bf16 v[192:207], v[80:83], a[208:211], v[192:207]
    s_waitcnt vmcnt(12)
    s_barrier
    ds_read_b64_tr_b16 v[64:65], v16 offset:0
    ds_read_b64_tr_b16 v[66:67], v16 offset:512
    v_max_f32 v180, 0x358637bd, v180
    v_max_f32 v181, 0x358637bd, v181
    v_mfma_f32_32x32x16_bf16 v[208:223], v[80:83], a[212:215], v[208:223]
    s_lshl4_add_u32 s57, s100, 1310720
    s_add_u32 m0, s60, 73728
    ds_read_b64_tr_b16 v[68:69], v17 offset:0
    buffer_load_dwordx4 v22, s[24:27], s57 offen offset:0  lds
    v_max_f32 v182, 0x358637bd, v182
    v_mfma_f32_32x32x16_bf16 v[224:239], v[84:87], a[208:211], v[224:239]
    ds_read_b64_tr_b16 v[70:71], v17 offset:512
    v_max_f32 v183, 0x358637bd, v183
    v_add_f32 v2, v2, v180
    v_add_f32 v3, v3, v181
    v_add_f32 v4, v4, v182
    v_add_f32_e64 v5, v5, v183
    v_mfma_f32_32x32x16_bf16 v[240:255], v[84:87], a[212:215], v[240:255]
    ds_read_b64_tr_b16 v[72:73], v16 offset:2048
    ds_read_b64_tr_b16 v[74:75], v16 offset:2560
    v_cvt_pk_bf16_f32 v170, v2, v3
    v_cvt_pk_bf16_f32 v171, v4, v5
    v_mul_f32 v2, 0x3fb8aa3b, v184
    v_mul_f32 v3, 0x3fb8aa3b, v185
    v_mfma_f32_32x32x16_bf16 v[192:207], v[88:91], a[216:219], v[192:207]
    ds_read_b64_tr_b16 v[76:77], v17 offset:2048
    buffer_load_dwordx4 v24, s[24:27], s57 offen offset:1024  lds
    v_mul_f32 v4, 0x3fb8aa3b, v186
    v_mul_f32 v5, 0x3fb8aa3b, v187
    v_mfma_f32_32x32x16_bf16 v[208:223], v[88:91], a[220:223], v[208:223]
    ds_read_b64_tr_b16 v[78:79], v17 offset:2560
    v_exp_f32_e64 v2, v2 clamp
    v_exp_f32_e64 v3, v3 clamp
    v_mfma_f32_32x32x16_bf16 v[224:239], v[92:95], a[216:219], v[224:239]
    v_exp_f32_e64 v4, v4 clamp
    v_exp_f32_e64 v5, v5 clamp
    v_max_f32 v184, 0x358637bd, v184
    v_max_f32 v185, 0x358637bd, v185
    v_mfma_f32_32x32x16_bf16 v[240:255], v[92:95], a[220:223], v[240:255]
    s_lshl4_add_u32 s57, s93, 786432
    v_max_f32 v186, 0x358637bd, v186
    v_max_f32 v187, 0x358637bd, v187
    v_add_f32 v2, v2, v184
    v_add_f32 v3, v3, v185
    v_add_f32 v4, v4, v186
    v_add_f32 v5, v5, v187
    s_waitcnt lgkmcnt(0)
    v_mfma_f32_32x32x16_bf16 v[192:207], v[64:67], a[224:227], v[192:207]
    s_add_u32 m0, s60, 65536
    ds_read_b64_tr_b16 v[80:81], v16 offset:4096
    ds_read_b64_tr_b16 v[82:83], v16 offset:4608
    buffer_load_dwordx4 v22, s[24:27], s57 offen offset:0  lds
    v_cvt_pk_bf16_f32 v172, v2, v3
    v_mfma_f32_32x32x16_bf16 v[208:223], v[64:67], a[228:231], v[208:223]
    s_nop 0
    ds_read_b64_tr_b16 v[84:85], v17 offset:4096
    v_cvt_pk_bf16_f32 v173, v4, v5
    v_mul_f32 v2, 0x3fb8aa3b, v188
    v_mul_f32 v3, 0x3fb8aa3b, v189
    v_mul_f32 v4, 0x3fb8aa3b, v190
    v_mul_f32 v5, 0x3fb8aa3b, v191
    v_mfma_f32_32x32x16_bf16 v[224:239], v[68:71], a[224:227], v[224:239]
    ds_read_b64_tr_b16 v[86:87], v17 offset:4608
    buffer_load_dword v45, v31, s[32:35], 0 offen offset:0 sc1
    s_waitcnt vmcnt(10)
    v_add_f32_dpp v96, v96, v96 row_ror:4 row_mask:0xf bank_mask:0xf
    v_add_f32_dpp v97, v97, v97 row_ror:4 row_mask:0xf bank_mask:0xf
    v_add_f32_dpp v98, v98, v98 row_ror:4 row_mask:0xf bank_mask:0xf
    v_add_f32_dpp v99, v99, v99 row_ror:4 row_mask:0xf bank_mask:0xf
    s_waitcnt vmcnt(9)
    v_add_f32_dpp v100, v100, v100 row_ror:4 row_mask:0xf bank_mask:0xf
    v_mfma_f32_32x32x16_bf16 v[240:255], v[68:71], a[228:231], v[240:255]
    ds_read_b64_tr_b16 v[88:89], v16 offset:6144
    ds_read_b64_tr_b16 v[90:91], v16 offset:6656
    v_add_f32_dpp v96, v96, v96 row_ror:8 row_mask:0xf bank_mask:0xf
    v_add_f32_dpp v97, v97, v97 row_ror:8 row_mask:0xf bank_mask:0xf
    v_add_f32_dpp v98, v98, v98 row_ror:8 row_mask:0xf bank_mask:0xf
    v_add_f32_dpp v99, v99, v99 row_ror:8 row_mask:0xf bank_mask:0xf
    v_mfma_f32_32x32x16_bf16 v[192:207], v[72:75], a[232:235], v[192:207]
    ds_read_b64_tr_b16 v[92:93], v17 offset:6144
    buffer_load_dwordx4 v24, s[24:27], s57 offen offset:1024  lds
    v_add_f32_dpp v100, v100, v100 row_ror:8 row_mask:0xf bank_mask:0xf
    v_mov_b32_e64 v102, v96
    v_mfma_f32_32x32x16_bf16 v[208:223], v[72:75], a[236:239], v[208:223]
    ds_read_b64_tr_b16 v[94:95], v17 offset:6656
    v_mov_b32 v103, v97
    v_mov_b32 v104, v98
    v_mov_b32 v105, v99
    v_mov_b32 v106, v100
    v_permlane16_swap_b32 v96, v102
    v_mfma_f32_32x32x16_bf16 v[224:239], v[76:79], a[232:235], v[224:239]
    v_permlane16_swap_b32 v97, v103
    v_permlane16_swap_b32 v98, v104
    v_permlane16_swap_b32 v99, v105
    v_permlane16_swap_b32 v100, v106
    v_add_f32 v96, v96, v102
    v_add_f32_e64 v97, v97, v103
    v_mfma_f32_32x32x16_bf16 v[240:255], v[76:79], a[236:239], v[240:255]
    v_add_f32 v98, v98, v104
    v_add_f32 v99, v99, v105
    v_add_f32 v100, v100, v106
    v_mov_b32 v102, v96
    v_mov_b32 v103, v97
    v_mov_b32 v104, v98
    s_waitcnt lgkmcnt(0)
    v_mfma_f32_32x32x16_bf16 v[192:207], v[80:83], a[240:243], v[192:207]
    s_barrier
    v_mov_b32 v105, v99
    v_mov_b32 v106, v100
    v_permlane32_swap_b32 v96, v102
    v_permlane32_swap_b32 v97, v103
    v_mfma_f32_32x32x16_bf16 v[208:223], v[80:83], a[244:247], v[208:223]
    v_permlane32_swap_b32 v98, v104
    v_permlane32_swap_b32 v99, v105
    v_permlane32_swap_b32 v100, v106
    v_add_f32 v96, v96, v102
    v_add_f32 v97, v97, v103
    v_add_f32 v98, v98, v104
    v_mfma_f32_32x32x16_bf16 v[224:239], v[84:87], a[240:243], v[224:239]
    v_add_f32 v99, v99, v105
    v_add_f32 v100, v100, v106
    v_cvt_pk_bf16_f32 v96, v96, v97
    v_cvt_pk_bf16_f32 v97, v98, v99
    v_mov_b32 v98, v100
    v_mov_b32 v99, s49
    v_mfma_f32_32x32x16_bf16 v[240:255], v[84:87], a[244:247], v[240:255]
    s_lshl4_add_u32 s77, s45, s47
    s_lshl_b32 s77, s77, 6
    s_add_u32 s77, s77, s58
    s_mov_b64 exec, 15
    buffer_store_dwordx4 v[96:99], v109, s[32:35], s77 offen sc1
    s_mov_b64 exec, -1
    v_mfma_f32_32x32x16_bf16 v[192:207], v[88:91], a[248:251], v[192:207]
    v_exp_f32_e64 v2, v2 clamp
    v_exp_f32_e64 v3, v3 clamp
    v_exp_f32_e64 v4, v4 clamp
    v_mfma_f32_32x32x16_bf16 v[208:223], v[88:91], a[252:255], v[208:223]
    v_exp_f32_e64 v5, v5 clamp
    v_max_f32 v188, 0x358637bd, v188
    v_max_f32 v189, 0x358637bd, v189
    v_max_f32 v190, 0x358637bd, v190
    v_max_f32 v191, 0x358637bd, v191
    v_mfma_f32_32x32x16_bf16 v[224:239], v[92:95], a[248:251], v[224:239]
    v_add_f32 v2, v2, v188
    v_add_f32 v3, v3, v189
    v_add_f32 v4, v4, v190
    v_add_f32_e64 v5, v5, v191
    v_cvt_pk_bf16_f32 v174, v2, v3
    v_cvt_pk_bf16_f32 v175, v4, v5
    v_mfma_f32_32x32x16_bf16 v[240:255], v[92:95], a[252:255], v[240:255]
    v_pk_mul_f32 v[2:3], v[192:193], v[192:193]
    v_pk_mul_f32 v[4:5], v[194:195], v[194:195]
    v_pk_mul_f32 v[6:7], v[196:197], v[196:197]
    v_pk_mul_f32 v[8:9], v[198:199], v[198:199]
    v_pk_fma_f32 v[2:3], v[2:3], v[32:33], v[32:33] op_sel:[0,1,0] op_sel_hi:[1,1,0]
    v_pk_fma_f32 v[4:5], v[4:5], v[32:33], v[32:33] op_sel:[0,1,0] op_sel_hi:[1,1,0]
    v_pk_fma_f32 v[6:7], v[6:7], v[32:33], v[32:33] op_sel:[0,1,0] op_sel_hi:[1,1,0]
    v_pk_fma_f32 v[8:9], v[8:9], v[32:33], v[32:33] op_sel:[0,1,0] op_sel_hi:[1,1,0]
    v_pk_mul_f32 v[2:3], v[2:3], v[192:193]
    v_pk_mul_f32 v[4:5], v[4:5], v[194:195]
    v_pk_mul_f32 v[6:7], v[6:7], v[196:197]
    v_pk_mul_f32 v[8:9], v[8:9], v[198:199]
    v_exp_f32 v2, v2
    v_exp_f32 v3, v3
    s_waitcnt vmcnt(2)
    v_cmp_ne_u32 vcc, s49, v45
    s_cbranch_vccnz L_A_again_14
L_A_ok_13:
    s_add_u32 s73, s93, 0
    buffer_load_dwordx4 a[160:163], v27, s[32:35], s73 offen sc1
    v_exp_f32 v4, v4
    v_exp_f32 v5, v5
    v_exp_f32 v6, v6
    v_exp_f32 v7, v7
    v_exp_f32 v8, v8
    v_exp_f32 v9, v9
    v_pk_mul_f32 v[200:201], v[200:201], v[192:193]
    v_pk_mul_f32 v[202:203], v[202:203], v[194:195]
    buffer_load_dwordx4 a[164:167], v28, s[32:35], s73 offen sc1
    v_pk_mul_f32 v[204:205], v[204:205], v[196:197]
    v_pk_mul_f32 v[206:207], v[206:207], v[198:199]
    v_pk_fma_f32 v[2:3], v[2:3], v[46:47], v[46:47] op_sel:[0,1,1] op_sel_hi:[1,1,1]
    v_pk_fma_f32 v[4:5], v[4:5], v[46:47], v[46:47] op_sel:[0,1,1] op_sel_hi:[1,1,1]
    v_pk_fma_f32 v[6:7], v[6:7], v[46:47], v[46:47] op_sel:[0,1,1] op_sel_hi:[1,1,1]
    v_pk_fma_f32 v[8:9], v[8:9], v[46:47], v[46:47] op_sel:[0,1,1] op_sel_hi:[1,1,1]
    v_rcp_f32 v2, v2
    v_rcp_f32 v3, v3
    v_rcp_f32 v4, v4
    v_rcp_f32 v5, v5
    v_rcp_f32 v6, v6
    s_add_u32 s73, s94, 0
    buffer_load_dwordx4 a[168:171], v27, s[32:35], s73 offen sc1
    v_rcp_f32 v7, v7
    v_rcp_f32 v8, v8
    v_rcp_f32_e64 v9, v9
    v_pk_mul_f32 v[200:201], v[200:201], v[2:3]
    v_pk_mul_f32 v[202:203], v[202:203], v[4:5]
    v_pk_mul_f32 v[204:205], v[204:205], v[6:7]
    v_pk_mul_f32 v[206:207], v[206:207], v[8:9]
    v_cvt_pk_bf16_f32 v192, v200, v201
    v_cvt_pk_bf16_f32 v193, v202, v203
    v_cvt_pk_bf16_f32 v194, v204, v205
    v_cvt_pk_bf16_f32 v195, v206, v207
    buffer_load_dwordx4 a[172:175], v28, s[32:35], s73 offen sc1
    buffer_store_dwordx4 v[192:195], v29, s[32:35], s67 offen offset:0 sc1
    v_pk_mul_f32 v[2:3], v[208:209], v[208:209]
    v_pk_mul_f32 v[4:5], v[210:211], v[210:211]
    v_pk_mul_f32 v[6:7], v[212:213], v[212:213]
    v_pk_mul_f32 v[8:9], v[214:215], v[214:215]
    v_pk_fma_f32 v[2:3], v[2:3], v[32:33], v[32:33] op_sel:[0,1,0] op_sel_hi:[1,1,0]
    v_pk_fma_f32 v[4:5], v[4:5], v[32:33], v[32:33] op_sel:[0,1,0] op_sel_hi:[1,1,0]
    v_pk_fma_f32 v[6:7], v[6:7], v[32:33], v[32:33] op_sel:[0,1,0] op_sel_hi:[1,1,0]
    v_pk_fma_f32 v[8:9], v[8:9], v[32:33], v[32:33] op_sel:[0,1,0] op_sel_hi:[1,1,0]
    v_pk_mul_f32 v[2:3], v[2:3], v[208:209]
    v_pk_mul_f32 v[4:5], v[4:5], v[210:211]
    v_pk_mul_f32 v[6:7], v[6:7], v[212:213]
    v_pk_mul_f32 v[8:9], v[8:9], v[214:215]
    v_exp_f32 v2, v2
    v_exp_f32 v3, v3
    v_exp_f32 v4, v4
    v_exp_f32 v5, v5
    v_exp_f32 v6, v6
    v_exp_f32 v7, v7
    v_exp_f32 v8, v8
    v_exp_f32 v9, v9
    v_pk_mul_f32 v[216:217], v[216:217], v[208:209]
    s_add_u32 s73, s95, 0
    s_nop 0
    buffer_load_dwordx4 a[176:179], v27, s[32:35], s73 offen sc1
    v_pk_mul_f32 v[218:219], v[218:219], v[210:211]
    v_pk_mul_f32 v[220:221], v[220:221], v[212:213]
    v_pk_mul_f32 v[222:223], v[222:223], v[214:215]
    v_pk_fma_f32 v[2:3], v[2:3], v[48:49], v[48:49] op_sel:[0,1,1] op_sel_hi:[1,1,1]
    v_pk_fma_f32 v[4:5], v[4:5], v[48:49], v[48:49] op_sel:[0,1,1] op_sel_hi:[1,1,1]
    v_pk_fma_f32 v[6:7], v[6:7], v[48:49], v[48:49] op_sel:[0,1,1] op_sel_hi:[1,1,1]
    v_pk_fma_f32 v[8:9], v[8:9], v[48:49], v[48:49] op_sel:[0,1,1] op_sel_hi:[1,1,1]
    v_rcp_f32 v2, v2
    v_rcp_f32 v3, v3
    v_rcp_f32 v4, v4
    v_rcp_f32 v5, v5
    buffer_load_dwordx4 a[180:183], v28, s[32:35], s73 offen sc1
    v_rcp_f32 v6, v6
    v_rcp_f32 v7, v7
    v_rcp_f32 v8, v8
    v_rcp_f32 v9, v9
    v_pk_mul_f32 v[216:217], v[216:217], v[2:3]
    v_pk_mul_f32 v[218:219], v[218:219], v[4:5]
    v_pk_mul_f32 v[220:221], v[220:221], v[6:7]
    v_pk_mul_f32 v[222:223], v[222:223], v[8:9]
    v_cvt_pk_bf16_f32 v208, v216, v217
    v_cvt_pk_bf16_f32 v209, v218, v219
    v_cvt_pk_bf16_f32 v210, v220, v221
    s_add_u32 s73, s96, 0
    s_nop 0
    buffer_load_dwordx4 a[184:187], v27, s[32:35], s73 offen sc1
    v_cvt_pk_bf16_f32 v211, v222, v223
    buffer_store_dwordx4 v[208:211], v30, s[32:35], s67 offen offset:0 sc1
    v_pk_mul_f32 v[2:3], v[224:225], v[224:225]
    v_pk_mul_f32 v[4:5], v[226:227], v[226:227]
    v_pk_mul_f32 v[6:7], v[228:229], v[228:229]
    v_pk_mul_f32 v[8:9], v[230:231], v[230:231]
    v_pk_fma_f32 v[2:3], v[2:3], v[32:33], v[32:33] op_sel:[0,1,0] op_sel_hi:[1,1,0]
    v_pk_fma_f32 v[4:5], v[4:5], v[32:33], v[32:33] op_sel:[0,1,0] op_sel_hi:[1,1,0]
    v_pk_fma_f32 v[6:7], v[6:7], v[32:33], v[32:33] op_sel:[0,1,0] op_sel_hi:[1,1,0]
    v_pk_fma_f32 v[8:9], v[8:9], v[32:33], v[32:33] op_sel:[0,1,0] op_sel_hi:[1,1,0]
    v_pk_mul_f32 v[2:3], v[2:3], v[224:225]
    v_pk_mul_f32 v[4:5], v[4:5], v[226:227]
    v_pk_mul_f32 v[6:7], v[6:7], v[228:229]
    v_pk_mul_f32 v[8:9], v[8:9], v[230:231]
    v_exp_f32 v2, v2
    v_exp_f32 v3, v3
    v_exp_f32 v4, v4
    v_exp_f32 v5, v5
    v_exp_f32 v6, v6
    v_exp_f32 v7, v7
L_islA4:
    s_cbranch_execz L_retA
    v_exp_f32 v8, v8
    v_exp_f32_e64 v9, v9
    buffer_load_dwordx4 a[188:191], v28, s[32:35], s73 offen sc1
    v_pk_mul_f32 v[232:233], v[232:233], v[224:225]
    v_pk_mul_f32 v[234:235], v[234:235], v[226:227]
    v_pk_mul_f32 v[236:237], v[236:237], v[228:229]
    v_pk_mul_f32 v[238:239], v[238:239], v[230:231]
    v_pk_fma_f32 v[2:3], v[2:3], v[46:47], v[46:47] op_sel:[0,1,1] op_sel_hi:[1,1,1]
    v_pk_fma_f32 v[4:5], v[4:5], v[46:47], v[46:47] op_sel:[0,1,1] op_sel_hi:[1,1,1]
    v_pk_fma_f32 v[6:7], v[6:7], v[46:47], v[46:47] op_sel:[0,1,1] op_sel_hi:[1,1,1]
    v_pk_fma_f32 v[8:9], v[8:9], v[46:47], v[46:47] op_sel:[0,1,1] op_sel_hi:[1,1,1]
    v_rcp_f32 v2, v2
    v_rcp_f32 v3, v3
    v_rcp_f32 v4, v4
    v_rcp_f32 v5, v5
    s_add_u32 s73, s97, 0
    buffer_load_dwordx4 a[192:195], v27, s[32:35], s73 offen sc1
    v_rcp_f32 v6, v6
    v_rcp_f32 v7, v7
    v_rcp_f32 v8, v8
    v_rcp_f32_e64 v9, v9
    v_pk_mul_f32 v[232:233], v[232:233], v[2:3]
    v_pk_mul_f32 v[234:235], v[234:235], v[4:5]
    v_pk_mul_f32 v[236:237], v[236:237], v[6:7]
    v_pk_mul_f32 v[238:239], v[238:239], v[8:9]
    v_cvt_pk_bf16_f32 v224, v232, v233
    v_cvt_pk_bf16_f32 v225, v234, v235
    buffer_load_dwordx4 a[196:199], v28, s[32:35], s73 offen sc1
    v_cvt_pk_bf16_f32 v226, v236, v237
    v_cvt_pk_bf16_f32 v227, v238, v239
    buffer_store_dwordx4 v[224:227], v29, s[32:35], s67 offen offset:1024 sc1
    v_pk_mul_f32 v[2:3], v[240:241], v[240:241]
    v_pk_mul_f32 v[4:5], v[242:243], v[242:243]
    v_pk_mul_f32 v[6:7], v[244:245], v[244:245]
    v_pk_mul_f32 v[8:9], v[246:247], v[246:247]
    v_pk_fma_f32 v[2:3], v[2:3], v[32:33], v[32:33] op_sel:[0,1,0] op_sel_hi:[1,1,0]
    v_pk_fma_f32 v[4:5], v[4:5], v[32:33], v[32:33] op_sel:[0,1,0] op_sel_hi:[1,1,0]
    v_pk_fma_f32 v[6:7], v[6:7], v[32:33], v[32:33] op_sel:[0,1,0] op_sel_hi:[1,1,0]
    v_pk_fma_f32 v[8:9], v[8:9], v[32:33], v[32:33] op_sel:[0,1,0] op_sel_hi:[1,1,0]
    v_pk_mul_f32 v[2:3], v[2:3], v[240:241]
    v_pk_mul_f32 v[4:5], v[4:5], v[242:243]
    v_pk_mul_f32 v[6:7], v[6:7], v[244:245]
    v_pk_mul_f32 v[8:9], v[8:9], v[246:247]
    v_exp_f32 v2, v2
    v_exp_f32 v3, v3
    v_exp_f32 v4, v4
    v_exp_f32 v5, v5
    v_exp_f32 v6, v6
    v_exp_f32 v7, v7
    v_exp_f32 v8, v8
    v_exp_f32 v9, v9
    s_add_u32 s73, s98, 0
    s_nop 0
    buffer_load_dwordx4 a[200:203], v27, s[32:35], s73 offen sc1
    v_pk_mul_f32 v[248:249], v[248:249], v[240:241]
    v_pk_mul_f32 v[250:251], v[250:251], v[242:243]
    v_pk_mul_f32 v[252:253], v[252:253], v[244:245]
    v_pk_mul_f32 v[254:255], v[254:255], v[246:247]
    v_pk_fma_f32 v[2:3], v[2:3], v[48:49], v[48:49] op_sel:[0,1,1] op_sel_hi:[1,1,1]
    v_pk_fma_f32 v[4:5], v[4:5], v[48:49], v[48:49] op_sel:[0,1,1] op_sel_hi:[1,1,1]
    v_pk_fma_f32 v[6:7], v[6:7], v[48:49], v[48:49] op_sel:[0,1,1] op_sel_hi:[1,1,1]
    v_pk_fma_f32 v[8:9], v[8:9], v[48:49], v[48:49] op_sel:[0,1,1] op_sel_hi:[1,1,1]
    v_rcp_f32 v2, v2
    v_rcp_f32 v3, v3
    v_rcp_f32_e64 v4, v4
    buffer_load_dwordx4 a[204:207], v28, s[32:35], s73 offen sc1
    v_rcp_f32 v5, v5
    v_rcp_f32 v6, v6
    v_rcp_f32 v7, v7
    v_rcp_f32 v8, v8
    v_rcp_f32_e64 v9, v9
    v_pk_mul_f32 v[248:249], v[248:249], v[2:3]
    v_pk_mul_f32 v[250:251], v[250:251], v[4:5]
    v_pk_mul_f32 v[252:253], v[252:253], v[6:7]
    v_pk_mul_f32 v[254:255], v[254:255], v[8:9]
    v_cvt_pk_bf16_f32 v240, v248, v249
    s_add_u32 s73, s99, 0
    s_nop 0
    buffer_load_dwordx4 a[208:211], v27, s[32:35], s73 offen sc1
    v_cvt_pk_bf16_f32 v241, v250, v251
    v_cvt_pk_bf16_f32 v242, v252, v253
    v_cvt_pk_bf16_f32 v243, v254, v255
    buffer_store_dwordx4 v[240:243], v30, s[32:35], s67 offen offset:1024 sc1
    buffer_load_dwordx4 v[100:103], v110, s[32:35], s58 offen offset:0 sc1
    buffer_load_dwordx4 v[104:107], v110, s[32:35], s58 offen offset:1024 sc1
    buffer_load_dwordx4 a[212:215], v28, s[32:35], s73 offen sc1
    s_add_u32 s73, s100, 0
    buffer_load_dwordx4 a[216:219], v27, s[32:35], s73 offen sc1
    buffer_load_dwordx4 a[220:223], v28, s[32:35], s73 offen sc1
    s_lshl4_add_u32 s57, s94, 786432
    s_add_u32 m0, s60, 0
    s_nop 0
    s_nop 0
    buffer_load_dwordx4 v22, s[24:27], s57 offen offset:0  lds
    buffer_load_dwordx4 v24, s[24:27], s57 offen offset:1024  lds
    ds_read_b64_tr_b16 a[0:1], v18 offset:57344
    ds_read_b64_tr_b16 a[2:3], v18 offset:58368
    ds_read_b64_tr_b16 a[4:5], v19 offset:57344
    ds_read_b64_tr_b16 a[6:7], v19 offset:58368
    s_lshl4_add_u32 s57, s95, 786432
    s_add_u32 m0, s60, 8192
    s_nop 0
    s_nop 0
    buffer_load_dwordx4 v22, s[24:27], s57 offen offset:0  lds
    buffer_load_dwordx4 v24, s[24:27], s57 offen offset:1024  lds
    ds_read_b64_tr_b16 a[8:9], v56 offset:8192
    ds_read_b64_tr_b16 a[10:11], v56 offset:9216
    ds_read_b64_tr_b16 a[12:13], v57 offset:8192
    ds_read_b64_tr_b16 a[14:15], v57 offset:9216
    s_waitcnt lgkmcnt(4)
    s_lshl4_add_u32 s57, s96, 786432
    s_add_u32 m0, s60, 57344
    s_nop 0
    buffer_load_dwordx4 v22, s[24:27], s57 offen offset:0  lds
    buffer_load_dwordx4 v24, s[24:27], s57 offen offset:1024  lds
    ds_read_b64_tr_b16 a[16:17], v56 offset:0
    ds_read_b64_tr_b16 a[18:19], v56 offset:1024
    ds_read_b64_tr_b16 a[20:21], v57 offset:0
    ds_read_b64_tr_b16 a[22:23], v57 offset:1024
    s_waitcnt lgkmcnt(4)
    s_lshl4_add_u32 s57, s97, 786432
    s_add_u32 m0, s60, 139264
    s_nop 0
    buffer_load_dwordx4 v22, s[24:27], s57 offen offset:0  lds
    s_waitcnt vmcnt(12)
    s_mov_b64 exec, 1
    buffer_store_dword v55, off, s[32:35], s69 offset:256 sc1
    s_mov_b64 exec, -1
    s_waitcnt vmcnt(12)
    v_xor_b32 v111, s49, v103
    s_waitcnt vmcnt(11)
    v_xor_b32 v112, s49, v107
    v_or_b32 v111, v111, v112
    v_cmp_ne_u32 vcc, 0, v111
    s_cbranch_vccnz L_A_again_12
L_A_ok_11:
    v_cvt_pk_bf16_f32 v102, v102, v106
    ds_write_b32 v38, v102
    s_waitcnt lgkmcnt(0)
    ds_read_b128 v[108:111], v37
    s_waitcnt lgkmcnt(0)
    v_cndmask_b32 v176, v100, v108, s[78:79]
    v_cndmask_b32 v180, v108, v100, s[78:79]
    v_cndmask_b32 v177, v101, v109, s[78:79]
    v_cndmask_b32 v181, v109, v101, s[78:79]
    v_cndmask_b32 v178, v104, v110, s[78:79]
    v_cndmask_b32 v182, v110, v104, s[78:79]
    v_cndmask_b32 v179, v105, v111, s[78:79]
    v_cndmask_b32 v183, v111, v105, s[78:79]
    s_nop 0
    v_mfma_f32_32x32x16_bf16 v[192:207], v[176:179], v[160:163], 0
    v_mfma_f32_32x32x16_bf16 v[208:223], v[180:183], v[164:167], 0
    v_mfma_f32_32x32x16_bf16 v[224:239], v[176:179], v[168:171], 0
    v_mfma_f32_32x32x16_bf16 v[240:255], v[180:183], v[172:175], 0
    s_nop 8
    v_add_f32 v200, 0x358637bd, v200
    v_add_f32 v208, 0x358637bd, v208
    v_add_f32 v232, 0x358637bd, v232
    v_add_f32 v240, 0x358637bd, v240
    v_rcp_f32 v200, v200
    v_rcp_f32 v208, v208
    v_rcp_f32 v232, v232
    v_rcp_f32 v240, v240
    v_mul_f32 v200, v200, v46
    v_mul_f32 v208, v208, v46
    v_mul_f32 v232, v232, v48
    v_mul_f32 v240, v240, v48
    v_pk_mul_f32 v[192:193], v[192:193], v[200:201] op_sel_hi:[1,0]
    v_pk_mul_f32 v[194:195], v[194:195], v[200:201] op_sel_hi:[1,0]
    v_pk_mul_f32 v[196:197], v[196:197], v[200:201] op_sel_hi:[1,0]
    v_pk_mul_f32 v[198:199], v[198:199], v[200:201] op_sel_hi:[1,0]
    v_cvt_pk_bf16_f32 v160, v192, v193
    v_cvt_pk_bf16_f32 v161, v194, v195
    v_cvt_pk_bf16_f32 v162, v196, v197
    v_cvt_pk_bf16_f32 v163, v198, v199
    buffer_store_dwordx4 v[160:163], v29, s[32:35], s68 offen offset:0 sc1
    v_pk_mul_f32 v[216:217], v[216:217], v[208:209] op_sel_hi:[1,0]
    v_pk_mul_f32 v[218:219], v[218:219], v[208:209] op_sel_hi:[1,0]
    v_pk_mul_f32 v[220:221], v[220:221], v[208:209] op_sel_hi:[1,0]
    v_pk_mul_f32 v[222:223], v[222:223], v[208:209] op_sel_hi:[1,0]
    v_cvt_pk_bf16_f32 v164, v216, v217
    v_cvt_pk_bf16_f32 v165, v218, v219
    v_cvt_pk_bf16_f32 v166, v220, v221
    v_cvt_pk_bf16_f32 v167, v222, v223
    buffer_store_dwordx4 v[164:167], v29, s[32:35], s68 offen offset:1024 sc1
    v_pk_mul_f32 v[224:225], v[224:225], v[232:233] op_sel_hi:[1,0]
    v_pk_mul_f32 v[226:227], v[226:227], v[232:233] op_sel_hi:[1,0]
    v_pk_mul_f32 v[228:229], v[228:229], v[232:233] op_sel_hi:[1,0]
    v_pk_mul_f32 v[230:231], v[230:231], v[232:233] op_sel_hi:[1,0]
    v_cvt_pk_bf16_f32 v168, v224, v225
    v_cvt_pk_bf16_f32 v169, v226, v227
    v_cvt_pk_bf16_f32 v170, v228, v229
    v_cvt_pk_bf16_f32 v171, v230, v231
    buffer_store_dwordx4 v[168:171], v30, s[32:35], s68 offen offset:0 sc1
    v_pk_mul_f32 v[248:249], v[248:249], v[240:241] op_sel_hi:[1,0]
    v_pk_mul_f32 v[250:251], v[250:251], v[240:241] op_sel_hi:[1,0]
    v_pk_mul_f32 v[252:253], v[252:253], v[240:241] op_sel_hi:[1,0]
    v_pk_mul_f32 v[254:255], v[254:255], v[240:241] op_sel_hi:[1,0]
    v_cvt_pk_bf16_f32 v172, v248, v249
    v_cvt_pk_bf16_f32 v173, v250, v251
    v_cvt_pk_bf16_f32 v174, v252, v253
    v_cvt_pk_bf16_f32 v175, v254, v255
    buffer_load_dwordx4 v24, s[24:27], s57 offen offset:1024  lds
    buffer_store_dwordx4 v[172:175], v30, s[32:35], s68 offen offset:1024 sc1
    ds_read_b64_tr_b16 a[24:25], v58 offset:24576
    ds_read_b64_tr_b16 a[26:27], v58 offset:25600
    ds_read_b64_tr_b16 a[28:29], v59 offset:24576
    ds_read_b64_tr_b16 a[30:31], v59 offset:25600
    s_lshl4_add_u32 s57, s98, 786432
    s_add_u32 m0, s60, 131072
    s_nop 0
    s_nop 0
    buffer_load_dwordx4 v22, s[24:27], s57 offen offset:0  lds
    buffer_load_dwordx4 v24, s[24:27], s57 offen offset:1024  lds
    ds_read_b64_tr_b16 a[32:33], v18 offset:16384
    ds_read_b64_tr_b16 a[34:35], v18 offset:17408
    ds_read_b64_tr_b16 a[36:37], v19 offset:16384
    ds_read_b64_tr_b16 a[38:39], v19 offset:17408
    s_waitcnt lgkmcnt(4)
    s_lshl4_add_u32 s57, s99, 786432
    s_add_u32 m0, s60, 90112
    s_nop 0
    buffer_load_dwordx4 v22, s[24:27], s57 offen offset:0  lds
    buffer_load_dwordx4 v24, s[24:27], s57 offen offset:1024  lds
    ds_read_b64_tr_b16 a[40:41], v18 offset:49152
    ds_read_b64_tr_b16 a[42:43], v18 offset:50176
    ds_read_b64_tr_b16 a[44:45], v19 offset:49152
    ds_read_b64_tr_b16 a[46:47], v19 offset:50176
    s_waitcnt lgkmcnt(4)
    s_lshl4_add_u32 s57, s100, 786432
    s_add_u32 m0, s60, 16384
    s_nop 0
    buffer_load_dwordx4 v22, s[24:27], s57 offen offset:0  lds
    buffer_load_dwordx4 v24, s[24:27], s57 offen offset:1024  lds
    ds_read_b64_tr_b16 a[48:49], v18 offset:24576
    ds_read_b64_tr_b16 a[50:51], v18 offset:25600
    ds_read_b64_tr_b16 a[52:53], v19 offset:24576
    ds_read_b64_tr_b16 a[54:55], v19 offset:25600
    s_waitcnt lgkmcnt(4)
    s_and_b32 s57, s93, 0xc00
    s_lshl4_add_u32 s57, s57, 524288
    s_add_u32 m0, s60, 49152
    s_nop 0
    buffer_load_dwordx4 v21, s[24:27], s57 offen offset:0  lds
    buffer_load_dwordx4 v23, s[24:27], s57 offen offset:1024  lds
    ds_read_b64_tr_b16 a[56:57], v58 offset:57344
    ds_read_b64_tr_b16 a[58:59], v58 offset:58368
    ds_read_b64_tr_b16 a[60:61], v59 offset:57344
    ds_read_b64_tr_b16 a[62:63], v59 offset:58368
    s_waitcnt lgkmcnt(0)
    v_mfma_f32_32x32x16_bf16 v[96:111], a[0:3], a[160:163], 0
    v_mfma_f32_32x32x16_bf16 v[112:127], a[4:7], a[160:163], 0
    s_and_b32 s57, s94, 0xc00
    s_lshl4_add_u32 s57, s57, 524288
    s_add_u32 m0, s60, 24576
    s_nop 0
    buffer_load_dwordx4 v21, s[24:27], s57 offen offset:0  lds
    v_mfma_f32_32x32x16_bf16 v[128:143], a[0:3], a[164:167], 0
    buffer_load_dwordx4 v23, s[24:27], s57 offen offset:1024  lds
    v_mfma_f32_32x32x16_bf16 v[144:159], a[4:7], a[164:167], 0
    ds_read_b64_tr_b16 a[64:65], v56 offset:16384
    ds_read_b64_tr_b16 a[66:67], v56 offset:17408
    ds_read_b64_tr_b16 a[68:69], v57 offset:16384
    ds_read_b64_tr_b16 a[70:71], v57 offset:17408
    s_waitcnt lgkmcnt(0)
    v_mfma_f32_32x32x16_bf16 v[96:111], a[8:11], a[168:171], v[96:111]
    v_mfma_f32_32x32x16_bf16 v[112:127], a[12:15], a[168:171], v[112:127]
    s_and_b32 s57, s95, 0xc00
    s_lshl4_add_u32 s57, s57, 524288
    s_add_u32 m0, s60, 122880
    s_nop 0
    buffer_load_dwordx4 v21, s[24:27], s57 offen offset:0  lds
    v_mfma_f32_32x32x16_bf16 v[128:143], a[8:11], a[172:175], v[128:143]
    buffer_load_dwordx4 v23, s[24:27], s57 offen offset:1024  lds
    v_mfma_f32_32x32x16_bf16 v[144:159], a[12:15], a[172:175], v[144:159]
    ds_read_b64_tr_b16 a[72:73], v58 offset:49152
    ds_read_b64_tr_b16 a[74:75], v58 offset:50176
    ds_read_b64_tr_b16 a[76:77], v59 offset:49152
    ds_read_b64_tr_b16 a[78:79], v59 offset:50176
    s_waitcnt lgkmcnt(0)
    v_mfma_f32_32x32x16_bf16 v[96:111], a[16:19], a[176:179], v[96:111]
    v_mfma_f32_32x32x16_bf16 v[112:127], a[20:23], a[176:179], v[112:127]
    s_and_b32 s57, s96, 0xc00
    s_lshl4_add_u32 s57, s57, 524288
    s_add_u32 m0, s60, 147456
    s_nop 0
    buffer_load_dwordx4 v21, s[24:27], s57 offen offset:0  lds
    v_mfma_f32_32x32x16_bf16 v[128:143], a[16:19], a[180:183], v[128:143]
    buffer_load_dwordx4 v23, s[24:27], s57 offen offset:1024  lds
    v_mfma_f32_32x32x16_bf16 v[144:159], a[20:23], a[180:183], v[144:159]
    ds_read_b64_tr_b16 a[80:81], v58 offset:16384
    ds_read_b64_tr_b16 a[82:83], v58 offset:17408
    ds_read_b64_tr_b16 a[84:85], v59 offset:16384
    ds_read_b64_tr_b16 a[86:87], v59 offset:17408
    s_waitcnt lgkmcnt(0)
    v_mfma_f32_32x32x16_bf16 v[96:111], a[24:27], a[184:187], v[96:111]
    v_mfma_f32_32x32x16_bf16 v[112:127], a[28:31], a[184:187], v[112:127]
    s_lshl4_add_u32 s57, s93, 0
    s_add_u32 m0, s60, 114688
    s_nop 0
    buffer_load_dwordx4 v22, s[28:31], s57 offen offset:0  lds
    v_mfma_f32_32x32x16_bf16 v[128:143], a[24:27], a[188:191], v[128:143]
    buffer_load_dwordx4 v24, s[28:31], s57 offen offset:1024  lds
    buffer_load_dword v44, v31, s[32:35], 0 offen offset:256 sc1
    v_mfma_f32_32x32x16_bf16 v[144:159], a[28:31], a[188:191], v[144:159]
    ds_read_b64_tr_b16 a[88:89], v58 offset:40960
    ds_read_b64_tr_b16 a[90:91], v58 offset:41984
    ds_read_b64_tr_b16 a[92:93], v59 offset:40960
    ds_read_b64_tr_b16 a[94:95], v59 offset:41984
    s_waitcnt lgkmcnt(0)
    v_mfma_f32_32x32x16_bf16 v[96:111], a[32:35], a[192:195], v[96:111]
    v_mfma_f32_32x32x16_bf16 v[112:127], a[36:39], a[192:195], v[112:127]
    s_lshl4_add_u32 s57, s94, 0
    s_add_u32 m0, s60, 81920
    s_nop 0
    buffer_load_dwordx4 v22, s[28:31], s57 offen offset:0  lds
    v_mfma_f32_32x32x16_bf16 v[128:143], a[32:35], a[196:199], v[128:143]
    buffer_load_dwordx4 v24, s[28:31], s57 offen offset:1024  lds
    v_mfma_f32_32x32x16_bf16 v[144:159], a[36:39], a[196:199], v[144:159]
    ds_read_b64_tr_b16 a[96:97], v58 offset:32768
    ds_read_b64_tr_b16 a[98:99], v58 offset:33792
    ds_read_b64_tr_b16 a[100:101], v59 offset:32768
    ds_read_b64_tr_b16 a[102:103], v59 offset:33792
    s_waitcnt lgkmcnt(0)
    v_mfma_f32_32x32x16_bf16 v[96:111], a[40:43], a[200:203], v[96:111]
    v_mfma_f32_32x32x16_bf16 v[112:127], a[44:47], a[200:203], v[112:127]
    s_lshl4_add_u32 s57, s95, 0
    s_add_u32 m0, s60, 106496
    s_nop 0
    buffer_load_dwordx4 v22, s[28:31], s57 offen offset:0  lds
    v_mfma_f32_32x32x16_bf16 v[128:143], a[40:43], a[204:207], v[128:143]
    buffer_load_dwordx4 v24, s[28:31], s57 offen offset:1024  lds
    v_mfma_f32_32x32x16_bf16 v[144:159], a[44:47], a[204:207], v[144:159]
    ds_read_b64_tr_b16 a[104:105], v18 offset:40960
    ds_read_b64_tr_b16 a[106:107], v18 offset:41984
    ds_read_b64_tr_b16 a[108:109], v19 offset:40960
    ds_read_b64_tr_b16 a[110:111], v19 offset:41984
    s_waitcnt lgkmcnt(0)
    v_mfma_f32_32x32x16_bf16 v[96:111], a[48:51], a[208:211], v[96:111]
    v_mfma_f32_32x32x16_bf16 v[112:127], a[52:55], a[208:211], v[112:127]
    s_waitcnt vmcnt(36)
    v_mfma_f32_32x32x16_bf16 v[128:143], a[48:51], a[212:215], v[128:143]
    s_lshl4_add_u32 s57, s96, 0
    s_add_u32 m0, s60, 98304
    s_nop 0
    buffer_load_dwordx4 v22, s[28:31], s57 offen offset:0  lds
    v_mfma_f32_32x32x16_bf16 v[144:159], a[52:55], a[212:215], v[144:159]
    buffer_load_dwordx4 v24, s[28:31], s57 offen offset:1024  lds
    s_waitcnt vmcnt(23)
    s_mov_b64 exec, 1
    buffer_store_dword v55, off, s[32:35], s69 offset:384 sc1
    s_mov_b64 exec, -1
    v_mfma_f32_32x32x16_bf16 v[96:111], a[56:59], a[216:219], v[96:111]
    v_mfma_f32_32x32x16_bf16 v[112:127], a[60:63], a[216:219], v[112:127]
    ds_read_b64_tr_b16 a[112:113], v18 offset:32768
    ds_read_b64_tr_b16 a[114:115], v18 offset:33792
    ds_read_b64_tr_b16 a[116:117], v19 offset:32768
    ds_read_b64_tr_b16 a[118:119], v19 offset:33792
    v_mfma_f32_32x32x16_bf16 v[128:143], a[56:59], a[220:223], v[128:143]
    s_waitcnt vmcnt(7)
    v_cmp_ne_u32 vcc, s49, v44
    s_cbranch_vccnz L_A_again_16
L_A_ok_15:
    buffer_load_dword v44, v31, s[32:35], 0 offen offset:128 sc1
    v_mfma_f32_32x32x16_bf16 v[144:159], a[60:63], a[220:223], v[144:159]
    s_lshl4_add_u32 s57, s97, 0
    s_add_u32 m0, s60, 40960
    s_nop 0
    s_nop 0
    buffer_load_dwordx4 v22, s[28:31], s57 offen offset:0  lds
    s_add_u32 s73, s93, 81920
    buffer_load_dwordx4 a[224:227], v27, s[32:35], s73 offen sc1
    buffer_load_dwordx4 a[228:231], v28, s[32:35], s73 offen sc1
    s_add_u32 s73, s94, 81920
    buffer_load_dwordx4 a[232:235], v27, s[32:35], s73 offen sc1
    buffer_load_dwordx4 a[236:239], v28, s[32:35], s73 offen sc1
    s_add_u32 s73, s95, 81920
    buffer_load_dwordx4 a[240:243], v27, s[32:35], s73 offen sc1
    buffer_load_dwordx4 a[244:247], v28, s[32:35], s73 offen sc1
    s_add_u32 s73, s96, 81920
    buffer_load_dwordx4 a[248:251], v27, s[32:35], s73 offen sc1
    buffer_load_dwordx4 a[252:255], v28, s[32:35], s73 offen sc1
    s_add_u32 s73, s97, 81920
    buffer_load_dwordx4 a[160:163], v27, s[32:35], s73 offen sc1
    buffer_load_dwordx4 a[164:167], v28, s[32:35], s73 offen sc1
    s_waitcnt lgkmcnt(0)
    s_waitcnt vmcnt(9)
    v_mfma_f32_32x32x16_bf16 v[96:111], a[64:67], a[224:227], v[96:111]
    v_mfma_f32_32x32x16_bf16 v[112:127], a[68:71], a[224:227], v[112:127]
    buffer_load_dwordx4 v24, s[28:31], s57 offen offset:1024  lds
    s_waitcnt vmcnt(9)
    v_mfma_f32_32x32x16_bf16 v[128:143], a[64:67], a[228:231], v[128:143]
    ds_read_b64_tr_b16 a[120:121], v58 offset:8192
    ds_read_b64_tr_b16 a[122:123], v58 offset:9216
    ds_read_b64_tr_b16 a[124:125], v59 offset:8192
    ds_read_b64_tr_b16 a[126:127], v59 offset:9216
    v_mfma_f32_32x32x16_bf16 v[144:159], a[68:71], a[228:231], v[144:159]
    s_add_u32 s73, s98, 81920
    buffer_load_dwordx4 a[168:171], v27, s[32:35], s73 offen sc1
    buffer_load_dwordx4 a[172:175], v28, s[32:35], s73 offen sc1
    s_waitcnt lgkmcnt(0)
    s_waitcnt vmcnt(10)
    v_mfma_f32_32x32x16_bf16 v[96:111], a[72:75], a[232:235], v[96:111]
    v_mfma_f32_32x32x16_bf16 v[112:127], a[76:79], a[232:235], v[112:127]
    s_lshl4_add_u32 s57, s98, 0
    s_add_u32 m0, s60, 32768
    s_nop 0
    buffer_load_dwordx4 v22, s[28:31], s57 offen offset:0  lds
    s_waitcnt vmcnt(10)
    v_mfma_f32_32x32x16_bf16 v[128:143], a[72:75], a[236:239], v[128:143]
    buffer_load_dwordx4 v24, s[28:31], s57 offen offset:1024  lds
    v_mfma_f32_32x32x16_bf16 v[144:159], a[76:79], a[236:239], v[144:159]
    ds_read_b64_tr_b16 a[128:129], v58 offset:0
    ds_read_b64_tr_b16 a[130:131], v58 offset:1024
    ds_read_b64_tr_b16 a[132:133], v59 offset:0
    ds_read_b64_tr_b16 a[134:135], v59 offset:1024
    s_add_u32 s73, s99, 81920
    buffer_load_dwordx4 a[176:179], v27, s[32:35], s73 offen sc1
    buffer_load_dwordx4 a[180:183], v28, s[32:35], s73 offen sc1
    s_waitcnt lgkmcnt(0)
    s_waitcnt vmcnt(12)
    v_mfma_f32_32x32x16_bf16 v[96:111], a[80:83], a[240:243], v[96:111]
    v_mfma_f32_32x32x16_bf16 v[112:127], a[84:87], a[240:243], v[112:127]
    s_waitcnt vmcnt(11)
    v_mfma_f32_32x32x16_bf16 v[128:143], a[80:83], a[244:247], v[128:143]
    s_lshl4_add_u32 s57, s99, 0
    s_add_u32 m0, s60, 73728
    s_nop 0
    buffer_load_dwordx4 v22, s[28:31], s57 offen offset:0  lds
    v_mfma_f32_32x32x16_bf16 v[144:159], a[84:87], a[244:247], v[144:159]
    buffer_load_dwordx4 v24, s[28:31], s57 offen offset:1024  lds
    s_add_u32 s73, s100, 81920
    buffer_load_dwordx4 a[184:187], v27, s[32:35], s73 offen sc1
    buffer_load_dwordx4 a[188:191], v28, s[32:35], s73 offen sc1
    s_waitcnt vmcnt(14)
    v_mfma_f32_32x32x16_bf16 v[96:111], a[88:91], a[248:251], v[96:111]
    v_mfma_f32_32x32x16_bf16 v[112:127], a[92:95], a[248:251], v[112:127]
    s_waitcnt vmcnt(13)
    v_mfma_f32_32x32x16_bf16 v[128:143], a[88:91], a[252:255], v[128:143]
    s_lshl4_add_u32 s57, s100, 0
    s_add_u32 m0, s60, 65536
    s_nop 0
    buffer_load_dwordx4 v22, s[28:31], s57 offen offset:0  lds
    v_cmp_ne_u32 vcc, s49, v44
    s_cbranch_vccnz L_A_again_18
L_A_ok_17:
    v_mfma_f32_32x32x16_bf16 v[144:159], a[92:95], a[252:255], v[144:159]
    s_nop 0
    buffer_load_dwordx4 v24, s[28:31], s57 offen offset:1024  lds
    s_add_u32 s73, s93, 49152
    buffer_load_dwordx4 a[192:195], v27, s[32:35], s73 offen sc1
    buffer_load_dwordx4 a[196:199], v28, s[32:35], s73 offen sc1
    v_mbcnt_lo_u32_b32 v2, -1, 0
    v_mbcnt_hi_u32_b32 v2, -1, v2
    v_and_b32 v3, 7, v2
    v_lshrrev_b32 v4, 5, v2
    v_xor_b32 v4, v4, v3
    v_lshlrev_b32 v4, 4, v4
    v_lshl_add_u32 v4, v3, 8, v4
    v_bfe_u32 v5, v2, 3, 2
    v_lshl_add_u32 v4, v5, 13, v4
    s_mul_i32 s52, s45, 32768
    s_lshl_b32 s53, s46, 7
    s_add_u32 s52, s52, s53
    s_add_u32 s52, s52, s60
    v_add_u32 v160, s52, v4
    v_xor_b32 v161, 32, v160
    v_xor_b32 v162, 64, v160
    v_xor_b32 v163, 96, v160
    v_xor_b32 v164, 128, v160
    v_xor_b32 v165, 160, v160
    v_xor_b32 v166, 192, v160
    v_xor_b32 v167, 224, v160
    v_xor_b32 v168, 32768, v160
    v_xor_b32 v169, 32800, v160
    v_xor_b32 v170, 32832, v160
    v_xor_b32 v171, 32864, v160
    v_xor_b32 v172, 32896, v160
    v_xor_b32 v173, 32928, v160
    v_xor_b32 v174, 32960, v160
    v_xor_b32 v175, 32992, v160
    v_lshrrev_b32 v5, 3, v2
    v_lshlrev_b32 v6, 1, v3
    v_xor_b32 v6, v6, v5
    v_lshlrev_b32 v6, 4, v6
    v_lshl_add_u32 v6, v5, 8, v6
    s_lshl_b32 s52, s44, 14
    v_add_u32 v6, s52, v6
    v_xor_b32 v7, 16, v6
    v_lshlrev_b32 v3, 4, v3
    v_lshl_add_u32 v3, v5, 10, v3
    s_lshl2_add_u32 s52, s50, s44
    s_lshl_b32 s52, s52, 14
    s_lshl_b32 s53, s51, 7
    s_add_u32 s52, s52, s53
    v_add_u32_e64 v3, s52, v3
    s_mov_b32 s54, 8192
    s_waitcnt vmcnt(16)
    v_mfma_f32_32x32x16_bf16 v[96:111], a[96:99], a[160:163], v[96:111]
    v_mfma_f32_32x32x16_bf16 v[112:127], a[100:103], a[160:163], v[112:127]
    s_waitcnt vmcnt(15)
    v_mfma_f32_32x32x16_bf16 v[128:143], a[96:99], a[164:167], v[128:143]
    v_mfma_f32_32x32x16_bf16 v[144:159], a[100:103], a[164:167], v[144:159]
    s_add_u32 s73, s94, 49152
    buffer_load_dwordx4 a[200:203], v27, s[32:35], s73 offen sc1
    buffer_load_dwordx4 a[204:207], v28, s[32:35], s73 offen sc1
    s_waitcnt vmcnt(15)
    v_mfma_f32_32x32x16_bf16 v[96:111], a[104:107], a[168:171], v[96:111]
    v_mfma_f32_32x32x16_bf16 v[112:127], a[108:111], a[168:171], v[112:127]
    s_waitcnt vmcnt(14)
    v_mfma_f32_32x32x16_bf16 v[128:143], a[104:107], a[172:175], v[128:143]
    v_mfma_f32_32x32x16_bf16 v[144:159], a[108:111], a[172:175], v[144:159]
    s_add_u32 s73, s95, 49152
    buffer_load_dwordx4 a[208:211], v27, s[32:35], s73 offen sc1
    buffer_load_dwordx4 a[212:215], v28, s[32:35], s73 offen sc1
    s_waitcnt vmcnt(13)
    v_mfma_f32_32x32x16_bf16 v[96:111], a[112:115], a[176:179], v[96:111]
    v_mfma_f32_32x32x16_bf16 v[112:127], a[116:119], a[176:179], v[112:127]
    s_waitcnt vmcnt(12)
    v_mfma_f32_32x32x16_bf16 v[128:143], a[112:115], a[180:183], v[128:143]
    v_mfma_f32_32x32x16_bf16 v[144:159], a[116:119], a[180:183], v[144:159]
    s_add_u32 s73, s96, 49152
    buffer_load_dwordx4 a[216:219], v27, s[32:35], s73 offen sc1
    buffer_load_dwordx4 a[220:223], v28, s[32:35], s73 offen sc1
    s_waitcnt vmcnt(11)
    v_mfma_f32_32x32x16_bf16 v[96:111], a[120:123], a[184:187], v[96:111]
    v_mfma_f32_32x32x16_bf16 v[112:127], a[124:127], a[184:187], v[112:127]
    s_waitcnt vmcnt(10)
    v_mfma_f32_32x32x16_bf16 v[128:143], a[120:123], a[188:191], v[128:143]
    v_mfma_f32_32x32x16_bf16 v[144:159], a[124:127], a[188:191], v[144:159]
    s_add_u32 s73, s97, 49152
    buffer_load_dwordx4 a[224:227], v27, s[32:35], s73 offen sc1
    buffer_load_dwordx4 a[228:231], v28, s[32:35], s73 offen sc1
    s_waitcnt vmcnt(9)
    v_mfma_f32_32x32x16_bf16 v[96:111], a[128:131], a[192:195], v[96:111]
    ds_read_b64_tr_b16 v[80:81], v18 offset:0
    ds_read_b64_tr_b16 v[82:83], v18 offset:1024
    v_mfma_f32_32x32x16_bf16 v[112:127], a[132:135], a[192:195], v[112:127]
    ds_read_b64_tr_b16 v[84:85], v19 offset:0
    ds_read_b64_tr_b16 v[86:87], v19 offset:1024
    s_waitcnt vmcnt(8)
    v_mfma_f32_32x32x16_bf16 v[128:143], a[128:131], a[196:199], v[128:143]
    v_mfma_f32_32x32x16_bf16 v[144:159], a[132:135], a[196:199], v[144:159]
    s_add_u32 s73, s98, 49152
    buffer_load_dwordx4 a[232:235], v27, s[32:35], s73 offen sc1
    buffer_load_dwordx4 a[236:239], v28, s[32:35], s73 offen sc1
    s_waitcnt lgkmcnt(0)
    s_waitcnt vmcnt(9)
    v_mfma_f32_32x32x16_bf16 v[96:111], v[80:83], a[200:203], v[96:111]
    ds_read_b64_tr_b16 v[64:65], v18 offset:8192
    ds_read_b64_tr_b16 v[66:67], v18 offset:9216
    v_mfma_f32_32x32x16_bf16 v[112:127], v[84:87], a[200:203], v[112:127]
    ds_read_b64_tr_b16 v[68:69], v19 offset:8192
    ds_read_b64_tr_b16 v[70:71], v19 offset:9216
    s_waitcnt vmcnt(8)
    v_mfma_f32_32x32x16_bf16 v[128:143], v[80:83], a[204:207], v[128:143]
    v_mfma_f32_32x32x16_bf16 v[144:159], v[84:87], a[204:207], v[144:159]
    s_add_u32 s73, s99, 49152
    buffer_load_dwordx4 a[240:243], v27, s[32:35], s73 offen sc1
    buffer_load_dwordx4 a[244:247], v28, s[32:35], s73 offen sc1
    s_waitcnt lgkmcnt(0)
    s_waitcnt vmcnt(9)
    v_mfma_f32_32x32x16_bf16 v[96:111], v[64:67], a[208:211], v[96:111]
    ds_read_b64_tr_b16 v[80:81], v18 offset:57344
    ds_read_b64_tr_b16 v[82:83], v18 offset:58368
    v_mfma_f32_32x32x16_bf16 v[112:127], v[68:71], a[208:211], v[112:127]
    ds_read_b64_tr_b16 v[84:85], v19 offset:57344
    ds_read_b64_tr_b16 v[86:87], v19 offset:58368
    s_waitcnt vmcnt(8)
    v_mfma_f32_32x32x16_bf16 v[128:143], v[64:67], a[212:215], v[128:143]
    v_mfma_f32_32x32x16_bf16 v[144:159], v[68:71], a[212:215], v[144:159]
    s_add_u32 s73, s100, 49152
    buffer_load_dwordx4 a[248:251], v27, s[32:35], s73 offen sc1
    buffer_load_dwordx4 a[252:255], v28, s[32:35], s73 offen sc1
    s_waitcnt lgkmcnt(0)
    s_waitcnt vmcnt(9)
    v_mfma_f32_32x32x16_bf16 v[96:111], v[80:83], a[216:219], v[96:111]
    ds_read_b64_tr_b16 v[64:65], v56 offset:8192
    ds_read_b64_tr_b16 v[66:67], v56 offset:9216
    v_mfma_f32_32x32x16_bf16 v[112:127], v[84:87], a[216:219], v[112:127]
    ds_read_b64_tr_b16 v[68:69], v57 offset:8192
    ds_read_b64_tr_b16 v[70:71], v57 offset:9216
    s_waitcnt vmcnt(8)
    v_mfma_f32_32x32x16_bf16 v[128:143], v[80:83], a[220:223], v[128:143]
    buffer_load_dword v44, v31, s[32:35], 0 offen offset:384 sc1
    v_mfma_f32_32x32x16_bf16 v[144:159], v[84:87], a[220:223], v[144:159]
    s_and_b32 s73, s93, 0xc00
    s_add_u32 s73, s73, 32768
    buffer_load_dwordx4 a[160:163], v25, s[32:35], s73 offen sc1
    buffer_load_dwordx4 a[164:167], v26, s[32:35], s73 offen sc1
    s_waitcnt lgkmcnt(0)
    s_waitcnt vmcnt(10)
    v_mfma_f32_32x32x16_bf16 v[96:111], v[64:67], a[224:227], v[96:111]
    ds_read_b64_tr_b16 v[80:81], v56 offset:0
L_islA5:
    s_cbranch_execz L_retA
    ds_read_b64_tr_b16 v[82:83], v56 offset:1024
    v_mfma_f32_32x32x16_bf16 v[112:127], v[68:71], a[224:227], v[112:127]
    ds_read_b64_tr_b16 v[84:85], v57 offset:0
    ds_read_b64_tr_b16 v[86:87], v57 offset:1024
    s_waitcnt vmcnt(9)
    v_mfma_f32_32x32x16_bf16 v[128:143], v[64:67], a[228:231], v[128:143]
    v_mfma_f32_32x32x16_bf16 v[144:159], v[68:71], a[228:231], v[144:159]
    s_and_b32 s73, s94, 0xc00
    s_add_u32 s73, s73, 32768
    buffer_load_dwordx4 a[168:171], v25, s[32:35], s73 offen sc1
    buffer_load_dwordx4 a[172:175], v26, s[32:35], s73 offen sc1
    s_waitcnt lgkmcnt(0)
    s_waitcnt vmcnt(10)
    v_mfma_f32_32x32x16_bf16 v[96:111], v[80:83], a[232:235], v[96:111]
    ds_read_b64_tr_b16 v[64:65], v58 offset:24576
    ds_read_b64_tr_b16 v[66:67], v58 offset:25600
    v_mfma_f32_32x32x16_bf16 v[112:127], v[84:87], a[232:235], v[112:127]
    ds_read_b64_tr_b16 v[68:69], v59 offset:24576
    ds_read_b64_tr_b16 v[70:71], v59 offset:25600
    s_waitcnt vmcnt(9)
    v_mfma_f32_32x32x16_bf16 v[128:143], v[80:83], a[236:239], v[128:143]
    v_mfma_f32_32x32x16_bf16 v[144:159], v[84:87], a[236:239], v[144:159]
    s_and_b32 s73, s95, 0xc00
    s_add_u32 s73, s73, 32768
    buffer_load_dwordx4 a[176:179], v25, s[32:35], s73 offen sc1
    buffer_load_dwordx4 a[180:183], v26, s[32:35], s73 offen sc1
    s_waitcnt lgkmcnt(0)
    s_waitcnt vmcnt(10)
    v_mfma_f32_32x32x16_bf16 v[96:111], v[64:67], a[240:243], v[96:111]
    ds_read_b64_tr_b16 v[80:81], v18 offset:16384
    ds_read_b64_tr_b16 v[82:83], v18 offset:17408
    v_mfma_f32_32x32x16_bf16 v[112:127], v[68:71], a[240:243], v[112:127]
    ds_read_b64_tr_b16 v[84:85], v19 offset:16384
    ds_read_b64_tr_b16 v[86:87], v19 offset:17408
    s_waitcnt vmcnt(9)
    v_mfma_f32_32x32x16_bf16 v[128:143], v[64:67], a[244:247], v[128:143]
    v_mfma_f32_32x32x16_bf16 v[144:159], v[68:71], a[244:247], v[144:159]
    s_and_b32 s73, s96, 0xc00
    s_add_u32 s73, s73, 32768
    buffer_load_dwordx4 a[184:187], v25, s[32:35], s73 offen sc1
    buffer_load_dwordx4 a[188:191], v26, s[32:35], s73 offen sc1
    s_waitcnt lgkmcnt(0)
    s_waitcnt vmcnt(10)
    v_mfma_f32_32x32x16_bf16 v[96:111], v[80:83], a[248:251], v[96:111]
    ds_read_b64_tr_b16 v[64:65], v18 offset:49152
    ds_read_b64_tr_b16 v[66:67], v18 offset:50176
    v_mfma_f32_32x32x16_bf16 v[112:127], v[84:87], a[248:251], v[112:127]
    ds_read_b64_tr_b16 v[68:69], v19 offset:49152
    ds_read_b64_tr_b16 v[70:71], v19 offset:50176
    s_waitcnt vmcnt(9)
    v_mfma_f32_32x32x16_bf16 v[128:143], v[80:83], a[252:255], v[128:143]
    s_waitcnt vmcnt(8)
    v_cmp_ne_u32 vcc, s49, v44
    s_cbranch_vccnz L_A_again_20
L_A_ok_19:
    v_mfma_f32_32x32x16_bf16 v[144:159], v[84:87], a[252:255], v[144:159]
    s_add_u32 s73, s93, 114688
    buffer_load_dwordx4 a[192:195], v27, s[32:35], s73 offen sc1
    s_add_u32 s73, s94, 114688
    buffer_load_dwordx4 a[200:203], v27, s[32:35], s73 offen sc1
    s_waitcnt lgkmcnt(0)
    s_waitcnt vmcnt(9)
    v_mfma_f32_32x32x16_bf16 v[96:111], v[64:67], a[160:163], v[96:111]
    ds_read_b64_tr_b16 v[80:81], v18 offset:24576
    ds_read_b64_tr_b16 v[82:83], v18 offset:25600
    v_mfma_f32_32x32x16_bf16 v[112:127], v[68:71], a[160:163], v[112:127]
    ds_read_b64_tr_b16 v[84:85], v19 offset:24576
    ds_read_b64_tr_b16 v[86:87], v19 offset:25600
    s_waitcnt vmcnt(8)
    v_mfma_f32_32x32x16_bf16 v[128:143], v[64:67], a[164:167], v[128:143]
    v_mfma_f32_32x32x16_bf16 v[144:159], v[68:71], a[164:167], v[144:159]
    s_add_u32 s73, s95, 114688
    buffer_load_dwordx4 a[208:211], v27, s[32:35], s73 offen sc1
    s_add_u32 s73, s96, 114688
    buffer_load_dwordx4 a[216:219], v27, s[32:35], s73 offen sc1
    s_waitcnt lgkmcnt(0)
    s_waitcnt vmcnt(9)
    v_mfma_f32_32x32x16_bf16 v[96:111], v[80:83], a[168:171], v[96:111]
    ds_read_b64_tr_b16 v[64:65], v58 offset:57344
    ds_read_b64_tr_b16 v[66:67], v58 offset:58368
    v_mfma_f32_32x32x16_bf16 v[112:127], v[84:87], a[168:171], v[112:127]
    ds_read_b64_tr_b16 v[68:69], v59 offset:57344
    ds_read_b64_tr_b16 v[70:71], v59 offset:58368
    s_waitcnt vmcnt(8)
    v_mfma_f32_32x32x16_bf16 v[128:143], v[80:83], a[172:175], v[128:143]
    v_mfma_f32_32x32x16_bf16 v[144:159], v[84:87], a[172:175], v[144:159]
    s_add_u32 s73, s97, 114688
    buffer_load_dwordx4 a[224:227], v27, s[32:35], s73 offen sc1
    s_add_u32 s73, s98, 114688
    buffer_load_dwordx4 a[232:235], v27, s[32:35], s73 offen sc1
    s_waitcnt lgkmcnt(0)
    s_waitcnt vmcnt(9)
    v_mfma_f32_32x32x16_bf16 v[96:111], v[64:67], a[176:179], v[96:111]
    ds_read_b64_tr_b16 v[80:81], v56 offset:16384
    ds_read_b64_tr_b16 v[82:83], v56 offset:17408
    v_mfma_f32_32x32x16_bf16 v[112:127], v[68:71], a[176:179], v[112:127]
    ds_read_b64_tr_b16 v[84:85], v57 offset:16384
    ds_read_b64_tr_b16 v[86:87], v57 offset:17408
    s_waitcnt vmcnt(8)
    v_mfma_f32_32x32x16_bf16 v[128:143], v[64:67], a[180:183], v[128:143]
    v_mfma_f32_32x32x16_bf16 v[144:159], v[68:71], a[180:183], v[144:159]
    s_add_u32 s73, s99, 114688
    buffer_load_dwordx4 a[240:243], v27, s[32:35], s73 offen sc1
    s_add_u32 s73, s100, 114688
    buffer_load_dwordx4 a[248:251], v27, s[32:35], s73 offen sc1
    s_waitcnt lgkmcnt(0)
    s_waitcnt vmcnt(9)
    v_mfma_f32_32x32x16_bf16 v[96:111], v[80:83], a[184:187], v[96:111]
    ds_read_b64_tr_b16 a[0:1], v58 offset:49152
    ds_read_b64_tr_b16 a[2:3], v58 offset:50176
    ds_read_b64_tr_b16 a[4:5], v59 offset:49152
    v_mfma_f32_32x32x16_bf16 v[112:127], v[84:87], a[184:187], v[112:127]
    ds_read_b64_tr_b16 a[6:7], v59 offset:50176
    ds_read_b64_tr_b16 a[8:9], v58 offset:16384
    ds_read_b64_tr_b16 a[10:11], v58 offset:17408
    s_waitcnt vmcnt(8)
    v_mfma_f32_32x32x16_bf16 v[128:143], v[80:83], a[188:191], v[128:143]
    ds_read_b64_tr_b16 a[12:13], v59 offset:16384
    ds_read_b64_tr_b16 a[14:15], v59 offset:17408
    v_mfma_f32_32x32x16_bf16 v[144:159], v[84:87], a[188:191], v[144:159]
    s_add_u32 s73, s93, 114688
    buffer_load_dwordx4 a[196:199], v28, s[32:35], s73 offen sc1
    s_add_u32 s73, s94, 114688
    buffer_load_dwordx4 a[204:207], v28, s[32:35], s73 offen sc1
    s_waitcnt lgkmcnt(0)
    s_waitcnt vmcnt(9)
    v_mfma_f32_32x32x16_bf16 v[96:111], a[0:3], a[192:195], v[96:111]
    ds_read_b64_tr_b16 a[16:17], v58 offset:40960
    ds_read_b64_tr_b16 a[18:19], v58 offset:41984
    ds_read_b64_tr_b16 a[20:21], v59 offset:40960
    v_mfma_f32_32x32x16_bf16 v[112:127], a[4:7], a[192:195], v[112:127]
    ds_read_b64_tr_b16 a[22:23], v59 offset:41984
    ds_read_b64_tr_b16 a[24:25], v58 offset:32768
    ds_read_b64_tr_b16 a[26:27], v58 offset:33792
    s_waitcnt vmcnt(8)
    v_mfma_f32_32x32x16_bf16 v[96:111], a[8:11], a[200:203], v[96:111]
    ds_read_b64_tr_b16 a[28:29], v59 offset:32768
    ds_read_b64_tr_b16 a[30:31], v59 offset:33792
    v_mfma_f32_32x32x16_bf16 v[112:127], a[12:15], a[200:203], v[112:127]
    s_add_u32 s73, s95, 114688
    buffer_load_dwordx4 a[212:215], v28, s[32:35], s73 offen sc1
    s_add_u32 s73, s96, 114688
    buffer_load_dwordx4 a[220:223], v28, s[32:35], s73 offen sc1
    s_waitcnt lgkmcnt(0)
    s_waitcnt vmcnt(9)
    v_mfma_f32_32x32x16_bf16 v[96:111], a[16:19], a[208:211], v[96:111]
    ds_read_b64_tr_b16 a[32:33], v18 offset:40960
    ds_read_b64_tr_b16 a[34:35], v18 offset:41984
    ds_read_b64_tr_b16 a[36:37], v19 offset:40960
    v_mfma_f32_32x32x16_bf16 v[112:127], a[20:23], a[208:211], v[112:127]
    ds_read_b64_tr_b16 a[38:39], v19 offset:41984
    ds_read_b64_tr_b16 a[40:41], v18 offset:32768
    ds_read_b64_tr_b16 a[42:43], v18 offset:33792
    s_waitcnt vmcnt(8)
    v_mfma_f32_32x32x16_bf16 v[96:111], a[24:27], a[216:219], v[96:111]
    ds_read_b64_tr_b16 a[44:45], v19 offset:32768
    ds_read_b64_tr_b16 a[46:47], v19 offset:33792
    v_mfma_f32_32x32x16_bf16 v[112:127], a[28:31], a[216:219], v[112:127]
    s_add_u32 s73, s97, 114688
    buffer_load_dwordx4 a[228:231], v28, s[32:35], s73 offen sc1
    s_add_u32 s73, s98, 114688
    buffer_load_dwordx4 a[236:239], v28, s[32:35], s73 offen sc1
    s_waitcnt lgkmcnt(0)
    s_waitcnt vmcnt(9)
    v_mfma_f32_32x32x16_bf16 v[96:111], a[32:35], a[224:227], v[96:111]
    ds_read_b64_tr_b16 a[48:49], v58 offset:8192
    ds_read_b64_tr_b16 a[50:51], v58 offset:9216
    ds_read_b64_tr_b16 a[52:53], v59 offset:8192
    v_mfma_f32_32x32x16_bf16 v[112:127], a[36:39], a[224:227], v[112:127]
    ds_read_b64_tr_b16 a[54:55], v59 offset:9216
    ds_read_b64_tr_b16 a[56:57], v58 offset:0
    ds_read_b64_tr_b16 a[58:59], v58 offset:1024
    s_waitcnt vmcnt(8)
    v_mfma_f32_32x32x16_bf16 v[96:111], a[40:43], a[232:235], v[96:111]
    ds_read_b64_tr_b16 a[60:61], v59 offset:0
    ds_read_b64_tr_b16 a[62:63], v59 offset:1024
    v_mfma_f32_32x32x16_bf16 v[112:127], a[44:47], a[232:235], v[112:127]
    s_add_u32 s73, s99, 114688
    buffer_load_dwordx4 a[244:247], v28, s[32:35], s73 offen sc1
    s_add_u32 s73, s100, 114688
    buffer_load_dwordx4 a[252:255], v28, s[32:35], s73 offen sc1
    s_waitcnt lgkmcnt(0)
    s_waitcnt vmcnt(9)
    v_mfma_f32_32x32x16_bf16 v[96:111], a[48:51], a[240:243], v[96:111]
    v_mfma_f32_32x32x16_bf16 v[112:127], a[52:55], a[240:243], v[112:127]
    s_waitcnt vmcnt(8)
    v_mfma_f32_32x32x16_bf16 v[96:111], a[56:59], a[248:251], v[96:111]
    v_mfma_f32_32x32x16_bf16 v[112:127], a[60:63], a[248:251], v[112:127]
    s_waitcnt vmcnt(7)
    v_mfma_f32_32x32x16_bf16 v[128:143], a[0:3], a[196:199], v[128:143]
    v_mfma_f32_32x32x16_bf16 v[144:159], a[4:7], a[196:199], v[144:159]
    s_nop 7
    ds_write_b128 v160, v[96:99]
    s_waitcnt vmcnt(6)
    v_mfma_f32_32x32x16_bf16 v[128:143], a[8:11], a[204:207], v[128:143]
    v_mfma_f32_32x32x16_bf16 v[144:159], a[12:15], a[204:207], v[144:159]
    ds_write_b128 v161, v[100:103]
    s_waitcnt vmcnt(5)
    v_mfma_f32_32x32x16_bf16 v[128:143], a[16:19], a[212:215], v[128:143]
    v_mfma_f32_32x32x16_bf16 v[144:159], a[20:23], a[212:215], v[144:159]
    ds_write_b128 v162, v[104:107]
    s_waitcnt vmcnt(4)
    v_mfma_f32_32x32x16_bf16 v[128:143], a[24:27], a[220:223], v[128:143]
    v_mfma_f32_32x32x16_bf16 v[144:159], a[28:31], a[220:223], v[144:159]
    ds_write_b128 v163, v[108:111]
    s_waitcnt vmcnt(3)
    v_mfma_f32_32x32x16_bf16 v[128:143], a[32:35], a[228:231], v[128:143]
    v_mfma_f32_32x32x16_bf16 v[144:159], a[36:39], a[228:231], v[144:159]
    ds_write_b128 v164, v[112:115]
    s_waitcnt vmcnt(2)
    v_mfma_f32_32x32x16_bf16 v[128:143], a[40:43], a[236:239], v[128:143]
    v_mfma_f32_32x32x16_bf16 v[144:159], a[44:47], a[236:239], v[144:159]
    ds_write_b128 v165, v[116:119]
    s_waitcnt vmcnt(1)
    v_mfma_f32_32x32x16_bf16 v[128:143], a[48:51], a[244:247], v[128:143]
    v_mfma_f32_32x32x16_bf16 v[144:159], a[52:55], a[244:247], v[144:159]
    ds_write_b128 v166, v[120:123]
    s_waitcnt vmcnt(0)
    v_mfma_f32_32x32x16_bf16 v[128:143], a[56:59], a[252:255], v[128:143]
    v_mfma_f32_32x32x16_bf16 v[144:159], a[60:63], a[252:255], v[144:159]
    ds_write_b128 v167, v[124:127]
    s_nop 9
    s_nop 0
    ds_write_b128 v168, v[128:131]
    ds_write_b128 v169, v[132:135]
    ds_write_b128 v170, v[136:139]
    ds_write_b128 v171, v[140:143]
    ds_write_b128 v172, v[144:147]
    ds_write_b128 v173, v[148:151]
    ds_write_b128 v174, v[152:155]
    ds_write_b128 v175, v[156:159]
    s_waitcnt lgkmcnt(0)
    s_barrier
    ds_read_b128 v[96:99], v6 offset:0
    ds_read_b128 v[100:103], v7 offset:0
    ds_read_b128 v[104:107], v6 offset:2048
    ds_read_b128 v[108:111], v7 offset:2048
    ds_read_b128 v[112:115], v6 offset:4096
    ds_read_b128 v[116:119], v7 offset:4096
    ds_read_b128 v[120:123], v6 offset:6144
    ds_read_b128 v[124:127], v7 offset:6144
    ds_read_b128 v[128:131], v6 offset:8192
    ds_read_b128 v[132:135], v7 offset:8192
    ds_read_b128 v[136:139], v6 offset:10240
    ds_read_b128 v[140:143], v7 offset:10240
    ds_read_b128 v[144:147], v6 offset:12288
    ds_read_b128 v[148:151], v7 offset:12288
    ds_read_b128 v[152:155], v6 offset:14336
    ds_read_b128 v[156:159], v7 offset:14336
    s_waitcnt lgkmcnt(13)
    v_pk_add_f32 v[96:97], v[96:97], v[104:105]
    v_pk_add_f32 v[98:99], v[98:99], v[106:107]
    s_waitcnt lgkmcnt(12)
    v_pk_add_f32 v[100:101], v[100:101], v[108:109]
    v_pk_add_f32 v[102:103], v[102:103], v[110:111]
    s_waitcnt lgkmcnt(9)
    v_pk_add_f32 v[112:113], v[112:113], v[120:121]
    v_pk_add_f32 v[114:115], v[114:115], v[122:123]
    s_waitcnt lgkmcnt(8)
    v_pk_add_f32 v[116:117], v[116:117], v[124:125]
    v_pk_add_f32 v[118:119], v[118:119], v[126:127]
    v_pk_add_f32 v[96:97], v[96:97], v[112:113]
    v_pk_add_f32 v[98:99], v[98:99], v[114:115]
    v_pk_add_f32 v[100:101], v[100:101], v[116:117]
    v_pk_add_f32 v[102:103], v[102:103], v[118:119]
    v_cvt_pk_bf16_f32 v176, v96, v97
    v_cvt_pk_bf16_f32 v177, v98, v99
    v_cvt_pk_bf16_f32 v178, v100, v101
    v_cvt_pk_bf16_f32 v179, v102, v103
    buffer_store_dwordx4 v[176:179], v3, s[36:39], 0 offen sc1
    s_waitcnt lgkmcnt(5)
    v_pk_add_f32 v[128:129], v[128:129], v[136:137]
    v_pk_add_f32 v[130:131], v[130:131], v[138:139]
    s_waitcnt lgkmcnt(4)
    v_pk_add_f32 v[132:133], v[132:133], v[140:141]
    v_pk_add_f32 v[134:135], v[134:135], v[142:143]
    s_waitcnt lgkmcnt(1)
    v_pk_add_f32 v[144:145], v[144:145], v[152:153]
    v_pk_add_f32 v[146:147], v[146:147], v[154:155]
    s_waitcnt lgkmcnt(0)
    v_pk_add_f32 v[148:149], v[148:149], v[156:157]
    v_pk_add_f32 v[150:151], v[150:151], v[158:159]
    v_pk_add_f32 v[128:129], v[128:129], v[144:145]
    v_pk_add_f32 v[130:131], v[130:131], v[146:147]
    v_pk_add_f32 v[132:133], v[132:133], v[148:149]
    v_pk_add_f32 v[134:135], v[134:135], v[150:151]
    v_cvt_pk_bf16_f32 v180, v128, v129
    v_cvt_pk_bf16_f32 v181, v130, v131
    v_cvt_pk_bf16_f32 v182, v132, v133
    v_cvt_pk_bf16_f32 v183, v134, v135
    buffer_store_dwordx4 v[180:183], v3, s[36:39], s54 offen sc1
    s_or_b32 s52, s2, s44
    s_cmp_eq_u32 s52, 0
    s_cbranch_scc1 L_A_noep_21_go
L_A_noep_21:
    s_endpgm
L_stopA:
L_A_again_6:
    s_sleep 2
    buffer_load_dwordx2 v[46:47], v230, s[32:35], 0 offen offset:0 sc1
    s_add_u32 s75, s75, 1
    s_waitcnt vmcnt(0)
    v_cmp_ne_u32 vcc, s49, v47
    s_cmp_lt_u32 s75, 0x40000
    s_cbranch_scc0 L_A_ok_5
    s_cbranch_vccnz L_A_again_6
    s_branch L_A_ok_5
L_A_again_8:
    s_sleep 2
    buffer_load_dwordx2 v[48:49], v230, s[32:35], 0 offen offset:256 sc1
    s_add_u32 s75, s75, 1
    s_waitcnt vmcnt(0)
    v_cmp_ne_u32 vcc, s49, v49
    s_cmp_lt_u32 s75, 0x40000
    s_cbranch_scc0 L_A_ok_7
    s_cbranch_vccnz L_A_again_8
    s_branch L_A_ok_7
L_A_again_10:
    s_sleep 2
    buffer_load_dword v44, v34, s[32:35], 0 offen offset:0 sc1
    s_add_u32 s75, s75, 1
    s_waitcnt vmcnt(0)
    v_cmp_ne_u32 vcc, s49, v44
    s_cmp_lt_u32 s75, 0x40000
    s_cbranch_scc0 L_A_ok_9
    s_cbranch_vccnz L_A_again_10
    s_branch L_A_ok_9
L_A_again_12:
    s_sleep 2
    buffer_load_dwordx4 v[100:103], v110, s[32:35], s58 offen offset:0 sc1
    buffer_load_dwordx4 v[104:107], v110, s[32:35], s58 offen offset:1024 sc1
    s_add_u32 s75, s75, 1
    s_waitcnt vmcnt(0)
    v_xor_b32 v111, s49, v103
    v_xor_b32 v112, s49, v107
    v_or_b32 v111, v111, v112
    v_cmp_ne_u32 vcc, 0, v111
    s_cmp_lt_u32 s75, 0x40000
    s_cbranch_scc0 L_A_ok_11
    s_cbranch_vccnz L_A_again_12
    s_branch L_A_ok_11
L_A_again_14:
    s_sleep 2
    buffer_load_dword v45, v31, s[32:35], 0 offen offset:0 sc1
    s_add_u32 s75, s75, 1
    s_waitcnt vmcnt(0)
    v_cmp_ne_u32 vcc, s49, v45
    s_cmp_lt_u32 s75, 0x40000
    s_cbranch_scc0 L_A_ok_13
    s_cbranch_vccnz L_A_again_14
    s_branch L_A_ok_13
L_A_again_16:
    s_sleep 2
    buffer_load_dword v44, v31, s[32:35], 0 offen offset:256 sc1
    s_add_u32 s75, s75, 1
    s_waitcnt vmcnt(0)
    v_cmp_ne_u32 vcc, s49, v44
    s_cmp_lt_u32 s75, 0x40000
    s_cbranch_scc0 L_A_ok_15
    s_cbranch_vccnz L_A_again_16
    s_branch L_A_ok_15
L_A_again_18:
    s_sleep 2
    buffer_load_dword v44, v31, s[32:35], 0 offen offset:128 sc1
    s_add_u32 s75, s75, 1
    s_waitcnt vmcnt(0)
    v_cmp_ne_u32 vcc, s49, v44
    s_cmp_lt_u32 s75, 0x40000
    s_cbranch_scc0 L_A_ok_17
    s_cbranch_vccnz L_A_again_18
    s_branch L_A_ok_17
L_A_again_20:
    s_sleep 2
    buffer_load_dword v44, v31, s[32:35], 0 offen offset:384 sc1
    s_add_u32 s75, s75, 1
    s_waitcnt vmcnt(0)
    v_cmp_ne_u32 vcc, s49, v44
    s_cmp_lt_u32 s75, 0x40000
    s_cbranch_scc0 L_A_ok_19
    s_cbranch_vccnz L_A_again_20
    s_branch L_A_ok_19
L_A_noep_21_go:
    s_mov_b64 exec, 1
    buffer_store_dword v55, off, s[32:35], 0 offset:0 sc1
    s_branch L_A_noep_21
L_endA:
.p2align 12
L_pathB:
    buffer_load_dword v44, off, s[32:35], 0 offset:0 sc1
    s_and_b32 s52, s2, 7
    s_lshr_b32 s53, s2, 3
    s_and_b32 s54, s53, 7
    s_lshr_b32 s45, s44, 1
    s_and_b32 s46, s44, 1
    s_and_b32 s101, s53, 3
    s_lshl_b32 s61, s44, 10
    v_lshrrev_b32 v209, 5, v192
    v_bfe_u32 v210, v192, 2, 2
    v_and_b32 v211, 3, v192
    v_and_b32 v212, 31, v192
    s_lshr_b32 s50, s52, 1
    s_lshl3_add_u32 s50, s50, s54
    s_and_b32 s51, s52, 1
    s_lshr_b32 s77, s53, 3
    s_lshl2_add_u32 s51, s51, s77
    v_bfe_u32 v2, v192, 1, 3
    v_xor_b32 v2, v2, v209
    v_lshlrev_b32_e64 v2, 4, v2
    v_lshl_add_u32 v2, v212, 7, v2
    s_lshl_b32 s52, s45, 13
    v_add_u32 v226, s52, v2
    v_xor_b32 v227, 32, v226
    v_xor_b32 v228, 64, v226
    v_xor_b32 v229, 0x60, v226
    v_and_b32 v2, 2, v210
    v_xor_b32 v2, v2, v196
    s_lshl_b32 s52, s46, 1
    v_xor_b32 v2, s52, v2
    v_lshlrev_b32_e64 v2, 5, v2
    v_lshl_add_u32 v2, v211, 3, v2
    v_lshl_add_u32 v3, v209, 3, v210
    v_lshl_add_u32 v4, v3, 7, v2
    v_lshl_add_u32 v16, v196, 13, v4
    v_xor_b32_e64 v17, 32, v16
    v_lshl_add_u32 v5, v209, 2, v210
    v_lshl_add_u32 v5, v5, 7, v2
    v_add_u32 v18, s60, v5
    v_xor_b32 v19, 64, v18
    v_xor_b32 v2, s46, v196
    v_lshlrev_b32 v2, 5, v2
    v_lshl_add_u32 v2, v211, 3, v2
    v_lshl_add_u32 v2, v3, 6, v2
    v_lshl_add_u32 v20, v196, 12, v2
    v_mul_u32_u24 v3, 3584, v202
    v_add_u32 v10, v3, v203
    v_xor_b32 v11, 32, v10
    v_add_u32 v12, 27648, v10
    v_add_u32 v13, 27648, v11
    v_lshrrev_b32_e64 v2, 2, v192
    v_lshl_add_u32 v2, s44, 4, v2
    v_mul_u32_u24 v3, 3584, v2
    v_lshl_add_u32 v3, v211, 4, v3
    s_lshl_b32 s63, s48, 6
    v_add_u32 v14, s63, v3
    v_xor_b32_e64 v15, 32, v14
    v_lshl_add_u32 v2, v193, 10, v197
    s_lshl_b32 s52, s51, 7
    s_lshl_b32 s53, s44, 16
    s_add_u32 s52, s52, s53
    v_add_u32 v21, s52, v2
    v_add_u32_e64 v22, s53, v21
    v_add_u32 v23, 7168, v21
    v_add_u32 v24, 7168, v22
    s_mul_i32 s52, s50, 294912
    s_add_u32 s52, s52, 1048576
    s_add_u32 s52, s52, s59
    v_add_u32 v2, s52, v208
    s_mul_i32 s73, s45, 147456
    s_sub_u32 s54, 147456, s73
    v_add_u32 v25, s73, v2
    v_add_u32 v26, s54, v2
    v_add_u32 v27, s59, v25
    v_add_u32 v28, s59, v26
    s_lshl_b32 s52, s47, 1
    s_add_u32 s52, s52, s45
    s_mul_i32 s53, s52, 294912
    s_add_u32 s53, s53, 1048576
    v_add_u32_e64 v29, s53, v208
    v_add_u32 v30, 147456, v29
    s_lshl_b32 s53, s52, 9
    s_add_u32 s53, s53, 81920
    v_lshlrev_b32 v2, 3, v212
    v_add_u32 v230, s53, v2
    s_lshl_b32 s52, s52, 2
    s_lshr_b32 s53, s48, 1
    s_add_u32 s52, s52, s53
    s_lshl_b32 s52, s52, 9
    s_and_b32 s53, s48, 1
    s_lshl_b32 s53, s53, 1
    s_add_u32 s53, s53, s46
    s_lshl_b32 s53, s53, 2
    s_add_u32 s52, s52, s53
    s_add_u32 s69, s52, 4096
    s_lshl_b32 s52, s50, 2
    s_add_u32 s52, s52, s44
    s_lshl_b32 s52, s52, 9
    s_add_u32 s52, s52, 4096
    v_lshlrev_b32 v2, 2, v211
    v_add_u32 v31, s52, v2
    s_lshl_b32 s52, s48, 2
    s_lshl_b32 s53, s46, 1
    s_add_u32 s52, s52, s53
    s_lshl_b32 s65, s52, 10
    s_add_u32 s67, s65, 49152
    v_mov_b32 v32, 0xc0135761
    v_mov_b32 v33, 0xbdd2d3e8
    s_lshl_b32 s52, s48, 1
    s_add_u32 s52, s52, s46
    s_add_u32 s52, s52, 32
    s_lshl_b32 s66, s52, 10
    s_mov_b32 s75, 0
    s_mul_i32 s52, s51, 2
    s_mul_i32 s53, s50, 1
    s_add_u32 s52, s52, s53
    s_add_u32 s53, s52, 0
    s_and_b32 s53, s53, 7
    s_lshl_b32 s93, s53, 10
    s_add_u32 s53, s52, 1
    s_and_b32 s53, s53, 7
    s_lshl_b32 s94, s53, 10
    s_add_u32 s53, s52, 2
    s_and_b32 s53, s53, 7
    s_lshl_b32 s95, s53, 10
    s_add_u32 s53, s52, 3
    s_and_b32 s53, s53, 7
    s_lshl_b32 s96, s53, 10
    s_add_u32 s53, s52, 4
    s_and_b32 s53, s53, 7
    s_lshl_b32 s97, s53, 10
    s_add_u32 s53, s52, 5
    s_and_b32 s53, s53, 7
    s_lshl_b32 s98, s53, 10
    s_add_u32 s53, s52, 6
    s_and_b32 s53, s53, 7
    s_lshl_b32 s99, s53, 10
    s_add_u32 s53, s52, 7
    s_and_b32 s53, s53, 7
    s_lshl_b32 s100, s53, 10
    s_nop 0
    v_add_u32 v231, 65536, v226
    v_add_u32 v34, 65536, v16
    v_add_u32 v35, 65536, v17
    v_add_u32 v232, 65536, v227
    v_add_u32 v233, 65536, v228
    v_add_u32 v234, 65536, v229
    v_add_u32 v36, 131072, v20
    v_add_u32 v37, 65536, v20
    v_add_u32 v45, 131072, v18
    v_add_u32 v46, 131072, v19
    v_add_u32 v47, 65536, v18
    v_add_u32 v48, 65536, v19
    s_mov_b64 exec, 0
    s_cmp_eq_u32 s44, 0
    s_cbranch_scc1 L_islB1
    s_cmp_eq_u32 s44, 1
    s_cbranch_scc1 L_islB2
    s_cmp_eq_u32 s44, 2
    s_cbranch_scc1 L_islB3
    s_branch L_islB4
L_retB:
    s_mov_b64 exec, -1
    s_lshl_b32 s77, s76, 10
    buffer_load_dwordx4 v[214:217], v208, s[8:11], s77 offen
    buffer_load_dwordx4 v[218:221], v208, s[8:11], s77 offen offset:1024
    buffer_load_dwordx4 v[222:225], v208, s[40:43], 0 offen
    s_mov_b32 s57, 128
    s_add_u32 m0, s59, 32768
    s_nop 0
    buffer_load_dwordx4 v198, s[8:11], s57 offen offset:0  lds
    buffer_load_dwordx4 v199, s[8:11], s57 offen offset:1024  lds
    buffer_load_dwordx4 v200, s[8:11], s57 offen offset:2048  lds
    buffer_load_dwordx4 v201, s[8:11], s57 offen offset:3072  lds
    s_mul_i32 s57, s64, 1
    s_add_u32 m0, s60, 49152
    s_nop 0
    buffer_load_dwordx4 v204, s[84:87], s57 offen offset:0  lds
    buffer_load_dwordx4 v206, s[84:87], s57 offen offset:1024  lds
    s_add_u32 m0, s60, 57344
    s_nop 0
    buffer_load_dwordx4 v205, s[88:91], s57 offen offset:0  lds
    buffer_load_dwordx4 v207, s[88:91], s57 offen offset:1024  lds
    s_waitcnt vmcnt(12)
    s_barrier
    ds_read_b128 a[0:3], v226 offset:0
    ds_read_b64_tr_b16 v[64:65], v16 offset:16384
    ds_read_b64_tr_b16 v[66:67], v16 offset:16896
    ds_read_b128 a[4:7], v226 offset:4096
    ds_read_b64_tr_b16 v[68:69], v17 offset:16384
    ds_read_b64_tr_b16 v[70:71], v17 offset:16896
    ds_read_b128 a[8:11], v227 offset:0
    ds_read_b64_tr_b16 v[72:73], v16 offset:18432
    ds_read_b64_tr_b16 v[74:75], v16 offset:18944
    ds_read_b128 a[12:15], v227 offset:4096
    ds_read_b64_tr_b16 v[76:77], v17 offset:18432
    ds_read_b64_tr_b16 v[78:79], v17 offset:18944
    s_waitcnt lgkmcnt(0)
    v_mfma_f32_32x32x16_bf16 v[96:111], v[64:67], a[0:3], 0
    s_waitcnt vmcnt(11)
    v_add_u32 v44, 0x9e3779b9, v44
    s_nop 0
    v_readfirstlane_b32 s49, v44
    ds_read_b128 a[16:19], v228 offset:0
    ds_read_b64_tr_b16 v[80:81], v16 offset:20480
    v_mfma_f32_32x32x16_bf16 v[112:127], v[64:67], a[4:7], 0
    s_mov_b32 s57, 256
    s_add_u32 m0, s59, 65536
    ds_read_b64_tr_b16 v[82:83], v16 offset:20992
    ds_read_b128 a[20:23], v228 offset:4096
    buffer_load_dwordx4 v198, s[8:11], s57 offen offset:0  lds
    buffer_load_dwordx4 v199, s[8:11], s57 offen offset:1024  lds
    v_mfma_f32_32x32x16_bf16 v[128:143], v[68:71], a[0:3], 0
    ds_read_b64_tr_b16 v[84:85], v17 offset:20480
    ds_read_b64_tr_b16 v[86:87], v17 offset:20992
    buffer_load_dwordx4 v200, s[8:11], s57 offen offset:2048  lds
    v_mfma_f32_32x32x16_bf16 v[144:159], v[68:71], a[4:7], 0
    ds_read_b128 a[24:27], v229 offset:0
    ds_read_b64_tr_b16 v[88:89], v16 offset:22528
    buffer_load_dwordx4 v201, s[8:11], s57 offen offset:3072  lds
    v_mfma_f32_32x32x16_bf16 v[96:111], v[72:75], a[8:11], v[96:111]
    s_mul_i32 s57, s64, 2
    s_add_u32 m0, s60, 81920
    ds_read_b64_tr_b16 v[90:91], v16 offset:23040
    ds_read_b128 a[28:31], v229 offset:4096
    buffer_load_dwordx4 v204, s[84:87], s57 offen offset:0  lds
    v_mfma_f32_32x32x16_bf16 v[112:127], v[72:75], a[12:15], v[112:127]
    ds_read_b64_tr_b16 v[92:93], v17 offset:22528
    ds_read_b64_tr_b16 v[94:95], v17 offset:23040
    buffer_load_dwordx4 v206, s[84:87], s57 offen offset:1024  lds
    v_mfma_f32_32x32x16_bf16 v[128:143], v[76:79], a[8:11], v[128:143]
    s_add_u32 m0, s60, 90112
    s_nop 0
    buffer_load_dwordx4 v205, s[88:91], s57 offen offset:0  lds
    v_mfma_f32_32x32x16_bf16 v[144:159], v[76:79], a[12:15], v[144:159]
    buffer_load_dwordx4 v207, s[88:91], s57 offen offset:1024  lds
    s_waitcnt lgkmcnt(0)
    v_mfma_f32_32x32x16_bf16 v[96:111], v[80:83], a[16:19], v[96:111]
    s_waitcnt vmcnt(8)
    s_barrier
    ds_read_b128 a[32:35], v226 offset:32768
    ds_read_b64_tr_b16 v[64:65], v16 offset:49152
    v_mov_b32 v238, 0x3f803f80
    v_mov_b32 v236, 0
    v_mov_b32_e64 v237, 0
    v_mfma_f32_32x32x16_bf16 v[112:127], v[80:83], a[20:23], v[112:127]
    s_mov_b32 s57, 384
    s_add_u32 m0, s59, 0
    ds_read_b64_tr_b16 v[66:67], v16 offset:49664
    ds_read_b128 a[36:39], v226 offset:36864
    buffer_load_dwordx4 v198, s[8:11], s57 offen offset:0  lds
    v_lshlrev_b32 v2, 16, v222
    v_mfma_f32_32x32x16_bf16 v[128:143], v[84:87], a[16:19], v[128:143]
    ds_read_b64_tr_b16 v[68:69], v17 offset:49152
    ds_read_b64_tr_b16 v[70:71], v17 offset:49664
    buffer_load_dwordx4 v199, s[8:11], s57 offen offset:1024  lds
    v_and_b32 v3, 0xffff0000, v222
    v_lshlrev_b32_e64 v4, 16, v214
    v_mfma_f32_32x32x16_bf16 v[144:159], v[84:87], a[20:23], v[144:159]
    ds_read_b128 a[40:43], v227 offset:32768
    ds_read_b64_tr_b16 v[72:73], v16 offset:51200
    v_and_b32 v5, 0xffff0000, v214
    v_mul_f32 v4, v4, v2
    v_mul_f32 v5, v5, v3
    v_cvt_pk_bf16_f32 v4, v4, v5
    v_lshlrev_b32_e64 v8, 16, v4
    v_mfma_f32_32x32x16_bf16 v[96:111], v[88:91], a[24:27], v[96:111]
    ds_read_b64_tr_b16 v[74:75], v16 offset:51712
    ds_read_b128 a[44:47], v227 offset:36864
    buffer_load_dwordx4 v200, s[8:11], s57 offen offset:2048  lds
    v_and_b32 v9, 0xffff0000, v4
    v_add_f32_e64 v236, v236, v8
    v_mfma_f32_32x32x16_bf16 v[112:127], v[88:91], a[28:31], v[112:127]
    ds_read_b64_tr_b16 v[76:77], v17 offset:51200
    ds_read_b64_tr_b16 v[78:79], v17 offset:51712
    v_add_f32 v236, v236, v9
    v_lshlrev_b32 v6, 16, v218
    v_and_b32 v7, 0xffff0000, v218
    v_mul_f32 v6, v6, v2
    v_mul_f32 v7, v7, v3
    v_mfma_f32_32x32x16_bf16 v[128:143], v[92:95], a[24:27], v[128:143]
    buffer_load_dwordx4 v201, s[8:11], s57 offen offset:3072  lds
    v_cvt_pk_bf16_f32 v6, v6, v7
    v_lshlrev_b32_e64 v8, 16, v6
    v_and_b32 v9, 0xffff0000, v6
    v_add_f32_e64 v237, v237, v8
    v_mfma_f32_32x32x16_bf16 v[144:159], v[92:95], a[28:31], v[144:159]
    s_mul_i32 s57, s64, 3
    v_add_f32 v237, v237, v9
    v_lshlrev_b32_e64 v2, 16, v223
    v_and_b32 v3, 0xffff0000, v223
    v_lshlrev_b32_e64 v4, 16, v215
    v_and_b32 v5, 0xffff0000, v215
    v_mul_f32 v4, v4, v2
    v_mul_f32 v5, v5, v3
    s_waitcnt lgkmcnt(0)
    v_mfma_f32_32x32x16_bf16 v[96:111], v[64:67], a[32:35], v[96:111]
    s_add_u32 m0, s60, 16384
    ds_read_b128 a[48:51], v228 offset:32768
    ds_read_b64_tr_b16 v[80:81], v16 offset:53248
    buffer_load_dwordx4 v204, s[84:87], s57 offen offset:0  lds
    v_cvt_pk_bf16_f32 v4, v4, v5
    v_lshlrev_b32 v8, 16, v4
    v_mfma_f32_32x32x16_bf16 v[112:127], v[64:67], a[36:39], v[112:127]
    ds_read_b64_tr_b16 v[82:83], v16 offset:53760
    ds_read_b128 a[52:55], v228 offset:36864
    v_and_b32 v9, 0xffff0000, v4
    v_add_f32 v236, v236, v8
    v_add_f32 v236, v236, v9
    v_lshlrev_b32_e64 v6, 16, v219
    v_and_b32 v7, 0xffff0000, v219
    v_mfma_f32_32x32x16_bf16 v[128:143], v[68:71], a[32:35], v[128:143]
    ds_read_b64_tr_b16 v[84:85], v17 offset:53248
    ds_read_b64_tr_b16 v[86:87], v17 offset:53760
    buffer_load_dwordx4 v206, s[84:87], s57 offen offset:1024  lds
    v_mul_f32 v6, v6, v2
    v_mul_f32 v7, v7, v3
    v_mfma_f32_32x32x16_bf16 v[144:159], v[68:71], a[36:39], v[144:159]
    ds_read_b128 a[56:59], v229 offset:32768
    ds_read_b64_tr_b16 v[88:89], v16 offset:55296
    v_cvt_pk_bf16_f32 v6, v6, v7
    v_lshlrev_b32_e64 v8, 16, v6
    v_and_b32 v9, 0xffff0000, v6
    v_add_f32 v237, v237, v8
    v_add_f32 v237, v237, v9
    v_mfma_f32_32x32x16_bf16 v[96:111], v[72:75], a[40:43], v[96:111]
    s_add_u32 m0, s60, 24576
    ds_read_b64_tr_b16 v[90:91], v16 offset:55808
    ds_read_b128 a[60:63], v229 offset:36864
    buffer_load_dwordx4 v205, s[88:91], s57 offen offset:0  lds
    v_lshlrev_b32_e64 v2, 16, v224
    v_and_b32 v3, 0xffff0000, v224
    v_mfma_f32_32x32x16_bf16 v[112:127], v[72:75], a[44:47], v[112:127]
    ds_read_b64_tr_b16 v[92:93], v17 offset:55296
    ds_read_b64_tr_b16 v[94:95], v17 offset:55808
    v_lshlrev_b32_e64 v4, 16, v216
    v_and_b32 v5, 0xffff0000, v216
    v_mul_f32 v4, v4, v2
    v_mul_f32 v5, v5, v3
    v_cvt_pk_bf16_f32 v4, v4, v5
    v_mfma_f32_32x32x16_bf16 v[128:143], v[76:79], a[40:43], v[128:143]
    buffer_load_dwordx4 v207, s[88:91], s57 offen offset:1024  lds
    v_lshlrev_b32_e64 v8, 16, v4
    v_and_b32 v9, 0xffff0000, v4
    v_add_f32 v236, v236, v8
    v_add_f32 v236, v236, v9
    v_mfma_f32_32x32x16_bf16 v[144:159], v[76:79], a[44:47], v[144:159]
    v_lshlrev_b32_e64 v6, 16, v220
    v_and_b32 v7, 0xffff0000, v220
    v_mul_f32 v6, v6, v2
    v_mul_f32 v7, v7, v3
    v_cvt_pk_bf16_f32 v6, v6, v7
    v_lshlrev_b32_e64 v8, 16, v6
    v_and_b32 v9, 0xffff0000, v6
    s_waitcnt lgkmcnt(0)
    v_mfma_f32_32x32x16_bf16 v[96:111], v[80:83], a[48:51], v[96:111]
    s_waitcnt vmcnt(8)
    s_barrier
    ds_read_b128 a[64:67], v231 offset:0
    ds_read_b64_tr_b16 v[64:65], v34 offset:16384
    v_add_f32 v237, v237, v8
    v_add_f32 v237, v237, v9
    v_lshlrev_b32 v2, 16, v225
    v_mfma_f32_32x32x16_bf16 v[112:127], v[80:83], a[52:55], v[112:127]
    s_mov_b32 s57, 512
    s_add_u32 m0, s59, 32768
    ds_read_b64_tr_b16 v[66:67], v34 offset:16896
    ds_read_b128 a[68:71], v231 offset:4096
    buffer_load_dwordx4 v198, s[8:11], s57 offen offset:0  lds
    v_and_b32 v3, 0xffff0000, v225
    v_mfma_f32_32x32x16_bf16 v[128:143], v[84:87], a[48:51], v[128:143]
    ds_read_b64_tr_b16 v[68:69], v35 offset:16384
    ds_read_b64_tr_b16 v[70:71], v35 offset:16896
    buffer_load_dwordx4 v199, s[8:11], s57 offen offset:1024  lds
    v_lshlrev_b32_e64 v4, 16, v217
    v_and_b32 v5, 0xffff0000, v217
    v_mfma_f32_32x32x16_bf16 v[144:159], v[84:87], a[52:55], v[144:159]
    ds_read_b128 a[72:75], v232 offset:0
    ds_read_b64_tr_b16 v[72:73], v34 offset:18432
    v_mul_f32 v4, v4, v2
    v_mul_f32 v5, v5, v3
    v_cvt_pk_bf16_f32 v4, v4, v5
    v_lshlrev_b32_e64 v8, 16, v4
    v_and_b32 v9, 0xffff0000, v4
    v_mfma_f32_32x32x16_bf16 v[96:111], v[88:91], a[56:59], v[96:111]
    ds_read_b64_tr_b16 v[74:75], v34 offset:18944
    ds_read_b128 a[76:79], v232 offset:4096
    buffer_load_dwordx4 v200, s[8:11], s57 offen offset:2048  lds
    v_add_f32 v236, v236, v8
    v_add_f32 v236, v236, v9
    v_mfma_f32_32x32x16_bf16 v[112:127], v[88:91], a[60:63], v[112:127]
    ds_read_b64_tr_b16 v[76:77], v35 offset:18432
    ds_read_b64_tr_b16 v[78:79], v35 offset:18944
    v_lshlrev_b32_e64 v6, 16, v221
    v_and_b32 v7, 0xffff0000, v221
    v_mul_f32 v6, v6, v2
    v_mul_f32 v7, v7, v3
    v_cvt_pk_bf16_f32 v6, v6, v7
    v_mfma_f32_32x32x16_bf16 v[128:143], v[92:95], a[56:59], v[128:143]
    buffer_load_dwordx4 v201, s[8:11], s57 offen offset:3072  lds
    v_lshlrev_b32_e64 v8, 16, v6
    v_and_b32 v9, 0xffff0000, v6
    v_add_f32 v237, v237, v8
    v_add_f32 v237, v237, v9
    v_mfma_f32_32x32x16_bf16 v[144:159], v[92:95], a[60:63], v[144:159]
    s_mul_i32 s57, s64, 4
    v_permlane32_swap_b32 v236, v237
    v_add_f32 v236, v236, v237
    s_nop 1
    v_add_f32_dpp v236, v236, v236 quad_perm:[1,0,3,2] row_mask:0xf bank_mask:0xf
    s_nop 1
    v_add_f32_dpp v236, v236, v236 quad_perm:[2,3,0,1] row_mask:0xf bank_mask:0xf
    s_nop 1
    v_add_f32_dpp v236, v236, v236 row_half_mirror row_mask:0xf bank_mask:0xf
    s_nop 1
    v_add_f32_dpp v236, v236, v236 row_mirror row_mask:0xf bank_mask:0xf
    v_mov_b32 v237, v236
    s_waitcnt lgkmcnt(0)
    v_mfma_f32_32x32x16_bf16 v[96:111], v[64:67], a[64:67], v[96:111]
    s_add_u32 m0, s60, 49152
    ds_read_b128 a[80:83], v233 offset:0
    ds_read_b64_tr_b16 v[80:81], v34 offset:20480
    buffer_load_dwordx4 v204, s[84:87], s57 offen offset:0  lds
    v_permlane16_swap_b32 v236, v237
    v_add_f32_e64 v236, v236, v237
    v_mfma_f32_32x32x16_bf16 v[112:127], v[64:67], a[68:71], v[112:127]
    ds_read_b64_tr_b16 v[82:83], v34 offset:20992
    ds_read_b128 a[84:87], v233 offset:4096
    v_cvt_pk_bf16_f32 v236, v236, v236
    v_and_b32 v236, 0xffff0000, v236
    v_mul_f32 v236, 0xbfb8aa3b, v236
    v_exp_f32_e64 v236, v236
    v_mfma_f32_32x32x16_bf16 v[128:143], v[68:71], a[64:67], v[128:143]
    ds_read_b64_tr_b16 v[84:85], v35 offset:20480
    ds_read_b64_tr_b16 v[86:87], v35 offset:20992
    buffer_load_dwordx4 v206, s[84:87], s57 offen offset:1024  lds
    v_add_f32_e64 v236, 1.0, v236
    v_mfma_f32_32x32x16_bf16 v[144:159], v[68:71], a[68:71], v[144:159]
    ds_read_b128 a[88:91], v234 offset:0
    ds_read_b64_tr_b16 v[88:89], v34 offset:22528
    v_rcp_f32 v236, v236
    s_nop 0
    v_cvt_pk_bf16_f32 v236, v236, v236
    v_and_b32 v236, 0xffff0000, v236
    v_mov_b32_e64 v237, s49
    v_mfma_f32_32x32x16_bf16 v[96:111], v[72:75], a[72:75], v[96:111]
    s_add_u32 m0, s60, 57344
    ds_read_b64_tr_b16 v[90:91], v34 offset:23040
    ds_read_b128 a[92:95], v234 offset:4096
    buffer_load_dwordx4 v205, s[88:91], s57 offen offset:0  lds
    v_mfma_f32_32x32x16_bf16 v[112:127], v[72:75], a[76:79], v[112:127]
    ds_read_b64_tr_b16 v[92:93], v35 offset:22528
    ds_read_b64_tr_b16 v[94:95], v35 offset:23040
    v_lshlrev_b32 v2, 3, v209
    s_lshl_b32 s77, s76, 3
    s_add_u32 s77, s77, 81920
    s_mov_b32 exec_lo, 1
    s_mov_b32 exec_hi, 1
    buffer_store_dwordx2 v[236:237], v2, s[32:35], s77 offen sc1
    s_mov_b64 exec, -1
    v_mfma_f32_32x32x16_bf16 v[128:143], v[76:79], a[72:75], v[128:143]
    buffer_load_dwordx4 v207, s[88:91], s57 offen offset:1024  lds
    v_mfma_f32_32x32x16_bf16 v[144:159], v[76:79], a[76:79], v[144:159]
    s_and_b32 s52, s101, 3
    s_cmp_lg_u32 s52, 0
    s_cbranch_scc1 L_B_t2_1
    v_lshrrev_b32_e64 v239, 7, v246
    s_and_b32 s52, s92, 127
    s_bfe_u32 s53, s2, 0x10000
    s_lshl_b32 s54, s53, 7
    s_add_u32 s54, s54, s52
    s_lshl_b32 s54, s54, 1
    s_bfe_u32 s77, s2, 0x20001
    v_bfe_u32 v240, v239, 1, 1
    v_add_u32 v240, s54, v240
    v_and_b32_e64 v241, 1, v239
    v_lshl_add_u32 v241, s77, 1, v241
    v_lshlrev_b32_e64 v241, 7, v241
    v_mul_u32_u24 v242, 3072, v240
    v_add_u32 v242, v242, v241
    s_mov_b64 exec, 15
    buffer_load_dword v248, v242, s[12:15], 0 offen
    s_mov_b64 exec, -1
    v_lshrrev_b32 v242, 2, v239
    v_lshl_add_u32 v241, v242, 10, v241
    v_add_u32 v241, 1536, v241
    v_lshlrev_b32 v242, 7, s77
    v_add_u32 v242, 1024, v242
    v_cmp_gt_u32 vcc, 8, v239
    s_nop 1
    v_cndmask_b32 v241, v242, v241, vcc
    v_mul_u32_u24 v240, 3584, v240
    v_add_u32 v241, v241, v240
    s_mov_b64 exec, 0x5ff
    buffer_load_dword v250, v241, s[16:19], 0 offen
    buffer_load_dword v249, v241, s[20:23], 0 offen
    s_mov_b64 exec, -1
    v_lshrrev_b32 v240, 2, v239
    v_and_b32 v241, 3, v239
    v_lshlrev_b32 v241, 7, v241
    v_lshl_add_u32 v241, v240, 10, v241
    s_lshl_b32 s53, s53, 9
    s_lshl_b32 s54, s77, 7
    s_add_u32 s54, s54, s52
    s_lshl_b32 s77, s54, 10
    s_add_u32 s77, s77, s53
    s_mov_b64 exec, 15
    buffer_load_dword v247, v241, s[28:31], s77 offen
    s_lshl_b32 s77, s54, 12
    s_add_u32 s77, s77, s53
    s_mov_b64 exec, 0xffff
    buffer_load_dword v245, v241, s[24:27], s77 offen
    s_mov_b64 exec, -1
L_B_t2_1:
    s_waitcnt lgkmcnt(0)
    v_mfma_f32_32x32x16_bf16 v[96:111], v[80:83], a[80:83], v[96:111]
    s_waitcnt vmcnt(9)
    s_barrier
    ds_read_b128 a[96:99], v226 offset:0
    ds_read_b64_tr_b16 v[64:65], v16 offset:16384
    v_mfma_f32_32x32x16_bf16 v[112:127], v[80:83], a[84:87], v[112:127]
    s_mov_b32 s57, 640
    s_add_u32 m0, s59, 65536
    ds_read_b64_tr_b16 v[66:67], v16 offset:16896
    ds_read_b128 a[100:103], v226 offset:4096
    buffer_load_dwordx4 v198, s[8:11], s57 offen offset:0  lds
    v_mfma_f32_32x32x16_bf16 v[128:143], v[84:87], a[80:83], v[128:143]
    ds_read_b64_tr_b16 v[68:69], v17 offset:16384
    ds_read_b64_tr_b16 v[70:71], v17 offset:16896
    buffer_load_dwordx4 v199, s[8:11], s57 offen offset:1024  lds
    v_mfma_f32_32x32x16_bf16 v[144:159], v[84:87], a[84:87], v[144:159]
    ds_read_b128 a[104:107], v227 offset:0
    ds_read_b64_tr_b16 v[72:73], v16 offset:18432
    v_mfma_f32_32x32x16_bf16 v[96:111], v[88:91], a[88:91], v[96:111]
    ds_read_b64_tr_b16 v[74:75], v16 offset:18944
    ds_read_b128 a[108:111], v227 offset:4096
    buffer_load_dwordx4 v200, s[8:11], s57 offen offset:2048  lds
    v_mfma_f32_32x32x16_bf16 v[112:127], v[88:91], a[92:95], v[112:127]
    ds_read_b64_tr_b16 v[76:77], v17 offset:18432
    ds_read_b64_tr_b16 v[78:79], v17 offset:18944
    v_mfma_f32_32x32x16_bf16 v[128:143], v[92:95], a[88:91], v[128:143]
    buffer_load_dwordx4 v201, s[8:11], s57 offen offset:3072  lds
    v_mfma_f32_32x32x16_bf16 v[144:159], v[92:95], a[92:95], v[144:159]
    s_mul_i32 s57, s64, 5
    s_waitcnt lgkmcnt(0)
    v_mfma_f32_32x32x16_bf16 v[96:111], v[64:67], a[96:99], v[96:111]
    s_add_u32 m0, s60, 81920
    ds_read_b128 a[112:115], v228 offset:0
    ds_read_b64_tr_b16 v[80:81], v16 offset:20480
    buffer_load_dwordx4 v204, s[84:87], s57 offen offset:0  lds
    v_mfma_f32_32x32x16_bf16 v[112:127], v[64:67], a[100:103], v[112:127]
    ds_read_b64_tr_b16 v[82:83], v16 offset:20992
    ds_read_b128 a[116:119], v228 offset:4096
    v_mfma_f32_32x32x16_bf16 v[128:143], v[68:71], a[96:99], v[128:143]
    ds_read_b64_tr_b16 v[84:85], v17 offset:20480
    ds_read_b64_tr_b16 v[86:87], v17 offset:20992
    buffer_load_dwordx4 v206, s[84:87], s57 offen offset:1024  lds
    v_mfma_f32_32x32x16_bf16 v[144:159], v[68:71], a[100:103], v[144:159]
    ds_read_b128 a[120:123], v229 offset:0
    ds_read_b64_tr_b16 v[88:89], v16 offset:22528
    v_mfma_f32_32x32x16_bf16 v[96:111], v[72:75], a[104:107], v[96:111]
    s_add_u32 m0, s60, 90112
    ds_read_b64_tr_b16 v[90:91], v16 offset:23040
    ds_read_b128 a[124:127], v229 offset:4096
    buffer_load_dwordx4 v205, s[88:91], s57 offen offset:0  lds
    v_mfma_f32_32x32x16_bf16 v[112:127], v[72:75], a[108:111], v[112:127]
    ds_read_b64_tr_b16 v[92:93], v17 offset:22528
    ds_read_b64_tr_b16 v[94:95], v17 offset:23040
    v_mfma_f32_32x32x16_bf16 v[128:143], v[76:79], a[104:107], v[128:143]
    buffer_load_dwordx4 v207, s[88:91], s57 offen offset:1024  lds
    v_mfma_f32_32x32x16_bf16 v[144:159], v[76:79], a[108:111], v[144:159]
    s_and_b32 s52, s101, 3
    s_cmp_lg_u32 s52, 1
    s_cbranch_scc1 L_B_t2_2
    v_lshrrev_b32 v239, 7, v246
    s_and_b32 s52, s92, 127
    s_bfe_u32 s53, s2, 0x10000
    s_lshl_b32 s54, s53, 7
    s_add_u32 s54, s54, s52
    s_lshl_b32 s54, s54, 1
    s_bfe_u32 s77, s2, 0x20001
    v_bfe_u32 v240, v239, 1, 1
    v_add_u32 v240, s54, v240
    v_and_b32_e64 v241, 1, v239
    v_lshl_add_u32 v241, s77, 1, v241
    v_lshlrev_b32_e64 v241, 7, v241
    v_mul_u32_u24 v242, 3072, v240
    v_add_u32 v242, v242, v241
    s_mov_b64 exec, 15
    buffer_load_dword v248, v242, s[12:15], 0 offen
    s_mov_b64 exec, -1
    v_lshrrev_b32 v242, 2, v239
    v_lshl_add_u32 v241, v242, 10, v241
    v_add_u32 v241, 1536, v241
    v_lshlrev_b32 v242, 7, s77
    v_add_u32 v242, 1024, v242
    v_cmp_gt_u32 vcc, 8, v239
    s_nop 1
    v_cndmask_b32 v241, v242, v241, vcc
    v_mul_u32_u24 v240, 3584, v240
    v_add_u32 v241, v241, v240
    s_mov_b64 exec, 0x5ff
    buffer_load_dword v250, v241, s[16:19], 0 offen
    buffer_load_dword v249, v241, s[20:23], 0 offen
    s_mov_b64 exec, -1
    v_lshrrev_b32 v240, 2, v239
    v_and_b32 v241, 3, v239
    v_lshlrev_b32 v241, 7, v241
    v_lshl_add_u32 v241, v240, 10, v241
    s_lshl_b32 s53, s53, 9
    s_lshl_b32 s54, s77, 7
    s_add_u32 s54, s54, s52
    s_lshl_b32 s77, s54, 10
    s_add_u32 s77, s77, s53
    s_mov_b64 exec, 15
    buffer_load_dword v247, v241, s[28:31], s77 offen
    s_lshl_b32 s77, s54, 12
    s_add_u32 s77, s77, s53
    s_mov_b64 exec, 0xffff
    buffer_load_dword v245, v241, s[24:27], s77 offen
    s_mov_b64 exec, -1
L_B_t2_2:
    s_waitcnt lgkmcnt(0)
    v_mfma_f32_32x32x16_bf16 v[96:111], v[80:83], a[112:115], v[96:111]
    s_waitcnt vmcnt(8)
    s_barrier
    ds_read_b128 a[128:131], v226 offset:32768
    ds_read_b64_tr_b16 v[64:65], v16 offset:49152
    v_mfma_f32_32x32x16_bf16 v[112:127], v[80:83], a[116:119], v[112:127]
    s_mov_b32 s57, 768
    s_add_u32 m0, s59, 0
    ds_read_b64_tr_b16 v[66:67], v16 offset:49664
    ds_read_b128 a[132:135], v226 offset:36864
    buffer_load_dwordx4 v198, s[8:11], s57 offen offset:0  lds
    v_mfma_f32_32x32x16_bf16 v[128:143], v[84:87], a[112:115], v[128:143]
    ds_read_b64_tr_b16 v[68:69], v17 offset:49152
    ds_read_b64_tr_b16 v[70:71], v17 offset:49664
    buffer_load_dwordx4 v199, s[8:11], s57 offen offset:1024  lds
    v_mfma_f32_32x32x16_bf16 v[144:159], v[84:87], a[116:119], v[144:159]
L_islB1:
    s_cbranch_execz L_retB
    ds_read_b128 a[136:139], v227 offset:32768
    ds_read_b64_tr_b16 v[72:73], v16 offset:51200
    v_mfma_f32_32x32x16_bf16 v[96:111], v[88:91], a[120:123], v[96:111]
    ds_read_b64_tr_b16 v[74:75], v16 offset:51712
    ds_read_b128 a[140:143], v227 offset:36864
    buffer_load_dwordx4 v200, s[8:11], s57 offen offset:2048  lds
    v_mfma_f32_32x32x16_bf16 v[112:127], v[88:91], a[124:127], v[112:127]
    ds_read_b64_tr_b16 v[76:77], v17 offset:51200
    ds_read_b64_tr_b16 v[78:79], v17 offset:51712
    v_mfma_f32_32x32x16_bf16 v[128:143], v[92:95], a[120:123], v[128:143]
    buffer_load_dwordx4 v201, s[8:11], s57 offen offset:3072  lds
    v_mfma_f32_32x32x16_bf16 v[144:159], v[92:95], a[124:127], v[144:159]
    s_mul_i32 s57, s64, 6
    s_waitcnt lgkmcnt(0)
    v_mfma_f32_32x32x16_bf16 v[96:111], v[64:67], a[128:131], v[96:111]
    s_add_u32 m0, s60, 16384
    ds_read_b128 a[144:147], v228 offset:32768
    ds_read_b64_tr_b16 v[80:81], v16 offset:53248
    buffer_load_dwordx4 v204, s[84:87], s57 offen offset:0  lds
    v_mfma_f32_32x32x16_bf16 v[112:127], v[64:67], a[132:135], v[112:127]
    ds_read_b64_tr_b16 v[82:83], v16 offset:53760
    ds_read_b128 a[148:151], v228 offset:36864
    v_mfma_f32_32x32x16_bf16 v[128:143], v[68:71], a[128:131], v[128:143]
    ds_read_b64_tr_b16 v[84:85], v17 offset:53248
    ds_read_b64_tr_b16 v[86:87], v17 offset:53760
    buffer_load_dwordx4 v206, s[84:87], s57 offen offset:1024  lds
    v_mfma_f32_32x32x16_bf16 v[144:159], v[68:71], a[132:135], v[144:159]
    ds_read_b128 a[152:155], v229 offset:32768
    ds_read_b64_tr_b16 v[88:89], v16 offset:55296
    v_mfma_f32_32x32x16_bf16 v[96:111], v[72:75], a[136:139], v[96:111]
    s_add_u32 m0, s60, 24576
    ds_read_b64_tr_b16 v[90:91], v16 offset:55808
    ds_read_b128 a[156:159], v229 offset:36864
    buffer_load_dwordx4 v205, s[88:91], s57 offen offset:0  lds
    v_mfma_f32_32x32x16_bf16 v[112:127], v[72:75], a[140:143], v[112:127]
    ds_read_b64_tr_b16 v[92:93], v17 offset:55296
    ds_read_b64_tr_b16 v[94:95], v17 offset:55808
    v_mfma_f32_32x32x16_bf16 v[128:143], v[76:79], a[136:139], v[128:143]
    buffer_load_dwordx4 v207, s[88:91], s57 offen offset:1024  lds
    v_mfma_f32_32x32x16_bf16 v[144:159], v[76:79], a[140:143], v[144:159]
    s_and_b32 s52, s101, 3
    s_cmp_lg_u32 s52, 2
    s_cbranch_scc1 L_B_t2_3
    v_lshrrev_b32 v239, 7, v246
    s_and_b32 s52, s92, 127
    s_bfe_u32 s53, s2, 0x10000
    s_lshl_b32 s54, s53, 7
    s_add_u32 s54, s54, s52
    s_lshl_b32 s54, s54, 1
    s_bfe_u32 s77, s2, 0x20001
    v_bfe_u32 v240, v239, 1, 1
    v_add_u32 v240, s54, v240
    v_and_b32_e64 v241, 1, v239
    v_lshl_add_u32 v241, s77, 1, v241
    v_lshlrev_b32_e64 v241, 7, v241
    v_mul_u32_u24 v242, 3072, v240
    v_add_u32 v242, v242, v241
    s_mov_b64 exec, 15
    buffer_load_dword v248, v242, s[12:15], 0 offen
    s_mov_b64 exec, -1
    v_lshrrev_b32 v242, 2, v239
    v_lshl_add_u32 v241, v242, 10, v241
    v_add_u32 v241, 1536, v241
    v_lshlrev_b32 v242, 7, s77
    v_add_u32 v242, 1024, v242
    v_cmp_gt_u32 vcc, 8, v239
    s_nop 1
    v_cndmask_b32 v241, v242, v241, vcc
    v_mul_u32_u24 v240, 3584, v240
    v_add_u32 v241, v241, v240
    s_mov_b64 exec, 0x5ff
    buffer_load_dword v250, v241, s[16:19], 0 offen
    buffer_load_dword v249, v241, s[20:23], 0 offen
    s_mov_b64 exec, -1
    v_lshrrev_b32 v240, 2, v239
    v_and_b32 v241, 3, v239
    v_lshlrev_b32 v241, 7, v241
    v_lshl_add_u32 v241, v240, 10, v241
    s_lshl_b32 s53, s53, 9
    s_lshl_b32 s54, s77, 7
    s_add_u32 s54, s54, s52
    s_lshl_b32 s77, s54, 10
    s_add_u32 s77, s77, s53
    s_mov_b64 exec, 15
    buffer_load_dword v247, v241, s[28:31], s77 offen
    s_lshl_b32 s77, s54, 12
    s_add_u32 s77, s77, s53
    s_mov_b64 exec, 0xffff
    buffer_load_dword v245, v241, s[24:27], s77 offen
    s_mov_b64 exec, -1
L_B_t2_3:
    s_waitcnt lgkmcnt(0)
    v_mfma_f32_32x32x16_bf16 v[96:111], v[80:83], a[144:147], v[96:111]
    s_waitcnt vmcnt(8)
    s_barrier
    ds_read_b128 a[160:163], v231 offset:0
    ds_read_b64_tr_b16 v[64:65], v34 offset:16384
    v_mfma_f32_32x32x16_bf16 v[112:127], v[80:83], a[148:151], v[112:127]
    s_mov_b32 s57, 896
    s_add_u32 m0, s59, 32768
    ds_read_b64_tr_b16 v[66:67], v34 offset:16896
    ds_read_b128 a[164:167], v231 offset:4096
    buffer_load_dwordx4 v198, s[8:11], s57 offen offset:0  lds
    v_mfma_f32_32x32x16_bf16 v[128:143], v[84:87], a[144:147], v[128:143]
    ds_read_b64_tr_b16 v[68:69], v35 offset:16384
    ds_read_b64_tr_b16 v[70:71], v35 offset:16896
    buffer_load_dwordx4 v199, s[8:11], s57 offen offset:1024  lds
    v_mfma_f32_32x32x16_bf16 v[144:159], v[84:87], a[148:151], v[144:159]
    ds_read_b128 a[168:171], v232 offset:0
    ds_read_b64_tr_b16 v[72:73], v34 offset:18432
    v_mfma_f32_32x32x16_bf16 v[96:111], v[88:91], a[152:155], v[96:111]
    ds_read_b64_tr_b16 v[74:75], v34 offset:18944
    ds_read_b128 a[172:175], v232 offset:4096
    buffer_load_dwordx4 v200, s[8:11], s57 offen offset:2048  lds
    v_mfma_f32_32x32x16_bf16 v[112:127], v[88:91], a[156:159], v[112:127]
    ds_read_b64_tr_b16 v[76:77], v35 offset:18432
    ds_read_b64_tr_b16 v[78:79], v35 offset:18944
    v_mfma_f32_32x32x16_bf16 v[128:143], v[92:95], a[152:155], v[128:143]
    buffer_load_dwordx4 v201, s[8:11], s57 offen offset:3072  lds
    v_mfma_f32_32x32x16_bf16 v[144:159], v[92:95], a[156:159], v[144:159]
    s_mul_i32 s57, s64, 7
    s_waitcnt lgkmcnt(0)
    v_mfma_f32_32x32x16_bf16 v[96:111], v[64:67], a[160:163], v[96:111]
    s_add_u32 m0, s60, 49152
    ds_read_b128 a[176:179], v233 offset:0
    ds_read_b64_tr_b16 v[80:81], v34 offset:20480
    buffer_load_dwordx4 v204, s[84:87], s57 offen offset:0  lds
    v_mfma_f32_32x32x16_bf16 v[112:127], v[64:67], a[164:167], v[112:127]
    ds_read_b64_tr_b16 v[82:83], v34 offset:20992
    ds_read_b128 a[180:183], v233 offset:4096
    v_mfma_f32_32x32x16_bf16 v[128:143], v[68:71], a[160:163], v[128:143]
    ds_read_b64_tr_b16 v[84:85], v35 offset:20480
    ds_read_b64_tr_b16 v[86:87], v35 offset:20992
    buffer_load_dwordx4 v206, s[84:87], s57 offen offset:1024  lds
    v_mfma_f32_32x32x16_bf16 v[144:159], v[68:71], a[164:167], v[144:159]
    ds_read_b128 a[184:187], v234 offset:0
    ds_read_b64_tr_b16 v[88:89], v34 offset:22528
    v_mfma_f32_32x32x16_bf16 v[96:111], v[72:75], a[168:171], v[96:111]
    s_add_u32 m0, s60, 57344
    ds_read_b64_tr_b16 v[90:91], v34 offset:23040
    ds_read_b128 a[188:191], v234 offset:4096
    buffer_load_dwordx4 v205, s[88:91], s57 offen offset:0  lds
    v_mfma_f32_32x32x16_bf16 v[112:127], v[72:75], a[172:175], v[112:127]
    ds_read_b64_tr_b16 v[92:93], v35 offset:22528
    ds_read_b64_tr_b16 v[94:95], v35 offset:23040
    v_mfma_f32_32x32x16_bf16 v[128:143], v[76:79], a[168:171], v[128:143]
    buffer_load_dwordx4 v207, s[88:91], s57 offen offset:1024  lds
    v_mfma_f32_32x32x16_bf16 v[144:159], v[76:79], a[172:175], v[144:159]
    s_and_b32 s52, s101, 3
    s_cmp_lg_u32 s52, 3
    s_cbranch_scc1 L_B_t2_4
    v_lshrrev_b32 v239, 7, v246
    s_and_b32 s52, s92, 127
    s_bfe_u32 s53, s2, 0x10000
    s_lshl_b32 s54, s53, 7
    s_add_u32 s54, s54, s52
    s_lshl_b32 s54, s54, 1
    s_bfe_u32 s77, s2, 0x20001
    v_bfe_u32 v240, v239, 1, 1
    v_add_u32 v240, s54, v240
    v_and_b32_e64 v241, 1, v239
    v_lshl_add_u32 v241, s77, 1, v241
    v_lshlrev_b32_e64 v241, 7, v241
    v_mul_u32_u24 v242, 3072, v240
    v_add_u32 v242, v242, v241
    s_mov_b64 exec, 15
    buffer_load_dword v248, v242, s[12:15], 0 offen
    s_mov_b64 exec, -1
    v_lshrrev_b32 v242, 2, v239
    v_lshl_add_u32 v241, v242, 10, v241
    v_add_u32 v241, 1536, v241
    v_lshlrev_b32 v242, 7, s77
    v_add_u32 v242, 1024, v242
    v_cmp_gt_u32 vcc, 8, v239
    s_nop 1
    v_cndmask_b32 v241, v242, v241, vcc
    v_mul_u32_u24 v240, 3584, v240
    v_add_u32 v241, v241, v240
    s_mov_b64 exec, 0x5ff
    buffer_load_dword v250, v241, s[16:19], 0 offen
    buffer_load_dword v249, v241, s[20:23], 0 offen
    s_mov_b64 exec, -1
    v_lshrrev_b32 v240, 2, v239
    v_and_b32 v241, 3, v239
    v_lshlrev_b32 v241, 7, v241
    v_lshl_add_u32 v241, v240, 10, v241
    s_lshl_b32 s53, s53, 9
    s_lshl_b32 s54, s77, 7
    s_add_u32 s54, s54, s52
    s_lshl_b32 s77, s54, 10
    s_add_u32 s77, s77, s53
    s_mov_b64 exec, 15
    buffer_load_dword v247, v241, s[28:31], s77 offen
    s_lshl_b32 s77, s54, 12
    s_add_u32 s77, s77, s53
    s_mov_b64 exec, 0xffff
    buffer_load_dword v245, v241, s[24:27], s77 offen
    s_mov_b64 exec, -1
L_B_t2_4:
    s_waitcnt lgkmcnt(0)
    v_mfma_f32_32x32x16_bf16 v[96:111], v[80:83], a[176:179], v[96:111]
    s_waitcnt vmcnt(8)
    s_barrier
    ds_read_b128 a[192:195], v226 offset:0
    ds_read_b64_tr_b16 v[64:65], v16 offset:16384
    v_mfma_f32_32x32x16_bf16 v[112:127], v[80:83], a[180:183], v[112:127]
    ds_read_b64_tr_b16 v[66:67], v16 offset:16896
    ds_read_b128 a[196:199], v226 offset:4096
    buffer_load_dwordx2 v[40:41], v230, s[32:35], 0 offen offset:0 sc1
    v_mfma_f32_32x32x16_bf16 v[128:143], v[84:87], a[176:179], v[128:143]
    ds_read_b64_tr_b16 v[68:69], v17 offset:16384
    ds_read_b64_tr_b16 v[70:71], v17 offset:16896
    buffer_load_dwordx2 v[42:43], v230, s[32:35], 0 offen offset:256 sc1
    v_mfma_f32_32x32x16_bf16 v[144:159], v[84:87], a[180:183], v[144:159]
    s_mov_b32 s57, 1536
    ds_read_b128 a[200:203], v227 offset:0
    ds_read_b64_tr_b16 v[72:73], v16 offset:18432
    v_mfma_f32_32x32x16_bf16 v[96:111], v[88:91], a[184:187], v[96:111]
    s_add_u32 m0, s60, 65536
    ds_read_b64_tr_b16 v[74:75], v16 offset:18944
    ds_read_b128 a[204:207], v227 offset:4096
    buffer_load_dwordx4 v10, s[16:19], s57 offen offset:0  lds
    v_mfma_f32_32x32x16_bf16 v[112:127], v[88:91], a[188:191], v[112:127]
    ds_read_b64_tr_b16 v[76:77], v17 offset:18432
    ds_read_b64_tr_b16 v[78:79], v17 offset:18944
    buffer_load_dwordx4 v12, s[16:19], s57 offen offset:1024  lds
    v_mfma_f32_32x32x16_bf16 v[128:143], v[92:95], a[184:187], v[128:143]
    v_mfma_f32_32x32x16_bf16 v[144:159], v[92:95], a[188:191], v[144:159]
    s_add_u32 m0, s60, 73728
    s_nop 0
    buffer_load_dwordx4 v11, s[20:23], s57 offen offset:0  lds
    s_waitcnt lgkmcnt(0)
    v_mfma_f32_32x32x16_bf16 v[96:111], v[64:67], a[192:195], v[96:111]
    ds_read_b128 a[208:211], v228 offset:0
    ds_read_b64_tr_b16 v[80:81], v16 offset:20480
    buffer_load_dwordx4 v13, s[20:23], s57 offen offset:1024  lds
    v_mfma_f32_32x32x16_bf16 v[112:127], v[64:67], a[196:199], v[112:127]
    s_mov_b32 s57, 1024
    ds_read_b64_tr_b16 v[82:83], v16 offset:20992
    ds_read_b128 a[212:215], v228 offset:4096
    v_mfma_f32_32x32x16_bf16 v[128:143], v[68:71], a[192:195], v[128:143]
    s_add_u32 m0, s61, 147456
    ds_read_b64_tr_b16 v[84:85], v17 offset:20480
    ds_read_b64_tr_b16 v[86:87], v17 offset:20992
    buffer_load_dwordx4 v14, s[16:19], s57 offen offset:0  lds
    v_mfma_f32_32x32x16_bf16 v[144:159], v[68:71], a[196:199], v[144:159]
    s_add_u32 m0, s61, 151552
    ds_read_b128 a[216:219], v229 offset:0
    ds_read_b64_tr_b16 v[88:89], v16 offset:22528
    buffer_load_dwordx4 v15, s[20:23], s57 offen offset:0  lds
    v_mfma_f32_32x32x16_bf16 v[96:111], v[72:75], a[200:203], v[96:111]
    s_mov_b32 s57, 230400
    ds_read_b64_tr_b16 v[90:91], v16 offset:23040
    ds_read_b128 a[220:223], v229 offset:4096
    v_mfma_f32_32x32x16_bf16 v[112:127], v[72:75], a[204:207], v[112:127]
    s_add_u32 m0, s61, 81920
    ds_read_b64_tr_b16 v[92:93], v17 offset:22528
    ds_read_b64_tr_b16 v[94:95], v17 offset:23040
    buffer_load_dwordx4 v14, s[16:19], s57 offen offset:0  lds
    v_mfma_f32_32x32x16_bf16 v[128:143], v[76:79], a[200:203], v[128:143]
    s_add_u32 m0, s61, 86016
    s_nop 0
    buffer_load_dwordx4 v15, s[20:23], s57 offen offset:0  lds
    v_mfma_f32_32x32x16_bf16 v[144:159], v[76:79], a[204:207], v[144:159]
    s_waitcnt lgkmcnt(0)
    v_mfma_f32_32x32x16_bf16 v[96:111], v[80:83], a[208:211], v[96:111]
    s_waitcnt vmcnt(10)
    s_barrier
    ds_read_b128 a[224:227], v226 offset:32768
    ds_read_b64_tr_b16 v[64:65], v16 offset:49152
    v_mfma_f32_32x32x16_bf16 v[112:127], v[80:83], a[212:215], v[112:127]
    s_mov_b32 s57, 230912
    s_add_u32 m0, s60, 0
    ds_read_b64_tr_b16 v[66:67], v16 offset:49664
    ds_read_b128 a[228:231], v226 offset:36864
    buffer_load_dwordx4 v10, s[16:19], s57 offen offset:0  lds
    v_mfma_f32_32x32x16_bf16 v[128:143], v[84:87], a[208:211], v[128:143]
    ds_read_b64_tr_b16 v[68:69], v17 offset:49152
    ds_read_b64_tr_b16 v[70:71], v17 offset:49664
    buffer_load_dwordx4 v12, s[16:19], s57 offen offset:1024  lds
    v_mfma_f32_32x32x16_bf16 v[144:159], v[84:87], a[212:215], v[144:159]
    ds_read_b128 a[232:235], v227 offset:32768
    ds_read_b64_tr_b16 v[72:73], v16 offset:51200
    v_mfma_f32_32x32x16_bf16 v[96:111], v[88:91], a[216:219], v[96:111]
    s_add_u32 m0, s60, 8192
    ds_read_b64_tr_b16 v[74:75], v16 offset:51712
    ds_read_b128 a[236:239], v227 offset:36864
    buffer_load_dwordx4 v11, s[20:23], s57 offen offset:0  lds
    v_mfma_f32_32x32x16_bf16 v[112:127], v[88:91], a[220:223], v[112:127]
    ds_read_b64_tr_b16 v[76:77], v17 offset:51200
    ds_read_b64_tr_b16 v[78:79], v17 offset:51712
    v_mfma_f32_32x32x16_bf16 v[128:143], v[92:95], a[216:219], v[128:143]
    buffer_load_dwordx4 v13, s[20:23], s57 offen offset:1024  lds
    v_mfma_f32_32x32x16_bf16 v[144:159], v[92:95], a[220:223], v[144:159]
    s_mov_b32 s57, 459776
    s_waitcnt lgkmcnt(0)
    v_mfma_f32_32x32x16_bf16 v[96:111], v[64:67], a[224:227], v[96:111]
    s_add_u32 m0, s61, 90112
    ds_read_b128 a[240:243], v228 offset:32768
    ds_read_b64_tr_b16 v[80:81], v16 offset:53248
    buffer_load_dwordx4 v14, s[16:19], s57 offen offset:0  lds
    v_mfma_f32_32x32x16_bf16 v[112:127], v[64:67], a[228:231], v[112:127]
    ds_read_b64_tr_b16 v[82:83], v16 offset:53760
    ds_read_b128 a[244:247], v228 offset:36864
    s_waitcnt vmcnt(14)
    v_cmp_ne_u32 vcc, s49, v41
    s_cbranch_vccnz L_B_again_6
L_B_ok_5:
    v_sub_f32 v41, 1.0, v40
    v_cvt_pk_bf16_f32 v41, v41, v41
    v_mfma_f32_32x32x16_bf16 v[128:143], v[68:71], a[224:227], v[128:143]
    s_add_u32 m0, s61, 94208
    ds_read_b64_tr_b16 v[84:85], v17 offset:53248
    ds_read_b64_tr_b16 v[86:87], v17 offset:53760
    buffer_load_dwordx4 v15, s[20:23], s57 offen offset:0  lds
    v_and_b32 v41, 0xffff0000, v41
    v_mfma_f32_32x32x16_bf16 v[144:159], v[68:71], a[228:231], v[144:159]
    s_mov_b32 s57, 689152
    ds_read_b128 a[248:251], v229 offset:32768
    ds_read_b64_tr_b16 v[88:89], v16 offset:55296
    v_max_f32 v41, 0x0da24260, v41
    v_rcp_f32_e64 v41, v41
    v_mfma_f32_32x32x16_bf16 v[96:111], v[72:75], a[232:235], v[96:111]
    s_add_u32 m0, s61, 16384
    ds_read_b64_tr_b16 v[90:91], v16 offset:55808
    ds_read_b128 a[252:255], v229 offset:36864
    buffer_load_dwordx4 v14, s[16:19], s57 offen offset:0  lds
    v_mfma_f32_32x32x16_bf16 v[112:127], v[72:75], a[236:239], v[112:127]
    ds_read_b64_tr_b16 v[92:93], v17 offset:55296
    ds_read_b64_tr_b16 v[94:95], v17 offset:55808
    s_waitcnt vmcnt(15)
    v_cmp_ne_u32 vcc, s49, v43
    s_cbranch_vccnz L_B_again_8
L_B_ok_7:
    v_sub_f32 v43, 1.0, v42
    v_cvt_pk_bf16_f32 v43, v43, v43
    v_mfma_f32_32x32x16_bf16 v[128:143], v[76:79], a[232:235], v[128:143]
    s_add_u32 m0, s61, 20480
    s_nop 0
    buffer_load_dwordx4 v15, s[20:23], s57 offen offset:0  lds
    v_and_b32 v43, 0xffff0000, v43
    v_max_f32 v43, 0x0da24260, v43
    v_mfma_f32_32x32x16_bf16 v[144:159], v[76:79], a[236:239], v[144:159]
    v_rcp_f32 v43, v43
    s_waitcnt lgkmcnt(0)
    v_mfma_f32_32x32x16_bf16 v[96:111], v[80:83], a[240:243], v[96:111]
    s_waitcnt vmcnt(8)
    s_barrier
    ds_read_b64_tr_b16 v[64:65], v36 offset:16384
    ds_read_b64_tr_b16 v[66:67], v36 offset:16640
    v_mfma_f32_32x32x16_bf16 v[112:127], v[80:83], a[244:247], v[112:127]
    s_mov_b32 s57, 460288
    s_add_u32 m0, s60, 32768
    ds_read_b64_tr_b16 v[68:69], v34 offset:0
    buffer_load_dwordx4 v10, s[16:19], s57 offen offset:0  lds
    v_mfma_f32_32x32x16_bf16 v[128:143], v[84:87], a[240:243], v[128:143]
    ds_read_b64_tr_b16 v[70:71], v34 offset:512
    v_mfma_f32_32x32x16_bf16 v[144:159], v[84:87], a[244:247], v[144:159]
    ds_read_b64_tr_b16 v[72:73], v35 offset:0
    ds_read_b64_tr_b16 v[74:75], v35 offset:512
    v_mfma_f32_32x32x16_bf16 v[96:111], v[88:91], a[248:251], v[96:111]
    ds_read_b64_tr_b16 v[76:77], v36 offset:17408
    buffer_load_dwordx4 v12, s[16:19], s57 offen offset:1024  lds
    v_mfma_f32_32x32x16_bf16 v[112:127], v[88:91], a[252:255], v[112:127]
    ds_read_b64_tr_b16 v[78:79], v36 offset:17664
    v_mfma_f32_32x32x16_bf16 v[128:143], v[92:95], a[248:251], v[128:143]
    v_mfma_f32_32x32x16_bf16 v[144:159], v[92:95], a[252:255], v[144:159]
    s_add_u32 m0, s60, 40960
    s_nop 0
    buffer_load_dwordx4 v11, s[20:23], s57 offen offset:0  lds
    s_waitcnt lgkmcnt(0)
    v_mfma_f32_32x32x16_bf16 v[160:175], v[64:67], a[0:3], 0
    ds_read_b64_tr_b16 v[80:81], v36 offset:18432
    ds_read_b64_tr_b16 v[82:83], v36 offset:18688
    v_mfma_f32_32x32x16_bf16 v[176:191], v[64:67], a[4:7], 0
    ds_read_b64_tr_b16 v[84:85], v34 offset:2048
    v_mul_f32 v2, v96, v96
    v_mul_f32 v3, v97, v97
    v_mul_f32 v4, v98, v98
    v_mul_f32_e64 v5, v99, v99
    v_fmaak_f32 v2, v2, v33, 0xc0135761
    v_mfma_f32_32x32x16_bf16 v[192:207], v[68:71], a[0:3], 0
    ds_read_b64_tr_b16 v[86:87], v34 offset:2560
    buffer_load_dwordx4 v13, s[20:23], s57 offen offset:1024  lds
    v_fmaak_f32 v3, v3, v33, 0xc0135761
    v_fmaak_f32 v4, v4, v33, 0xc0135761
    v_mfma_f32_32x32x16_bf16 v[208:223], v[68:71], a[4:7], 0
    ds_read_b64_tr_b16 v[88:89], v35 offset:2048
    ds_read_b64_tr_b16 v[90:91], v35 offset:2560
    v_fmaak_f32 v5, v5, v33, 0xc0135761
    v_mul_f32 v2, v2, v96
    v_mul_f32 v3, v3, v97
    v_mul_f32_e64 v4, v4, v98
    v_mfma_f32_32x32x16_bf16 v[224:239], v[72:75], a[0:3], 0
    s_mov_b32 s57, 918528
    ds_read_b64_tr_b16 v[92:93], v36 offset:19456
    v_mul_f32 v5, v5, v99
    v_exp_f32 v2, v2
    v_exp_f32_e64 v3, v3
    v_mfma_f32_32x32x16_bf16 v[240:255], v[72:75], a[4:7], 0
    s_add_u32 m0, s61, 24576
    ds_read_b64_tr_b16 v[94:95], v36 offset:19712
    buffer_load_dwordx4 v14, s[16:19], s57 offen offset:0  lds
    v_exp_f32_e64 v4, v4
    v_mfma_f32_32x32x16_bf16 v[160:175], v[76:79], a[8:11], v[160:175]
    v_exp_f32 v5, v5
    v_mul_f32 v104, v104, v96
    v_mul_f32 v105, v105, v97
    v_mul_f32 v106, v106, v98
    v_mul_f32_e64 v107, v107, v99
    v_mfma_f32_32x32x16_bf16 v[176:191], v[76:79], a[12:15], v[176:191]
    v_fma_f32 v2, v2, v41, v41
    v_fma_f32 v3, v3, v41, v41
    v_fma_f32 v4, v4, v41, v41
    v_fma_f32 v5, v5, v41, v41
    v_rcp_f32 v2, v2
    s_waitcnt lgkmcnt(0)
    v_mfma_f32_32x32x16_bf16 v[160:175], v[80:83], a[16:19], v[160:175]
    s_add_u32 m0, s61, 28672
    ds_read_b64_tr_b16 v[64:65], v37 offset:16384
    ds_read_b64_tr_b16 v[66:67], v37 offset:16640
    buffer_load_dwordx4 v15, s[20:23], s57 offen offset:0  lds
    v_mfma_f32_32x32x16_bf16 v[176:191], v[80:83], a[20:23], v[176:191]
    ds_read_b64_tr_b16 v[68:69], v34 offset:4096
    v_rcp_f32 v3, v3
    v_rcp_f32 v4, v4
    v_mfma_f32_32x32x16_bf16 v[192:207], v[84:87], a[8:11], v[192:207]
    s_mov_b32 s57, 1147904
    ds_read_b64_tr_b16 v[70:71], v34 offset:4608
    v_rcp_f32 v5, v5
    v_mul_f32 v104, v104, v2
    v_mul_f32 v105, v105, v3
    v_mul_f32 v106, v106, v4
    v_mfma_f32_32x32x16_bf16 v[208:223], v[84:87], a[12:15], v[208:223]
    s_add_u32 m0, s61, 49152
    ds_read_b64_tr_b16 v[72:73], v35 offset:4096
    ds_read_b64_tr_b16 v[74:75], v35 offset:4608
    buffer_load_dwordx4 v14, s[16:19], s57 offen offset:0  lds
    v_mul_f32_e64 v107, v107, v5
    v_mfma_f32_32x32x16_bf16 v[224:239], v[88:91], a[8:11], v[224:239]
    ds_read_b64_tr_b16 v[76:77], v37 offset:17408
    v_cvt_pk_bf16_f32 v96, v104, v105
    v_cvt_pk_bf16_f32 v97, v106, v107
    v_mul_f32 v2, v100, v100
    v_mul_f32 v3, v101, v101
    v_mul_f32_e64 v4, v102, v102
    v_mfma_f32_32x32x16_bf16 v[240:255], v[88:91], a[12:15], v[240:255]
    ds_read_b64_tr_b16 v[78:79], v37 offset:17664
    v_mul_f32_e64 v5, v103, v103
    v_fmaak_f32 v2, v2, v33, 0xc0135761
    v_fmaak_f32 v3, v3, v33, 0xc0135761
    v_fmaak_f32 v4, v4, v33, 0xc0135761
    v_fmaak_f32 v5, v5, v33, 0xc0135761
    v_mfma_f32_32x32x16_bf16 v[160:175], v[92:95], a[24:27], v[160:175]
    s_add_u32 m0, s61, 53248
    s_nop 0
    buffer_load_dwordx4 v15, s[20:23], s57 offen offset:0  lds
    v_mul_f32 v2, v2, v100
    v_mul_f32 v3, v3, v101
    v_mul_f32 v4, v4, v102
    v_mfma_f32_32x32x16_bf16 v[176:191], v[92:95], a[28:31], v[176:191]
    v_mul_f32 v5, v5, v103
    v_exp_f32 v2, v2
    v_exp_f32 v3, v3
    s_waitcnt lgkmcnt(0)
    v_mfma_f32_32x32x16_bf16 v[160:175], v[64:67], a[32:35], v[160:175]
    s_lshl4_add_u32 s57, s93, 0
    ds_read_b64_tr_b16 v[80:81], v37 offset:18432
    ds_read_b64_tr_b16 v[82:83], v37 offset:18688
    v_exp_f32 v4, v4
    v_exp_f32_e64 v5, v5
    v_mfma_f32_32x32x16_bf16 v[176:191], v[64:67], a[36:39], v[176:191]
    s_add_u32 m0, s60, 57344
    ds_read_b64_tr_b16 v[84:85], v34 offset:6144
    buffer_load_dwordx4 v22, s[24:27], s57 offen offset:0  lds
    v_mul_f32 v108, v108, v100
    v_mul_f32 v109, v109, v101
    v_mfma_f32_32x32x16_bf16 v[192:207], v[68:71], a[16:19], v[192:207]
    ds_read_b64_tr_b16 v[86:87], v34 offset:6656
    v_mul_f32 v110, v110, v102
    v_mul_f32 v111, v111, v103
    v_fma_f32 v2, v2, v41, v41
    v_fma_f32 v3, v3, v41, v41
    v_fma_f32 v4, v4, v41, v41
    v_mfma_f32_32x32x16_bf16 v[208:223], v[68:71], a[20:23], v[208:223]
    ds_read_b64_tr_b16 v[88:89], v35 offset:6144
    ds_read_b64_tr_b16 v[90:91], v35 offset:6656
    v_fma_f32 v5, v5, v41, v41
    v_rcp_f32_e64 v2, v2
    v_mfma_f32_32x32x16_bf16 v[224:239], v[72:75], a[16:19], v[224:239]
    ds_read_b64_tr_b16 v[92:93], v37 offset:19456
    buffer_load_dwordx4 v24, s[24:27], s57 offen offset:1024  lds
    v_rcp_f32_e64 v3, v3
    v_mfma_f32_32x32x16_bf16 v[240:255], v[72:75], a[20:23], v[240:255]
    ds_read_b64_tr_b16 v[94:95], v37 offset:19712
    v_rcp_f32 v4, v4
    v_rcp_f32 v5, v5
    v_mul_f32_e64 v108, v108, v2
    v_mfma_f32_32x32x16_bf16 v[160:175], v[76:79], a[40:43], v[160:175]
    v_mul_f32 v109, v109, v3
    v_mul_f32 v110, v110, v4
    v_mul_f32_e64 v111, v111, v5
    v_cvt_pk_bf16_f32 v98, v108, v109
    v_cvt_pk_bf16_f32 v99, v110, v111
    v_mfma_f32_32x32x16_bf16 v[176:191], v[76:79], a[44:47], v[176:191]
    buffer_store_dwordx4 v[96:99], v29, s[32:35], s65 offen offset:0 sc1
    v_mul_f32 v2, v112, v112
    v_mul_f32 v3, v113, v113
    v_mul_f32 v4, v114, v114
    s_waitcnt lgkmcnt(0)
    v_mfma_f32_32x32x16_bf16 v[160:175], v[80:83], a[48:51], v[160:175]
    s_waitcnt vmcnt(11)
    s_barrier
    ds_read_b64_tr_b16 v[64:65], v37 offset:24576
    ds_read_b64_tr_b16 v[66:67], v37 offset:24832
    v_mul_f32_e64 v5, v115, v115
    v_fmaak_f32 v2, v2, v33, 0xc0135761
    v_mfma_f32_32x32x16_bf16 v[176:191], v[80:83], a[52:55], v[176:191]
    s_mov_b32 s57, 689664
    s_add_u32 m0, s60, 65536
    ds_read_b64_tr_b16 v[68:69], v16 offset:0
    buffer_load_dwordx4 v10, s[16:19], s57 offen offset:0  lds
    v_fmaak_f32 v3, v3, v33, 0xc0135761
    v_mfma_f32_32x32x16_bf16 v[192:207], v[84:87], a[24:27], v[192:207]
    ds_read_b64_tr_b16 v[70:71], v16 offset:512
    v_fmaak_f32 v4, v4, v33, 0xc0135761
    v_fmaak_f32 v5, v5, v33, 0xc0135761
    v_mul_f32 v2, v2, v112
    v_mul_f32 v3, v3, v113
    v_mul_f32_e64 v4, v4, v114
    v_mfma_f32_32x32x16_bf16 v[208:223], v[84:87], a[28:31], v[208:223]
    ds_read_b64_tr_b16 v[72:73], v17 offset:0
    ds_read_b64_tr_b16 v[74:75], v17 offset:512
    v_mul_f32 v5, v5, v115
    v_exp_f32 v2, v2
    v_mfma_f32_32x32x16_bf16 v[224:239], v[88:91], a[24:27], v[224:239]
    ds_read_b64_tr_b16 v[76:77], v37 offset:25600
    buffer_load_dwordx4 v12, s[16:19], s57 offen offset:1024  lds
    v_exp_f32_e64 v3, v3
    v_mfma_f32_32x32x16_bf16 v[240:255], v[88:91], a[28:31], v[240:255]
    ds_read_b64_tr_b16 v[78:79], v37 offset:25856
    v_exp_f32 v4, v4
    v_exp_f32 v5, v5
    v_mul_f32_e64 v120, v120, v112
    v_mfma_f32_32x32x16_bf16 v[160:175], v[92:95], a[56:59], v[160:175]
    v_mul_f32 v121, v121, v113
    v_mul_f32 v122, v122, v114
    v_mul_f32_e64 v123, v123, v115
    v_fma_f32 v2, v2, v43, v43
    v_fma_f32 v3, v3, v43, v43
    v_fma_f32 v4, v4, v43, v43
    v_mfma_f32_32x32x16_bf16 v[176:191], v[92:95], a[60:63], v[176:191]
    s_add_u32 m0, s60, 73728
    s_nop 0
    buffer_load_dwordx4 v11, s[20:23], s57 offen offset:0  lds
    v_fma_f32 v5, v5, v43, v43
    v_rcp_f32 v2, v2
    s_waitcnt lgkmcnt(0)
    v_mfma_f32_32x32x16_bf16 v[160:175], v[64:67], a[64:67], v[160:175]
    ds_read_b64_tr_b16 v[80:81], v37 offset:26624
    ds_read_b64_tr_b16 v[82:83], v37 offset:26880
    v_rcp_f32 v3, v3
    v_rcp_f32_e64 v4, v4
    v_mfma_f32_32x32x16_bf16 v[176:191], v[64:67], a[68:71], v[176:191]
    ds_read_b64_tr_b16 v[84:85], v16 offset:2048
    v_rcp_f32 v5, v5
    v_mul_f32 v120, v120, v2
    v_mul_f32 v121, v121, v3
    v_mul_f32 v122, v122, v4
    v_mfma_f32_32x32x16_bf16 v[192:207], v[68:71], a[32:35], v[192:207]
    ds_read_b64_tr_b16 v[86:87], v16 offset:2560
    buffer_load_dwordx4 v13, s[20:23], s57 offen offset:1024  lds
    v_mul_f32_e64 v123, v123, v5
    v_cvt_pk_bf16_f32 v112, v120, v121
    v_mfma_f32_32x32x16_bf16 v[208:223], v[68:71], a[36:39], v[208:223]
    ds_read_b64_tr_b16 v[88:89], v17 offset:2048
    ds_read_b64_tr_b16 v[90:91], v17 offset:2560
    v_cvt_pk_bf16_f32 v113, v122, v123
    v_mul_f32 v2, v116, v116
    v_mul_f32 v3, v117, v117
    v_mul_f32_e64 v4, v118, v118
    v_mfma_f32_32x32x16_bf16 v[224:239], v[72:75], a[32:35], v[224:239]
    s_mov_b32 s57, 1377280
    ds_read_b64_tr_b16 v[92:93], v37 offset:27648
    v_mul_f32_e64 v5, v119, v119
    v_fmaak_f32 v2, v2, v33, 0xc0135761
    v_fmaak_f32 v3, v3, v33, 0xc0135761
    v_fmaak_f32 v4, v4, v33, 0xc0135761
    v_fmaak_f32 v5, v5, v33, 0xc0135761
    v_mfma_f32_32x32x16_bf16 v[240:255], v[72:75], a[36:39], v[240:255]
    s_add_u32 m0, s61, 81920
    ds_read_b64_tr_b16 v[94:95], v37 offset:27904
L_islB2:
    s_cbranch_execz L_retB
    buffer_load_dwordx4 v14, s[16:19], s57 offen offset:0  lds
    v_mul_f32 v2, v2, v116
    v_mul_f32_e64 v3, v3, v117
    v_mfma_f32_32x32x16_bf16 v[160:175], v[76:79], a[72:75], v[160:175]
    v_mul_f32 v4, v4, v118
    v_mul_f32 v5, v5, v119
    v_exp_f32 v2, v2
    v_exp_f32 v3, v3
    v_mfma_f32_32x32x16_bf16 v[176:191], v[76:79], a[76:79], v[176:191]
    v_exp_f32 v4, v4
    v_exp_f32 v5, v5
    v_mul_f32 v124, v124, v116
    v_mul_f32 v125, v125, v117
    s_waitcnt lgkmcnt(0)
    v_mfma_f32_32x32x16_bf16 v[160:175], v[80:83], a[80:83], v[160:175]
    s_add_u32 m0, s61, 86016
    ds_read_b64_tr_b16 v[64:65], v20 offset:16384
    ds_read_b64_tr_b16 v[66:67], v20 offset:16640
    buffer_load_dwordx4 v15, s[20:23], s57 offen offset:0  lds
    v_mul_f32 v126, v126, v118
    v_mfma_f32_32x32x16_bf16 v[176:191], v[80:83], a[84:87], v[176:191]
    ds_read_b64_tr_b16 v[68:69], v16 offset:4096
    v_mul_f32_e64 v127, v127, v119
    v_fma_f32 v2, v2, v43, v43
    v_fma_f32 v3, v3, v43, v43
    v_fma_f32 v4, v4, v43, v43
    v_fma_f32 v5, v5, v43, v43
    v_mfma_f32_32x32x16_bf16 v[192:207], v[84:87], a[40:43], v[192:207]
    s_mov_b32 s57, 1606656
    ds_read_b64_tr_b16 v[70:71], v16 offset:4608
    v_rcp_f32 v2, v2
    v_rcp_f32 v3, v3
    v_mfma_f32_32x32x16_bf16 v[208:223], v[84:87], a[44:47], v[208:223]
    s_add_u32 m0, s61, 147456
    ds_read_b64_tr_b16 v[72:73], v17 offset:4096
    ds_read_b64_tr_b16 v[74:75], v17 offset:4608
    buffer_load_dwordx4 v14, s[16:19], s57 offen offset:0  lds
    v_mfma_f32_32x32x16_bf16 v[224:239], v[88:91], a[40:43], v[224:239]
    ds_read_b64_tr_b16 v[76:77], v20 offset:17408
    v_rcp_f32 v4, v4
    v_rcp_f32 v5, v5
    v_mul_f32_e64 v124, v124, v2
    v_mfma_f32_32x32x16_bf16 v[240:255], v[88:91], a[44:47], v[240:255]
    ds_read_b64_tr_b16 v[78:79], v20 offset:17664
    v_mul_f32 v125, v125, v3
    v_mul_f32 v126, v126, v4
    v_mul_f32_e64 v127, v127, v5
    v_cvt_pk_bf16_f32 v114, v124, v125
    v_cvt_pk_bf16_f32 v115, v126, v127
    v_mfma_f32_32x32x16_bf16 v[160:175], v[92:95], a[88:91], v[160:175]
    s_add_u32 m0, s61, 151552
    s_nop 0
    buffer_load_dwordx4 v15, s[20:23], s57 offen offset:0  lds
    buffer_store_dwordx4 v[112:115], v30, s[32:35], s65 offen offset:0 sc1
    v_mul_f32 v2, v128, v128
    v_mfma_f32_32x32x16_bf16 v[176:191], v[92:95], a[92:95], v[176:191]
    v_mul_f32 v3, v129, v129
    v_mul_f32 v4, v130, v130
    v_mul_f32_e64 v5, v131, v131
    v_fmaak_f32 v2, v2, v33, 0xc0135761
    v_fmaak_f32 v3, v3, v33, 0xc0135761
    v_fmaak_f32 v4, v4, v33, 0xc0135761
    s_waitcnt lgkmcnt(0)
    v_mfma_f32_32x32x16_bf16 v[160:175], v[64:67], a[96:99], v[160:175]
    s_lshl4_add_u32 s57, s94, 0
    ds_read_b64_tr_b16 v[80:81], v20 offset:18432
    ds_read_b64_tr_b16 v[82:83], v20 offset:18688
    v_fmaak_f32 v5, v5, v33, 0xc0135761
    v_mul_f32 v2, v2, v128
    v_mul_f32 v3, v3, v129
    v_mul_f32_e64 v4, v4, v130
    v_mfma_f32_32x32x16_bf16 v[176:191], v[64:67], a[100:103], v[176:191]
    s_add_u32 m0, s60, 139264
    ds_read_b64_tr_b16 v[84:85], v16 offset:6144
    buffer_load_dwordx4 v22, s[24:27], s57 offen offset:0  lds
    v_mul_f32_e64 v5, v5, v131
    v_mfma_f32_32x32x16_bf16 v[192:207], v[68:71], a[48:51], v[192:207]
    ds_read_b64_tr_b16 v[86:87], v16 offset:6656
    v_exp_f32 v2, v2
    v_exp_f32 v3, v3
    v_mfma_f32_32x32x16_bf16 v[208:223], v[68:71], a[52:55], v[208:223]
    ds_read_b64_tr_b16 v[88:89], v17 offset:6144
    ds_read_b64_tr_b16 v[90:91], v17 offset:6656
    v_exp_f32 v4, v4
    v_exp_f32 v5, v5
    v_mfma_f32_32x32x16_bf16 v[224:239], v[72:75], a[48:51], v[224:239]
    ds_read_b64_tr_b16 v[92:93], v20 offset:19456
    buffer_load_dwordx4 v24, s[24:27], s57 offen offset:1024  lds
    v_mul_f32 v136, v136, v128
    v_mul_f32 v137, v137, v129
    v_mfma_f32_32x32x16_bf16 v[240:255], v[72:75], a[52:55], v[240:255]
    ds_read_b64_tr_b16 v[94:95], v20 offset:19712
    v_mul_f32 v138, v138, v130
    v_mul_f32 v139, v139, v131
    v_fma_f32 v2, v2, v41, v41
    v_fma_f32 v3, v3, v41, v41
    v_fma_f32 v4, v4, v41, v41
    v_mfma_f32_32x32x16_bf16 v[160:175], v[76:79], a[104:107], v[160:175]
    v_fma_f32 v5, v5, v41, v41
    v_rcp_f32 v2, v2
    v_rcp_f32 v3, v3
    v_mfma_f32_32x32x16_bf16 v[176:191], v[76:79], a[108:111], v[176:191]
    v_rcp_f32 v4, v4
    v_rcp_f32 v5, v5
    v_mul_f32 v136, v136, v2
    v_mul_f32 v137, v137, v3
    s_waitcnt lgkmcnt(0)
    v_mfma_f32_32x32x16_bf16 v[160:175], v[80:83], a[112:115], v[160:175]
    s_waitcnt vmcnt(14)
    s_barrier
    ds_read_b64_tr_b16 v[64:65], v20 offset:24576
    ds_read_b64_tr_b16 v[66:67], v20 offset:24832
    v_mul_f32 v138, v138, v4
    v_mul_f32_e64 v139, v139, v5
    v_mfma_f32_32x32x16_bf16 v[176:191], v[80:83], a[116:119], v[176:191]
    s_mov_b32 s57, 919040
    s_add_u32 m0, s60, 0
    ds_read_b64_tr_b16 v[68:69], v16 offset:32768
    buffer_load_dwordx4 v10, s[16:19], s57 offen offset:0  lds
    v_cvt_pk_bf16_f32 v128, v136, v137
    v_mfma_f32_32x32x16_bf16 v[192:207], v[84:87], a[56:59], v[192:207]
    ds_read_b64_tr_b16 v[70:71], v16 offset:33280
    v_cvt_pk_bf16_f32 v129, v138, v139
    v_mul_f32 v2, v132, v132
    v_mul_f32 v3, v133, v133
    v_mul_f32 v4, v134, v134
    v_mul_f32_e64 v5, v135, v135
    v_mfma_f32_32x32x16_bf16 v[208:223], v[84:87], a[60:63], v[208:223]
    ds_read_b64_tr_b16 v[72:73], v17 offset:32768
    ds_read_b64_tr_b16 v[74:75], v17 offset:33280
    v_fmaak_f32 v2, v2, v33, 0xc0135761
    v_fmaak_f32 v3, v3, v33, 0xc0135761
    v_fmaak_f32 v4, v4, v33, 0xc0135761
    v_fmaak_f32 v5, v5, v33, 0xc0135761
    v_mfma_f32_32x32x16_bf16 v[224:239], v[88:91], a[56:59], v[224:239]
    ds_read_b64_tr_b16 v[76:77], v20 offset:25600
    buffer_load_dwordx4 v12, s[16:19], s57 offen offset:1024  lds
    v_mul_f32 v2, v2, v132
    v_mul_f32 v3, v3, v133
    v_mfma_f32_32x32x16_bf16 v[240:255], v[88:91], a[60:63], v[240:255]
    ds_read_b64_tr_b16 v[78:79], v20 offset:25856
    v_mul_f32 v4, v4, v134
    v_mul_f32 v5, v5, v135
    v_exp_f32_e64 v2, v2
    v_mfma_f32_32x32x16_bf16 v[160:175], v[92:95], a[120:123], v[160:175]
    v_exp_f32 v3, v3
    v_exp_f32 v4, v4
    v_exp_f32_e64 v5, v5
    v_mfma_f32_32x32x16_bf16 v[176:191], v[92:95], a[124:127], v[176:191]
    s_add_u32 m0, s60, 8192
    s_nop 0
    buffer_load_dwordx4 v11, s[20:23], s57 offen offset:0  lds
    v_mul_f32 v140, v140, v132
    v_mul_f32 v141, v141, v133
    v_mul_f32 v142, v142, v134
    s_waitcnt lgkmcnt(0)
    v_mfma_f32_32x32x16_bf16 v[160:175], v[64:67], a[128:131], v[160:175]
    ds_read_b64_tr_b16 v[80:81], v20 offset:26624
    ds_read_b64_tr_b16 v[82:83], v20 offset:26880
    v_mul_f32 v143, v143, v135
    v_fma_f32 v2, v2, v41, v41
    v_fma_f32 v3, v3, v41, v41
    v_fma_f32 v4, v4, v41, v41
    v_mfma_f32_32x32x16_bf16 v[176:191], v[64:67], a[132:135], v[176:191]
    ds_read_b64_tr_b16 v[84:85], v16 offset:34816
    v_fma_f32 v5, v5, v41, v41
    v_rcp_f32 v2, v2
    v_rcp_f32 v3, v3
    v_mfma_f32_32x32x16_bf16 v[192:207], v[68:71], a[64:67], v[192:207]
    ds_read_b64_tr_b16 v[86:87], v16 offset:35328
    buffer_load_dwordx4 v13, s[20:23], s57 offen offset:1024  lds
    v_rcp_f32_e64 v4, v4
    v_mfma_f32_32x32x16_bf16 v[208:223], v[68:71], a[68:71], v[208:223]
    ds_read_b64_tr_b16 v[88:89], v17 offset:34816
    ds_read_b64_tr_b16 v[90:91], v17 offset:35328
    v_rcp_f32 v5, v5
    v_mul_f32 v140, v140, v2
    v_mul_f32_e64 v141, v141, v3
    v_mfma_f32_32x32x16_bf16 v[224:239], v[72:75], a[64:67], v[224:239]
    s_lshl4_add_u32 s57, s95, 0
    ds_read_b64_tr_b16 v[92:93], v20 offset:27648
    v_mul_f32 v142, v142, v4
    v_mul_f32_e64 v143, v143, v5
    v_cvt_pk_bf16_f32 v130, v140, v141
    v_cvt_pk_bf16_f32 v131, v142, v143
    v_mfma_f32_32x32x16_bf16 v[240:255], v[72:75], a[68:71], v[240:255]
    s_add_u32 m0, s60, 131072
    ds_read_b64_tr_b16 v[94:95], v20 offset:27904
    buffer_load_dwordx4 v22, s[24:27], s57 offen offset:0  lds
    buffer_store_dwordx4 v[128:131], v29, s[32:35], s65 offen offset:1024 sc1
    v_mfma_f32_32x32x16_bf16 v[160:175], v[76:79], a[136:139], v[160:175]
    v_mul_f32 v2, v144, v144
    v_mul_f32 v3, v145, v145
    v_mul_f32 v4, v146, v146
    v_mul_f32 v5, v147, v147
    v_fmaak_f32 v2, v2, v33, 0xc0135761
    v_fmaak_f32 v3, v3, v33, 0xc0135761
    v_mfma_f32_32x32x16_bf16 v[176:191], v[76:79], a[140:143], v[176:191]
    v_fmaak_f32 v4, v4, v33, 0xc0135761
    v_fmaak_f32 v5, v5, v33, 0xc0135761
    v_mul_f32 v2, v2, v144
    v_mul_f32 v3, v3, v145
    v_mul_f32 v4, v4, v146
    v_mul_f32 v5, v5, v147
    s_waitcnt lgkmcnt(0)
    v_mfma_f32_32x32x16_bf16 v[160:175], v[80:83], a[144:147], v[160:175]
    ds_read_b64_tr_b16 v[64:65], v20 offset:49152
    ds_read_b64_tr_b16 v[66:67], v20 offset:49408
    buffer_load_dwordx4 v24, s[24:27], s57 offen offset:1024  lds
    v_mfma_f32_32x32x16_bf16 v[176:191], v[80:83], a[148:151], v[176:191]
    ds_read_b64_tr_b16 v[68:69], v16 offset:36864
    v_exp_f32 v2, v2
    v_exp_f32_e64 v3, v3
    v_mfma_f32_32x32x16_bf16 v[192:207], v[84:87], a[72:75], v[192:207]
    s_lshl4_add_u32 s57, s96, 0
    ds_read_b64_tr_b16 v[70:71], v16 offset:37376
    v_exp_f32 v4, v4
    v_exp_f32 v5, v5
    v_mul_f32 v152, v152, v144
    v_mfma_f32_32x32x16_bf16 v[208:223], v[84:87], a[76:79], v[208:223]
    s_add_u32 m0, s60, 90112
    ds_read_b64_tr_b16 v[72:73], v17 offset:36864
    ds_read_b64_tr_b16 v[74:75], v17 offset:37376
    buffer_load_dwordx4 v22, s[24:27], s57 offen offset:0  lds
    v_mul_f32_e64 v153, v153, v145
    v_mfma_f32_32x32x16_bf16 v[224:239], v[88:91], a[72:75], v[224:239]
    ds_read_b64_tr_b16 v[76:77], v20 offset:50176
    v_mul_f32 v154, v154, v146
    v_mul_f32 v155, v155, v147
    v_fma_f32 v2, v2, v43, v43
    v_fma_f32 v3, v3, v43, v43
    v_fma_f32 v4, v4, v43, v43
    v_mfma_f32_32x32x16_bf16 v[240:255], v[88:91], a[76:79], v[240:255]
    ds_read_b64_tr_b16 v[78:79], v20 offset:50432
    v_fma_f32 v5, v5, v43, v43
    v_rcp_f32 v2, v2
    v_rcp_f32 v3, v3
    v_mfma_f32_32x32x16_bf16 v[160:175], v[92:95], a[152:155], v[160:175]
    buffer_load_dwordx4 v24, s[24:27], s57 offen offset:1024  lds
    v_rcp_f32_e64 v4, v4
    v_mfma_f32_32x32x16_bf16 v[176:191], v[92:95], a[156:159], v[176:191]
    v_rcp_f32 v5, v5
    v_mul_f32 v152, v152, v2
    v_mul_f32 v153, v153, v3
    v_mul_f32 v154, v154, v4
    v_mul_f32 v155, v155, v5
    s_waitcnt lgkmcnt(0)
    v_mfma_f32_32x32x16_bf16 v[160:175], v[64:67], a[160:163], v[160:175]
    s_lshl4_add_u32 s57, s97, 0
    ds_read_b64_tr_b16 v[80:81], v20 offset:51200
    ds_read_b64_tr_b16 v[82:83], v20 offset:51456
    v_cvt_pk_bf16_f32 v144, v152, v153
    v_cvt_pk_bf16_f32 v145, v154, v155
    v_mul_f32 v2, v148, v148
    v_mul_f32_e64 v3, v149, v149
    v_mfma_f32_32x32x16_bf16 v[176:191], v[64:67], a[164:167], v[176:191]
    s_add_u32 m0, s60, 16384
    ds_read_b64_tr_b16 v[84:85], v16 offset:38912
    buffer_load_dwordx4 v22, s[24:27], s57 offen offset:0  lds
    v_mul_f32 v4, v150, v150
    v_mul_f32 v5, v151, v151
    v_mfma_f32_32x32x16_bf16 v[192:207], v[68:71], a[80:83], v[192:207]
    ds_read_b64_tr_b16 v[86:87], v16 offset:39424
    v_fmaak_f32 v2, v2, v33, 0xc0135761
    v_fmaak_f32 v3, v3, v33, 0xc0135761
    v_fmaak_f32 v4, v4, v33, 0xc0135761
    v_fmaak_f32 v5, v5, v33, 0xc0135761
    v_mul_f32_e64 v2, v2, v148
    v_mfma_f32_32x32x16_bf16 v[208:223], v[68:71], a[84:87], v[208:223]
    ds_read_b64_tr_b16 v[88:89], v17 offset:38912
    ds_read_b64_tr_b16 v[90:91], v17 offset:39424
    v_mul_f32 v3, v3, v149
    v_mul_f32 v4, v4, v150
    v_mul_f32_e64 v5, v5, v151
    v_mfma_f32_32x32x16_bf16 v[224:239], v[72:75], a[80:83], v[224:239]
    ds_read_b64_tr_b16 v[92:93], v20 offset:52224
    buffer_load_dwordx4 v24, s[24:27], s57 offen offset:1024  lds
    v_exp_f32_e64 v2, v2
    v_mfma_f32_32x32x16_bf16 v[240:255], v[72:75], a[84:87], v[240:255]
    ds_read_b64_tr_b16 v[94:95], v20 offset:52480
    v_exp_f32 v3, v3
    v_exp_f32 v4, v4
    v_mfma_f32_32x32x16_bf16 v[160:175], v[76:79], a[168:171], v[160:175]
    v_exp_f32 v5, v5
    v_mul_f32 v156, v156, v148
    v_mul_f32 v157, v157, v149
    v_mul_f32 v158, v158, v150
    v_mul_f32_e64 v159, v159, v151
    v_mfma_f32_32x32x16_bf16 v[176:191], v[76:79], a[172:175], v[176:191]
    v_fma_f32 v2, v2, v43, v43
    v_fma_f32 v3, v3, v43, v43
    v_fma_f32 v4, v4, v43, v43
    v_fma_f32 v5, v5, v43, v43
    v_rcp_f32 v2, v2
    s_waitcnt lgkmcnt(0)
    v_mfma_f32_32x32x16_bf16 v[160:175], v[80:83], a[176:179], v[160:175]
    s_waitcnt vmcnt(14)
    s_barrier
    ds_read_b64_tr_b16 v[64:65], v37 offset:16384
    ds_read_b64_tr_b16 v[66:67], v37 offset:16640
    v_rcp_f32_e64 v3, v3
    v_mfma_f32_32x32x16_bf16 v[176:191], v[80:83], a[180:183], v[176:191]
    s_mov_b32 s57, 1148416
    s_add_u32 m0, s60, 32768
    ds_read_b64_tr_b16 v[68:69], v34 offset:0
    buffer_load_dwordx4 v10, s[16:19], s57 offen offset:0  lds
    v_mfma_f32_32x32x16_bf16 v[192:207], v[84:87], a[88:91], v[192:207]
    ds_read_b64_tr_b16 v[70:71], v34 offset:512
    v_rcp_f32 v4, v4
    v_rcp_f32 v5, v5
    v_mul_f32_e64 v156, v156, v2
    v_mfma_f32_32x32x16_bf16 v[208:223], v[84:87], a[92:95], v[208:223]
    ds_read_b64_tr_b16 v[72:73], v35 offset:0
    ds_read_b64_tr_b16 v[74:75], v35 offset:512
    v_mul_f32 v157, v157, v3
    v_mul_f32 v158, v158, v4
    v_mul_f32_e64 v159, v159, v5
    v_cvt_pk_bf16_f32 v146, v156, v157
    v_mfma_f32_32x32x16_bf16 v[224:239], v[88:91], a[88:91], v[224:239]
    ds_read_b64_tr_b16 v[76:77], v37 offset:17408
    buffer_load_dwordx4 v12, s[16:19], s57 offen offset:1024  lds
    v_cvt_pk_bf16_f32 v147, v158, v159
    v_mfma_f32_32x32x16_bf16 v[240:255], v[88:91], a[92:95], v[240:255]
    ds_read_b64_tr_b16 v[78:79], v37 offset:17664
    buffer_store_dwordx4 v[144:147], v30, s[32:35], s65 offen offset:1024 sc1
    v_mfma_f32_32x32x16_bf16 v[160:175], v[92:95], a[184:187], v[160:175]
    v_mfma_f32_32x32x16_bf16 v[176:191], v[92:95], a[188:191], v[176:191]
    s_add_u32 m0, s60, 40960
    s_nop 0
    buffer_load_dwordx4 v11, s[20:23], s57 offen offset:0  lds
    s_waitcnt lgkmcnt(0)
    v_mfma_f32_32x32x16_bf16 v[160:175], v[64:67], a[192:195], v[160:175]
    ds_read_b64_tr_b16 v[80:81], v37 offset:18432
    ds_read_b64_tr_b16 v[82:83], v37 offset:18688
    v_mfma_f32_32x32x16_bf16 v[176:191], v[64:67], a[196:199], v[176:191]
    ds_read_b64_tr_b16 v[84:85], v34 offset:2048
    v_mfma_f32_32x32x16_bf16 v[192:207], v[68:71], a[96:99], v[192:207]
    ds_read_b64_tr_b16 v[86:87], v34 offset:2560
    buffer_load_dwordx4 v13, s[20:23], s57 offen offset:1024  lds
    v_mfma_f32_32x32x16_bf16 v[208:223], v[68:71], a[100:103], v[208:223]
    ds_read_b64_tr_b16 v[88:89], v35 offset:2048
    ds_read_b64_tr_b16 v[90:91], v35 offset:2560
    v_mfma_f32_32x32x16_bf16 v[224:239], v[72:75], a[96:99], v[224:239]
    s_lshl4_add_u32 s57, s98, 0
    ds_read_b64_tr_b16 v[92:93], v37 offset:19456
    v_mfma_f32_32x32x16_bf16 v[240:255], v[72:75], a[100:103], v[240:255]
    s_add_u32 m0, s60, 49152
    ds_read_b64_tr_b16 v[94:95], v37 offset:19712
    buffer_load_dwordx4 v22, s[24:27], s57 offen offset:0  lds
    v_mfma_f32_32x32x16_bf16 v[160:175], v[76:79], a[200:203], v[160:175]
    v_mfma_f32_32x32x16_bf16 v[176:191], v[76:79], a[204:207], v[176:191]
    s_waitcnt lgkmcnt(0)
    v_mfma_f32_32x32x16_bf16 v[160:175], v[80:83], a[208:211], v[160:175]
    ds_read_b64_tr_b16 v[64:65], v36 offset:16384
    ds_read_b64_tr_b16 v[66:67], v36 offset:16640
    buffer_load_dwordx4 v24, s[24:27], s57 offen offset:1024  lds
    v_mfma_f32_32x32x16_bf16 v[176:191], v[80:83], a[212:215], v[176:191]
    ds_read_b64_tr_b16 v[68:69], v34 offset:4096
    v_mfma_f32_32x32x16_bf16 v[192:207], v[84:87], a[104:107], v[192:207]
    s_lshl4_add_u32 s57, s99, 0
    ds_read_b64_tr_b16 v[70:71], v34 offset:4608
    v_mfma_f32_32x32x16_bf16 v[208:223], v[84:87], a[108:111], v[208:223]
    s_add_u32 m0, s60, 24576
    ds_read_b64_tr_b16 v[72:73], v35 offset:4096
    ds_read_b64_tr_b16 v[74:75], v35 offset:4608
    buffer_load_dwordx4 v22, s[24:27], s57 offen offset:0  lds
    v_mfma_f32_32x32x16_bf16 v[224:239], v[88:91], a[104:107], v[224:239]
    ds_read_b64_tr_b16 v[76:77], v36 offset:17408
    v_mfma_f32_32x32x16_bf16 v[240:255], v[88:91], a[108:111], v[240:255]
    ds_read_b64_tr_b16 v[78:79], v36 offset:17664
    v_mfma_f32_32x32x16_bf16 v[160:175], v[92:95], a[216:219], v[160:175]
    buffer_load_dwordx4 v24, s[24:27], s57 offen offset:1024  lds
    v_mfma_f32_32x32x16_bf16 v[176:191], v[92:95], a[220:223], v[176:191]
    s_waitcnt lgkmcnt(0)
    v_mfma_f32_32x32x16_bf16 v[160:175], v[64:67], a[224:227], v[160:175]
    s_lshl4_add_u32 s57, s100, 0
    ds_read_b64_tr_b16 v[80:81], v36 offset:18432
    ds_read_b64_tr_b16 v[82:83], v36 offset:18688
    v_mfma_f32_32x32x16_bf16 v[176:191], v[64:67], a[228:231], v[176:191]
    s_add_u32 m0, s60, 122880
    ds_read_b64_tr_b16 v[84:85], v34 offset:6144
    buffer_load_dwordx4 v22, s[24:27], s57 offen offset:0  lds
    v_mfma_f32_32x32x16_bf16 v[192:207], v[68:71], a[112:115], v[192:207]
    ds_read_b64_tr_b16 v[86:87], v34 offset:6656
    v_mfma_f32_32x32x16_bf16 v[208:223], v[68:71], a[116:119], v[208:223]
    ds_read_b64_tr_b16 v[88:89], v35 offset:6144
    ds_read_b64_tr_b16 v[90:91], v35 offset:6656
    v_mfma_f32_32x32x16_bf16 v[224:239], v[72:75], a[112:115], v[224:239]
    ds_read_b64_tr_b16 v[92:93], v36 offset:19456
    buffer_load_dwordx4 v24, s[24:27], s57 offen offset:1024  lds
    v_mfma_f32_32x32x16_bf16 v[240:255], v[72:75], a[116:119], v[240:255]
    ds_read_b64_tr_b16 v[94:95], v36 offset:19712
    v_mfma_f32_32x32x16_bf16 v[160:175], v[76:79], a[232:235], v[160:175]
    v_mfma_f32_32x32x16_bf16 v[176:191], v[76:79], a[236:239], v[176:191]
    s_waitcnt lgkmcnt(0)
    v_mfma_f32_32x32x16_bf16 v[160:175], v[80:83], a[240:243], v[160:175]
    s_waitcnt vmcnt(18)
    s_barrier
    ds_read_b64_tr_b16 v[64:65], v16 offset:0
    ds_read_b64_tr_b16 v[66:67], v16 offset:512
    v_mfma_f32_32x32x16_bf16 v[176:191], v[80:83], a[244:247], v[176:191]
    s_mov_b32 s57, 1377792
    s_add_u32 m0, s60, 65536
    ds_read_b64_tr_b16 v[68:69], v17 offset:0
    buffer_load_dwordx4 v10, s[16:19], s57 offen offset:0  lds
    v_mfma_f32_32x32x16_bf16 v[192:207], v[84:87], a[120:123], v[192:207]
    ds_read_b64_tr_b16 v[70:71], v17 offset:512
    buffer_load_dwordx4 v12, s[16:19], s57 offen offset:1024  lds
    v_mfma_f32_32x32x16_bf16 v[208:223], v[84:87], a[124:127], v[208:223]
    ds_read_b64_tr_b16 v[72:73], v16 offset:2048
    ds_read_b64_tr_b16 v[74:75], v16 offset:2560
    v_mfma_f32_32x32x16_bf16 v[224:239], v[88:91], a[120:123], v[224:239]
    s_add_u32 m0, s60, 73728
    ds_read_b64_tr_b16 v[76:77], v17 offset:2048
    buffer_load_dwordx4 v11, s[20:23], s57 offen offset:0  lds
    v_mfma_f32_32x32x16_bf16 v[240:255], v[88:91], a[124:127], v[240:255]
    ds_read_b64_tr_b16 v[78:79], v17 offset:2560
    v_mfma_f32_32x32x16_bf16 v[160:175], v[92:95], a[248:251], v[160:175]
    buffer_load_dwordx4 v13, s[20:23], s57 offen offset:1024  lds
    v_mfma_f32_32x32x16_bf16 v[176:191], v[92:95], a[252:255], v[176:191]
    s_lshl4_add_u32 s57, s93, 1310720
    s_waitcnt lgkmcnt(0)
    v_mfma_f32_32x32x16_bf16 v[192:207], v[64:67], a[128:131], v[192:207]
    s_add_u32 m0, s60, 147456
    ds_read_b64_tr_b16 v[80:81], v16 offset:4096
    ds_read_b64_tr_b16 v[82:83], v16 offset:4608
    buffer_load_dwordx4 v22, s[24:27], s57 offen offset:0  lds
    v_mfma_f32_32x32x16_bf16 v[208:223], v[64:67], a[132:135], v[208:223]
    ds_read_b64_tr_b16 v[84:85], v17 offset:4096
    s_waitcnt vmcnt(13)
    s_mov_b64 exec, 1
    buffer_store_dword v44, off, s[32:35], s69 offset:0 sc1
    s_mov_b64 exec, -1
    v_mfma_f32_32x32x16_bf16 v[224:239], v[68:71], a[128:131], v[224:239]
    ds_read_b64_tr_b16 v[86:87], v17 offset:4608
    buffer_load_dwordx4 v24, s[24:27], s57 offen offset:1024  lds
    v_mul_f32 v2, v160, v160
    v_mul_f32 v3, v161, v161
    v_mfma_f32_32x32x16_bf16 v[240:255], v[68:71], a[132:135], v[240:255]
    s_lshl4_add_u32 s57, s94, 1310720
    ds_read_b64_tr_b16 v[88:89], v16 offset:6144
    ds_read_b64_tr_b16 v[90:91], v16 offset:6656
    v_mul_f32 v4, v162, v162
    v_mul_f32 v5, v163, v163
    v_fmaak_f32 v2, v2, v33, 0xc0135761
    v_fmaak_f32 v3, v3, v33, 0xc0135761
    v_mfma_f32_32x32x16_bf16 v[192:207], v[72:75], a[136:139], v[192:207]
    s_add_u32 m0, s60, 114688
    ds_read_b64_tr_b16 v[92:93], v17 offset:6144
    buffer_load_dwordx4 v22, s[24:27], s57 offen offset:0  lds
    v_fmaak_f32 v4, v4, v33, 0xc0135761
    v_fmaak_f32 v5, v5, v33, 0xc0135761
    v_mfma_f32_32x32x16_bf16 v[208:223], v[72:75], a[140:143], v[208:223]
    ds_read_b64_tr_b16 v[94:95], v17 offset:6656
    v_mul_f32 v2, v2, v160
    v_mul_f32 v3, v3, v161
    v_mul_f32 v4, v4, v162
    v_mul_f32 v5, v5, v163
    v_mfma_f32_32x32x16_bf16 v[224:239], v[76:79], a[136:139], v[224:239]
    buffer_load_dwordx4 v24, s[24:27], s57 offen offset:1024  lds
    v_exp_f32_e64 v2, v2
    v_mfma_f32_32x32x16_bf16 v[240:255], v[76:79], a[140:143], v[240:255]
    v_exp_f32 v3, v3
    v_exp_f32 v4, v4
    v_exp_f32 v5, v5
    s_waitcnt lgkmcnt(0)
    v_mfma_f32_32x32x16_bf16 v[192:207], v[80:83], a[144:147], v[192:207]
    s_waitcnt vmcnt(15)
    s_barrier
    ds_read_b64_tr_b16 v[64:65], v16 offset:32768
    ds_read_b64_tr_b16 v[66:67], v16 offset:33280
    v_mul_f32 v168, v168, v160
    v_mul_f32 v169, v169, v161
    v_mfma_f32_32x32x16_bf16 v[208:223], v[80:83], a[148:151], v[208:223]
    s_mov_b32 s57, 1607168
    s_add_u32 m0, s60, 0
    ds_read_b64_tr_b16 v[68:69], v17 offset:32768
    buffer_load_dwordx4 v10, s[16:19], s57 offen offset:0  lds
    v_mul_f32 v170, v170, v162
    v_mfma_f32_32x32x16_bf16 v[224:239], v[84:87], a[144:147], v[224:239]
    ds_read_b64_tr_b16 v[70:71], v17 offset:33280
    buffer_load_dwordx4 v12, s[16:19], s57 offen offset:1024  lds
    v_mul_f32_e64 v171, v171, v163
    v_fma_f32 v2, v2, v41, v41
    v_mfma_f32_32x32x16_bf16 v[240:255], v[84:87], a[148:151], v[240:255]
    ds_read_b64_tr_b16 v[72:73], v16 offset:34816
    ds_read_b64_tr_b16 v[74:75], v16 offset:35328
    v_fma_f32 v3, v3, v41, v41
    v_fma_f32 v4, v4, v41, v41
    v_fma_f32 v5, v5, v41, v41
    v_mfma_f32_32x32x16_bf16 v[192:207], v[88:91], a[152:155], v[192:207]
    s_add_u32 m0, s60, 8192
    ds_read_b64_tr_b16 v[76:77], v17 offset:34816
    buffer_load_dwordx4 v11, s[20:23], s57 offen offset:0  lds
    v_rcp_f32_e64 v2, v2
    v_mfma_f32_32x32x16_bf16 v[208:223], v[88:91], a[156:159], v[208:223]
    ds_read_b64_tr_b16 v[78:79], v17 offset:35328
    v_rcp_f32 v3, v3
    v_rcp_f32 v4, v4
    v_mfma_f32_32x32x16_bf16 v[224:239], v[92:95], a[152:155], v[224:239]
    buffer_load_dwordx4 v13, s[20:23], s57 offen offset:1024  lds
    v_rcp_f32 v5, v5
    v_mul_f32 v168, v168, v2
    v_mfma_f32_32x32x16_bf16 v[240:255], v[92:95], a[156:159], v[240:255]
    s_lshl4_add_u32 s57, s95, 1310720
    v_mul_f32 v169, v169, v3
    v_mul_f32 v170, v170, v4
    v_mul_f32_e64 v171, v171, v5
    v_cvt_pk_bf16_f32 v160, v168, v169
    v_cvt_pk_bf16_f32 v161, v170, v171
    v_mul_f32 v2, v164, v164
    s_waitcnt lgkmcnt(0)
    v_mfma_f32_32x32x16_bf16 v[192:207], v[64:67], a[160:163], v[192:207]
    s_add_u32 m0, s60, 81920
    ds_read_b64_tr_b16 v[80:81], v16 offset:36864
    ds_read_b64_tr_b16 v[82:83], v16 offset:37376
    buffer_load_dwordx4 v22, s[24:27], s57 offen offset:0  lds
    v_mul_f32_e64 v3, v165, v165
    v_mfma_f32_32x32x16_bf16 v[208:223], v[64:67], a[164:167], v[208:223]
    ds_read_b64_tr_b16 v[84:85], v17 offset:36864
    v_mul_f32 v4, v166, v166
    v_mul_f32 v5, v167, v167
    v_fmaak_f32 v2, v2, v33, 0xc0135761
    v_fmaak_f32 v3, v3, v33, 0xc0135761
    v_fmaak_f32 v4, v4, v33, 0xc0135761
    v_mfma_f32_32x32x16_bf16 v[224:239], v[68:71], a[160:163], v[224:239]
    ds_read_b64_tr_b16 v[86:87], v17 offset:37376
    buffer_load_dwordx4 v24, s[24:27], s57 offen offset:1024  lds
    v_fmaak_f32 v5, v5, v33, 0xc0135761
    v_mul_f32_e64 v2, v2, v164
    v_mfma_f32_32x32x16_bf16 v[240:255], v[68:71], a[164:167], v[240:255]
    s_lshl4_add_u32 s57, s96, 1310720
    ds_read_b64_tr_b16 v[88:89], v16 offset:38912
    ds_read_b64_tr_b16 v[90:91], v16 offset:39424
    v_mul_f32 v3, v3, v165
    v_mul_f32 v4, v4, v166
    v_mul_f32_e64 v5, v5, v167
    v_mfma_f32_32x32x16_bf16 v[192:207], v[72:75], a[168:171], v[192:207]
    s_add_u32 m0, s60, 106496
    ds_read_b64_tr_b16 v[92:93], v17 offset:38912
    buffer_load_dwordx4 v22, s[24:27], s57 offen offset:0  lds
    v_exp_f32_e64 v2, v2
    v_mfma_f32_32x32x16_bf16 v[208:223], v[72:75], a[172:175], v[208:223]
    ds_read_b64_tr_b16 v[94:95], v17 offset:39424
    v_exp_f32 v3, v3
    v_exp_f32 v4, v4
    v_mfma_f32_32x32x16_bf16 v[224:239], v[76:79], a[168:171], v[224:239]
    buffer_load_dwordx4 v24, s[24:27], s57 offen offset:1024  lds
    v_exp_f32 v5, v5
    v_mul_f32 v172, v172, v164
    v_mfma_f32_32x32x16_bf16 v[240:255], v[76:79], a[172:175], v[240:255]
    v_mul_f32 v173, v173, v165
    v_mul_f32 v174, v174, v166
    v_mul_f32_e64 v175, v175, v167
    v_fma_f32 v2, v2, v41, v41
    v_fma_f32 v3, v3, v41, v41
    v_fma_f32 v4, v4, v41, v41
    s_waitcnt lgkmcnt(0)
    v_mfma_f32_32x32x16_bf16 v[192:207], v[80:83], a[176:179], v[192:207]
    s_waitcnt vmcnt(13)
    s_barrier
    ds_read_b64_tr_b16 v[64:65], v34 offset:0
    ds_read_b64_tr_b16 v[66:67], v34 offset:512
    v_fma_f32 v5, v5, v41, v41
    v_mfma_f32_32x32x16_bf16 v[208:223], v[80:83], a[180:183], v[208:223]
    s_lshl4_add_u32 s57, s97, 1310720
    s_add_u32 m0, s60, 98304
    ds_read_b64_tr_b16 v[68:69], v35 offset:0
    buffer_load_dwordx4 v22, s[24:27], s57 offen offset:0  lds
    v_mfma_f32_32x32x16_bf16 v[224:239], v[84:87], a[176:179], v[224:239]
    ds_read_b64_tr_b16 v[70:71], v35 offset:512
    v_rcp_f32 v2, v2
    v_rcp_f32_e64 v3, v3
    v_mfma_f32_32x32x16_bf16 v[240:255], v[84:87], a[180:183], v[240:255]
    ds_read_b64_tr_b16 v[72:73], v34 offset:2048
    ds_read_b64_tr_b16 v[74:75], v34 offset:2560
    buffer_load_dwordx4 v24, s[24:27], s57 offen offset:1024  lds
    v_mfma_f32_32x32x16_bf16 v[192:207], v[88:91], a[184:187], v[192:207]
    ds_read_b64_tr_b16 v[76:77], v35 offset:2048
    v_rcp_f32 v4, v4
    v_rcp_f32 v5, v5
    v_mul_f32_e64 v172, v172, v2
    v_mfma_f32_32x32x16_bf16 v[208:223], v[88:91], a[188:191], v[208:223]
    s_lshl4_add_u32 s57, s98, 1310720
    ds_read_b64_tr_b16 v[78:79], v35 offset:2560
    v_mul_f32 v173, v173, v3
    v_mul_f32 v174, v174, v4
    v_mul_f32_e64 v175, v175, v5
    v_cvt_pk_bf16_f32 v162, v172, v173
    v_cvt_pk_bf16_f32 v163, v174, v175
    v_mfma_f32_32x32x16_bf16 v[224:239], v[92:95], a[184:187], v[224:239]
    s_add_u32 m0, s60, 40960
    s_nop 0
    buffer_load_dwordx4 v22, s[24:27], s57 offen offset:0  lds
    buffer_store_dwordx4 v[160:163], v29, s[32:35], s66 offen offset:0 sc1
    v_mul_f32 v2, v176, v176
L_islB3:
    s_cbranch_execz L_retB
    v_mfma_f32_32x32x16_bf16 v[240:255], v[92:95], a[188:191], v[240:255]
    v_mul_f32 v3, v177, v177
    v_mul_f32 v4, v178, v178
    v_mul_f32 v5, v179, v179
    v_fmaak_f32 v2, v2, v33, 0xc0135761
    v_fmaak_f32 v3, v3, v33, 0xc0135761
    v_fmaak_f32 v4, v4, v33, 0xc0135761
    s_waitcnt lgkmcnt(0)
    v_mfma_f32_32x32x16_bf16 v[192:207], v[64:67], a[192:195], v[192:207]
    ds_read_b64_tr_b16 v[80:81], v34 offset:4096
    ds_read_b64_tr_b16 v[82:83], v34 offset:4608
    buffer_load_dwordx4 v24, s[24:27], s57 offen offset:1024  lds
    v_fmaak_f32 v5, v5, v33, 0xc0135761
    v_mfma_f32_32x32x16_bf16 v[208:223], v[64:67], a[196:199], v[208:223]
    ds_read_b64_tr_b16 v[84:85], v35 offset:4096
    v_mul_f32 v2, v2, v176
    v_mul_f32 v3, v3, v177
    v_mul_f32 v4, v4, v178
    v_mul_f32_e64 v5, v5, v179
    v_mfma_f32_32x32x16_bf16 v[224:239], v[68:71], a[192:195], v[224:239]
    s_lshl4_add_u32 s57, s99, 1310720
    ds_read_b64_tr_b16 v[86:87], v35 offset:4608
    v_exp_f32 v2, v2
    v_exp_f32 v3, v3
    v_mfma_f32_32x32x16_bf16 v[240:255], v[68:71], a[196:199], v[240:255]
    s_add_u32 m0, s60, 32768
    ds_read_b64_tr_b16 v[88:89], v34 offset:6144
    ds_read_b64_tr_b16 v[90:91], v34 offset:6656
    buffer_load_dwordx4 v22, s[24:27], s57 offen offset:0  lds
    v_mfma_f32_32x32x16_bf16 v[192:207], v[72:75], a[200:203], v[192:207]
    ds_read_b64_tr_b16 v[92:93], v35 offset:6144
    v_exp_f32 v4, v4
    v_exp_f32 v5, v5
    v_mul_f32_e64 v184, v184, v176
    v_mfma_f32_32x32x16_bf16 v[208:223], v[72:75], a[204:207], v[208:223]
    ds_read_b64_tr_b16 v[94:95], v35 offset:6656
    buffer_load_dwordx4 v24, s[24:27], s57 offen offset:1024  lds
    v_mul_f32 v185, v185, v177
    v_mul_f32 v186, v186, v178
    v_mfma_f32_32x32x16_bf16 v[224:239], v[76:79], a[200:203], v[224:239]
    v_mul_f32_e64 v187, v187, v179
    v_fma_f32 v2, v2, v43, v43
    v_fma_f32 v3, v3, v43, v43
    v_fma_f32 v4, v4, v43, v43
    v_fma_f32 v5, v5, v43, v43
    v_mfma_f32_32x32x16_bf16 v[240:255], v[76:79], a[204:207], v[240:255]
    v_rcp_f32 v2, v2
    v_rcp_f32 v3, v3
    v_rcp_f32 v4, v4
    s_waitcnt lgkmcnt(0)
    v_mfma_f32_32x32x16_bf16 v[192:207], v[80:83], a[208:211], v[192:207]
    s_waitcnt vmcnt(11)
    s_barrier
    ds_read_b64_tr_b16 v[64:65], v16 offset:0
    ds_read_b64_tr_b16 v[66:67], v16 offset:512
    v_rcp_f32_e64 v5, v5
    v_mfma_f32_32x32x16_bf16 v[208:223], v[80:83], a[212:215], v[208:223]
    s_lshl4_add_u32 s57, s100, 1310720
    s_add_u32 m0, s60, 73728
    ds_read_b64_tr_b16 v[68:69], v17 offset:0
    buffer_load_dwordx4 v22, s[24:27], s57 offen offset:0  lds
    v_mul_f32_e64 v184, v184, v2
    v_mfma_f32_32x32x16_bf16 v[224:239], v[84:87], a[208:211], v[224:239]
    ds_read_b64_tr_b16 v[70:71], v17 offset:512
    v_mul_f32 v185, v185, v3
    v_mul_f32 v186, v186, v4
    v_mul_f32_e64 v187, v187, v5
    v_cvt_pk_bf16_f32 v176, v184, v185
    v_cvt_pk_bf16_f32 v177, v186, v187
    v_mfma_f32_32x32x16_bf16 v[240:255], v[84:87], a[212:215], v[240:255]
    ds_read_b64_tr_b16 v[72:73], v16 offset:2048
    ds_read_b64_tr_b16 v[74:75], v16 offset:2560
    v_mul_f32 v2, v180, v180
    v_mul_f32 v3, v181, v181
    v_mul_f32 v4, v182, v182
    v_mul_f32 v5, v183, v183
    v_mfma_f32_32x32x16_bf16 v[192:207], v[88:91], a[216:219], v[192:207]
    ds_read_b64_tr_b16 v[76:77], v17 offset:2048
    buffer_load_dwordx4 v24, s[24:27], s57 offen offset:1024  lds
    v_fmaak_f32 v2, v2, v33, 0xc0135761
    v_fmaak_f32 v3, v3, v33, 0xc0135761
    v_mfma_f32_32x32x16_bf16 v[208:223], v[88:91], a[220:223], v[208:223]
    ds_read_b64_tr_b16 v[78:79], v17 offset:2560
    v_fmaak_f32 v4, v4, v33, 0xc0135761
    v_fmaak_f32 v5, v5, v33, 0xc0135761
    v_mul_f32 v2, v2, v180
    v_mul_f32 v3, v3, v181
    v_mul_f32_e64 v4, v4, v182
    v_mfma_f32_32x32x16_bf16 v[224:239], v[92:95], a[216:219], v[224:239]
    v_mul_f32 v5, v5, v183
    v_exp_f32 v2, v2
    v_exp_f32_e64 v3, v3
    v_mfma_f32_32x32x16_bf16 v[240:255], v[92:95], a[220:223], v[240:255]
    s_lshl4_add_u32 s57, s93, 786432
    v_exp_f32 v4, v4
    v_exp_f32 v5, v5
    v_mul_f32 v188, v188, v180
    v_mul_f32 v189, v189, v181
    s_waitcnt lgkmcnt(0)
    v_mfma_f32_32x32x16_bf16 v[192:207], v[64:67], a[224:227], v[192:207]
    s_add_u32 m0, s60, 65536
    ds_read_b64_tr_b16 v[80:81], v16 offset:4096
    ds_read_b64_tr_b16 v[82:83], v16 offset:4608
    buffer_load_dwordx4 v22, s[24:27], s57 offen offset:0  lds
    v_mul_f32 v190, v190, v182
    v_mfma_f32_32x32x16_bf16 v[208:223], v[64:67], a[228:231], v[208:223]
    ds_read_b64_tr_b16 v[84:85], v17 offset:4096
    v_mul_f32_e64 v191, v191, v183
    v_fma_f32 v2, v2, v43, v43
    v_fma_f32 v3, v3, v43, v43
    v_fma_f32 v4, v4, v43, v43
    v_fma_f32 v5, v5, v43, v43
    v_mfma_f32_32x32x16_bf16 v[224:239], v[68:71], a[224:227], v[224:239]
    ds_read_b64_tr_b16 v[86:87], v17 offset:4608
    buffer_load_dword v39, v31, s[32:35], 0 offen offset:0 sc1
    v_rcp_f32 v2, v2
    v_rcp_f32 v3, v3
    v_mfma_f32_32x32x16_bf16 v[240:255], v[68:71], a[228:231], v[240:255]
    ds_read_b64_tr_b16 v[88:89], v16 offset:6144
    ds_read_b64_tr_b16 v[90:91], v16 offset:6656
    v_rcp_f32 v4, v4
    v_rcp_f32 v5, v5
    v_mfma_f32_32x32x16_bf16 v[192:207], v[72:75], a[232:235], v[192:207]
    ds_read_b64_tr_b16 v[92:93], v17 offset:6144
    buffer_load_dwordx4 v24, s[24:27], s57 offen offset:1024  lds
    v_mul_f32 v188, v188, v2
    v_mul_f32 v189, v189, v3
    v_mfma_f32_32x32x16_bf16 v[208:223], v[72:75], a[236:239], v[208:223]
    ds_read_b64_tr_b16 v[94:95], v17 offset:6656
    v_mul_f32 v190, v190, v4
    v_mul_f32 v191, v191, v5
    v_cvt_pk_bf16_f32 v178, v188, v189
    v_cvt_pk_bf16_f32 v179, v190, v191
    v_mfma_f32_32x32x16_bf16 v[224:239], v[76:79], a[232:235], v[224:239]
    buffer_store_dwordx4 v[176:179], v30, s[32:35], s66 offen offset:0 sc1
    v_mfma_f32_32x32x16_bf16 v[240:255], v[76:79], a[236:239], v[240:255]
    s_waitcnt lgkmcnt(0)
    v_mfma_f32_32x32x16_bf16 v[192:207], v[80:83], a[240:243], v[192:207]
    s_barrier
    v_mfma_f32_32x32x16_bf16 v[208:223], v[80:83], a[244:247], v[208:223]
    v_mfma_f32_32x32x16_bf16 v[224:239], v[84:87], a[240:243], v[224:239]
    v_mfma_f32_32x32x16_bf16 v[240:255], v[84:87], a[244:247], v[240:255]
    v_mfma_f32_32x32x16_bf16 v[192:207], v[88:91], a[248:251], v[192:207]
    v_mfma_f32_32x32x16_bf16 v[208:223], v[88:91], a[252:255], v[208:223]
    v_mfma_f32_32x32x16_bf16 v[224:239], v[92:95], a[248:251], v[224:239]
    v_mfma_f32_32x32x16_bf16 v[240:255], v[92:95], a[252:255], v[240:255]
    s_nop 8
    s_nop 0
    v_pk_mul_f32 v[2:3], v[192:193], v[192:193]
    v_pk_mul_f32 v[4:5], v[194:195], v[194:195]
    v_pk_mul_f32 v[6:7], v[196:197], v[196:197]
    v_pk_mul_f32 v[8:9], v[198:199], v[198:199]
    v_pk_fma_f32 v[2:3], v[2:3], v[32:33], v[32:33] op_sel:[0,1,0] op_sel_hi:[1,1,0]
    v_pk_fma_f32 v[4:5], v[4:5], v[32:33], v[32:33] op_sel:[0,1,0] op_sel_hi:[1,1,0]
    v_pk_fma_f32 v[6:7], v[6:7], v[32:33], v[32:33] op_sel:[0,1,0] op_sel_hi:[1,1,0]
    v_pk_fma_f32 v[8:9], v[8:9], v[32:33], v[32:33] op_sel:[0,1,0] op_sel_hi:[1,1,0]
    v_pk_mul_f32 v[2:3], v[2:3], v[192:193]
    v_pk_mul_f32 v[4:5], v[4:5], v[194:195]
    v_pk_mul_f32 v[6:7], v[6:7], v[196:197]
    v_pk_mul_f32 v[8:9], v[8:9], v[198:199]
    s_waitcnt vmcnt(2)
    v_cmp_ne_u32 vcc, s49, v39
    s_cbranch_vccnz L_B_again_10
L_B_ok_9:
    s_add_u32 s73, s93, 0
    buffer_load_dwordx4 a[160:163], v27, s[32:35], s73 offen sc1
    v_exp_f32 v2, v2
    v_exp_f32 v3, v3
    v_exp_f32 v4, v4
    v_exp_f32 v5, v5
    v_exp_f32 v6, v6
    v_exp_f32 v7, v7
    buffer_load_dwordx4 a[164:167], v28, s[32:35], s73 offen sc1
    v_exp_f32 v8, v8
    v_exp_f32 v9, v9
    v_pk_mul_f32 v[200:201], v[200:201], v[192:193]
    v_pk_mul_f32 v[202:203], v[202:203], v[194:195]
    v_pk_mul_f32 v[204:205], v[204:205], v[196:197]
    v_pk_mul_f32 v[206:207], v[206:207], v[198:199]
    v_pk_fma_f32 v[2:3], v[2:3], v[40:41], v[40:41] op_sel:[0,1,1] op_sel_hi:[1,1,1]
    v_pk_fma_f32 v[4:5], v[4:5], v[40:41], v[40:41] op_sel:[0,1,1] op_sel_hi:[1,1,1]
    s_add_u32 s73, s94, 0
    buffer_load_dwordx4 a[168:171], v27, s[32:35], s73 offen sc1
    v_pk_fma_f32 v[6:7], v[6:7], v[40:41], v[40:41] op_sel:[0,1,1] op_sel_hi:[1,1,1]
    v_pk_fma_f32 v[8:9], v[8:9], v[40:41], v[40:41] op_sel:[0,1,1] op_sel_hi:[1,1,1]
    v_rcp_f32 v2, v2
    v_rcp_f32 v3, v3
    v_rcp_f32 v4, v4
    v_rcp_f32 v5, v5
    v_rcp_f32 v6, v6
    buffer_load_dwordx4 a[172:175], v28, s[32:35], s73 offen sc1
    v_rcp_f32 v7, v7
    v_rcp_f32 v8, v8
    v_rcp_f32_e64 v9, v9
    v_pk_mul_f32 v[200:201], v[200:201], v[2:3]
    v_pk_mul_f32 v[202:203], v[202:203], v[4:5]
    v_pk_mul_f32 v[204:205], v[204:205], v[6:7]
    v_pk_mul_f32 v[206:207], v[206:207], v[8:9]
    v_cvt_pk_bf16_f32 v192, v200, v201
    s_add_u32 s73, s95, 0
    s_nop 0
    buffer_load_dwordx4 a[176:179], v27, s[32:35], s73 offen sc1
    v_cvt_pk_bf16_f32 v193, v202, v203
    v_cvt_pk_bf16_f32 v194, v204, v205
    v_cvt_pk_bf16_f32 v195, v206, v207
    buffer_store_dwordx4 v[192:195], v29, s[32:35], s67 offen offset:0 sc1
    v_pk_mul_f32 v[2:3], v[208:209], v[208:209]
    v_pk_mul_f32 v[4:5], v[210:211], v[210:211]
    v_pk_mul_f32 v[6:7], v[212:213], v[212:213]
    v_pk_mul_f32 v[8:9], v[214:215], v[214:215]
    v_pk_fma_f32 v[2:3], v[2:3], v[32:33], v[32:33] op_sel:[0,1,0] op_sel_hi:[1,1,0]
    v_pk_fma_f32 v[4:5], v[4:5], v[32:33], v[32:33] op_sel:[0,1,0] op_sel_hi:[1,1,0]
    v_pk_fma_f32 v[6:7], v[6:7], v[32:33], v[32:33] op_sel:[0,1,0] op_sel_hi:[1,1,0]
    v_pk_fma_f32 v[8:9], v[8:9], v[32:33], v[32:33] op_sel:[0,1,0] op_sel_hi:[1,1,0]
    v_pk_mul_f32 v[2:3], v[2:3], v[208:209]
    v_pk_mul_f32 v[4:5], v[4:5], v[210:211]
    v_pk_mul_f32 v[6:7], v[6:7], v[212:213]
    v_pk_mul_f32 v[8:9], v[8:9], v[214:215]
    v_exp_f32 v2, v2
    v_exp_f32 v3, v3
    v_exp_f32_e64 v4, v4
    buffer_load_dwordx4 a[180:183], v28, s[32:35], s73 offen sc1
    v_exp_f32 v5, v5
    v_exp_f32 v6, v6
    v_exp_f32 v7, v7
    v_exp_f32 v8, v8
    v_exp_f32_e64 v9, v9
    v_pk_mul_f32 v[216:217], v[216:217], v[208:209]
    s_add_u32 s73, s96, 0
    s_nop 0
    buffer_load_dwordx4 a[184:187], v27, s[32:35], s73 offen sc1
    v_pk_mul_f32 v[218:219], v[218:219], v[210:211]
    v_pk_mul_f32 v[220:221], v[220:221], v[212:213]
    v_pk_mul_f32 v[222:223], v[222:223], v[214:215]
    v_pk_fma_f32 v[2:3], v[2:3], v[42:43], v[42:43] op_sel:[0,1,1] op_sel_hi:[1,1,1]
    v_pk_fma_f32 v[4:5], v[4:5], v[42:43], v[42:43] op_sel:[0,1,1] op_sel_hi:[1,1,1]
    v_pk_fma_f32 v[6:7], v[6:7], v[42:43], v[42:43] op_sel:[0,1,1] op_sel_hi:[1,1,1]
    v_pk_fma_f32 v[8:9], v[8:9], v[42:43], v[42:43] op_sel:[0,1,1] op_sel_hi:[1,1,1]
    v_rcp_f32 v2, v2
    v_rcp_f32 v3, v3
    v_rcp_f32_e64 v4, v4
    buffer_load_dwordx4 a[188:191], v28, s[32:35], s73 offen sc1
    v_rcp_f32 v5, v5
    v_rcp_f32 v6, v6
    v_rcp_f32 v7, v7
    v_rcp_f32 v8, v8
    v_rcp_f32 v9, v9
    s_add_u32 s73, s97, 0
    buffer_load_dwordx4 a[192:195], v27, s[32:35], s73 offen sc1
    v_pk_mul_f32 v[216:217], v[216:217], v[2:3]
    v_pk_mul_f32 v[218:219], v[218:219], v[4:5]
    v_pk_mul_f32 v[220:221], v[220:221], v[6:7]
    v_pk_mul_f32 v[222:223], v[222:223], v[8:9]
    v_cvt_pk_bf16_f32 v208, v216, v217
    v_cvt_pk_bf16_f32 v209, v218, v219
    v_cvt_pk_bf16_f32 v210, v220, v221
    v_cvt_pk_bf16_f32 v211, v222, v223
    buffer_store_dwordx4 v[208:211], v30, s[32:35], s67 offen offset:0 sc1
    v_pk_mul_f32 v[2:3], v[224:225], v[224:225]
    v_pk_mul_f32 v[4:5], v[226:227], v[226:227]
    v_pk_mul_f32 v[6:7], v[228:229], v[228:229]
    v_pk_mul_f32 v[8:9], v[230:231], v[230:231]
    v_pk_fma_f32 v[2:3], v[2:3], v[32:33], v[32:33] op_sel:[0,1,0] op_sel_hi:[1,1,0]
    v_pk_fma_f32 v[4:5], v[4:5], v[32:33], v[32:33] op_sel:[0,1,0] op_sel_hi:[1,1,0]
    v_pk_fma_f32 v[6:7], v[6:7], v[32:33], v[32:33] op_sel:[0,1,0] op_sel_hi:[1,1,0]
    v_pk_fma_f32 v[8:9], v[8:9], v[32:33], v[32:33] op_sel:[0,1,0] op_sel_hi:[1,1,0]
    v_pk_mul_f32 v[2:3], v[2:3], v[224:225]
    v_pk_mul_f32 v[4:5], v[4:5], v[226:227]
    v_pk_mul_f32 v[6:7], v[6:7], v[228:229]
    v_pk_mul_f32 v[8:9], v[8:9], v[230:231]
    v_exp_f32_e64 v2, v2
    buffer_load_dwordx4 a[196:199], v28, s[32:35], s73 offen sc1
    v_exp_f32 v3, v3
    v_exp_f32 v4, v4
    v_exp_f32 v5, v5
    v_exp_f32 v6, v6
    v_exp_f32 v7, v7
    v_exp_f32 v8, v8
    s_add_u32 s73, s98, 0
    buffer_load_dwordx4 a[200:203], v27, s[32:35], s73 offen sc1
    v_exp_f32 v9, v9
    v_pk_mul_f32 v[232:233], v[232:233], v[224:225]
    v_pk_mul_f32 v[234:235], v[234:235], v[226:227]
    v_pk_mul_f32 v[236:237], v[236:237], v[228:229]
    v_pk_mul_f32 v[238:239], v[238:239], v[230:231]
    v_pk_fma_f32 v[2:3], v[2:3], v[40:41], v[40:41] op_sel:[0,1,1] op_sel_hi:[1,1,1]
    v_pk_fma_f32 v[4:5], v[4:5], v[40:41], v[40:41] op_sel:[0,1,1] op_sel_hi:[1,1,1]
    v_pk_fma_f32 v[6:7], v[6:7], v[40:41], v[40:41] op_sel:[0,1,1] op_sel_hi:[1,1,1]
    v_pk_fma_f32 v[8:9], v[8:9], v[40:41], v[40:41] op_sel:[0,1,1] op_sel_hi:[1,1,1]
    buffer_load_dwordx4 a[204:207], v28, s[32:35], s73 offen sc1
    v_rcp_f32 v2, v2
    v_rcp_f32 v3, v3
    v_rcp_f32 v4, v4
    v_rcp_f32 v5, v5
    v_rcp_f32 v6, v6
    v_rcp_f32 v7, v7
    s_add_u32 s73, s99, 0
    buffer_load_dwordx4 a[208:211], v27, s[32:35], s73 offen sc1
    v_rcp_f32 v8, v8
    v_rcp_f32_e64 v9, v9
    v_pk_mul_f32 v[232:233], v[232:233], v[2:3]
    v_pk_mul_f32 v[234:235], v[234:235], v[4:5]
    v_pk_mul_f32 v[236:237], v[236:237], v[6:7]
    v_pk_mul_f32 v[238:239], v[238:239], v[8:9]
    v_cvt_pk_bf16_f32 v224, v232, v233
    v_cvt_pk_bf16_f32 v225, v234, v235
    buffer_load_dwordx4 a[212:215], v28, s[32:35], s73 offen sc1
    v_cvt_pk_bf16_f32 v226, v236, v237
    v_cvt_pk_bf16_f32 v227, v238, v239
    buffer_store_dwordx4 v[224:227], v29, s[32:35], s67 offen offset:1024 sc1
    v_pk_mul_f32 v[2:3], v[240:241], v[240:241]
    v_pk_mul_f32 v[4:5], v[242:243], v[242:243]
    v_pk_mul_f32 v[6:7], v[244:245], v[244:245]
    v_pk_mul_f32 v[8:9], v[246:247], v[246:247]
    v_pk_fma_f32 v[2:3], v[2:3], v[32:33], v[32:33] op_sel:[0,1,0] op_sel_hi:[1,1,0]
    v_pk_fma_f32 v[4:5], v[4:5], v[32:33], v[32:33] op_sel:[0,1,0] op_sel_hi:[1,1,0]
    v_pk_fma_f32 v[6:7], v[6:7], v[32:33], v[32:33] op_sel:[0,1,0] op_sel_hi:[1,1,0]
    v_pk_fma_f32 v[8:9], v[8:9], v[32:33], v[32:33] op_sel:[0,1,0] op_sel_hi:[1,1,0]
    v_pk_mul_f32 v[2:3], v[2:3], v[240:241]
    v_pk_mul_f32 v[4:5], v[4:5], v[242:243]
    v_pk_mul_f32 v[6:7], v[6:7], v[244:245]
    v_pk_mul_f32 v[8:9], v[8:9], v[246:247]
    v_exp_f32 v2, v2
    v_exp_f32 v3, v3
    v_exp_f32 v4, v4
    v_exp_f32 v5, v5
    s_add_u32 s73, s100, 0
    buffer_load_dwordx4 a[216:219], v27, s[32:35], s73 offen sc1
    v_exp_f32 v6, v6
    v_exp_f32 v7, v7
    v_exp_f32 v8, v8
    v_exp_f32_e64 v9, v9
    v_pk_mul_f32 v[248:249], v[248:249], v[240:241]
    v_pk_mul_f32 v[250:251], v[250:251], v[242:243]
    v_pk_mul_f32 v[252:253], v[252:253], v[244:245]
    buffer_load_dwordx4 a[220:223], v28, s[32:35], s73 offen sc1
    v_pk_mul_f32 v[254:255], v[254:255], v[246:247]
    v_pk_fma_f32 v[2:3], v[2:3], v[42:43], v[42:43] op_sel:[0,1,1] op_sel_hi:[1,1,1]
    v_pk_fma_f32 v[4:5], v[4:5], v[42:43], v[42:43] op_sel:[0,1,1] op_sel_hi:[1,1,1]
    v_pk_fma_f32 v[6:7], v[6:7], v[42:43], v[42:43] op_sel:[0,1,1] op_sel_hi:[1,1,1]
    v_pk_fma_f32 v[8:9], v[8:9], v[42:43], v[42:43] op_sel:[0,1,1] op_sel_hi:[1,1,1]
    v_rcp_f32 v2, v2
    v_rcp_f32 v3, v3
    v_rcp_f32_e64 v4, v4
    s_lshl4_add_u32 s57, s94, 786432
    s_add_u32 m0, s60, 0
    s_nop 0
    buffer_load_dwordx4 v22, s[24:27], s57 offen offset:0  lds
    v_rcp_f32 v5, v5
    v_rcp_f32 v6, v6
    v_rcp_f32 v7, v7
    v_rcp_f32 v8, v8
    v_rcp_f32_e64 v9, v9
    v_pk_mul_f32 v[248:249], v[248:249], v[2:3]
    v_pk_mul_f32 v[250:251], v[250:251], v[4:5]
    buffer_load_dwordx4 v24, s[24:27], s57 offen offset:1024  lds
    v_pk_mul_f32 v[252:253], v[252:253], v[6:7]
    v_pk_mul_f32 v[254:255], v[254:255], v[8:9]
    v_cvt_pk_bf16_f32 v240, v248, v249
    v_cvt_pk_bf16_f32 v241, v250, v251
    v_cvt_pk_bf16_f32 v242, v252, v253
    v_cvt_pk_bf16_f32 v243, v254, v255
    buffer_store_dwordx4 v[240:243], v30, s[32:35], s67 offen offset:1024 sc1
    ds_read_b64_tr_b16 a[0:1], v18 offset:57344
    ds_read_b64_tr_b16 a[2:3], v18 offset:58368
    ds_read_b64_tr_b16 a[4:5], v19 offset:57344
    ds_read_b64_tr_b16 a[6:7], v19 offset:58368
    s_lshl4_add_u32 s57, s95, 786432
    s_add_u32 m0, s60, 8192
    s_nop 0
    s_nop 0
    buffer_load_dwordx4 v22, s[24:27], s57 offen offset:0  lds
    buffer_load_dwordx4 v24, s[24:27], s57 offen offset:1024  lds
    ds_read_b64_tr_b16 a[8:9], v45 offset:8192
    ds_read_b64_tr_b16 a[10:11], v45 offset:9216
    ds_read_b64_tr_b16 a[12:13], v46 offset:8192
    ds_read_b64_tr_b16 a[14:15], v46 offset:9216
    s_waitcnt lgkmcnt(4)
    s_lshl4_add_u32 s57, s96, 786432
    s_add_u32 m0, s60, 57344
    s_nop 0
    buffer_load_dwordx4 v22, s[24:27], s57 offen offset:0  lds
    buffer_load_dwordx4 v24, s[24:27], s57 offen offset:1024  lds
    ds_read_b64_tr_b16 a[16:17], v45 offset:0
    ds_read_b64_tr_b16 a[18:19], v45 offset:1024
    ds_read_b64_tr_b16 a[20:21], v46 offset:0
    ds_read_b64_tr_b16 a[22:23], v46 offset:1024
    s_waitcnt lgkmcnt(4)
    s_lshl4_add_u32 s57, s97, 786432
    s_add_u32 m0, s60, 139264
    s_nop 0
    buffer_load_dwordx4 v22, s[24:27], s57 offen offset:0  lds
    buffer_load_dwordx4 v24, s[24:27], s57 offen offset:1024  lds
    ds_read_b64_tr_b16 a[24:25], v47 offset:24576
    ds_read_b64_tr_b16 a[26:27], v47 offset:25600
    ds_read_b64_tr_b16 a[28:29], v48 offset:24576
    ds_read_b64_tr_b16 a[30:31], v48 offset:25600
    s_waitcnt lgkmcnt(4)
    s_lshl4_add_u32 s57, s98, 786432
    s_add_u32 m0, s60, 131072
    s_nop 0
    buffer_load_dwordx4 v22, s[24:27], s57 offen offset:0  lds
    buffer_load_dwordx4 v24, s[24:27], s57 offen offset:1024  lds
    ds_read_b64_tr_b16 a[32:33], v18 offset:16384
    ds_read_b64_tr_b16 a[34:35], v18 offset:17408
    ds_read_b64_tr_b16 a[36:37], v19 offset:16384
    ds_read_b64_tr_b16 a[38:39], v19 offset:17408
    s_waitcnt lgkmcnt(4)
    s_lshl4_add_u32 s57, s99, 786432
    s_add_u32 m0, s60, 90112
    s_nop 0
    buffer_load_dwordx4 v22, s[24:27], s57 offen offset:0  lds
    buffer_load_dwordx4 v24, s[24:27], s57 offen offset:1024  lds
    ds_read_b64_tr_b16 a[40:41], v18 offset:49152
    ds_read_b64_tr_b16 a[42:43], v18 offset:50176
    ds_read_b64_tr_b16 a[44:45], v19 offset:49152
    ds_read_b64_tr_b16 a[46:47], v19 offset:50176
    s_waitcnt vmcnt(10)
    s_mov_b64 exec, 1
    buffer_store_dword v44, off, s[32:35], s69 offset:128 sc1
    s_mov_b64 exec, -1
    s_waitcnt lgkmcnt(4)
    s_lshl4_add_u32 s57, s100, 786432
    s_add_u32 m0, s60, 16384
    s_nop 0
    s_nop 0
    buffer_load_dwordx4 v22, s[24:27], s57 offen offset:0  lds
    buffer_load_dwordx4 v24, s[24:27], s57 offen offset:1024  lds
    ds_read_b64_tr_b16 a[48:49], v18 offset:24576
    ds_read_b64_tr_b16 a[50:51], v18 offset:25600
    ds_read_b64_tr_b16 a[52:53], v19 offset:24576
    ds_read_b64_tr_b16 a[54:55], v19 offset:25600
    s_waitcnt lgkmcnt(4)
    s_and_b32 s57, s93, 0xc00
    s_lshl4_add_u32 s57, s57, 524288
    s_add_u32 m0, s60, 49152
    s_nop 0
    buffer_load_dwordx4 v21, s[24:27], s57 offen offset:0  lds
    buffer_load_dwordx4 v23, s[24:27], s57 offen offset:1024  lds
    ds_read_b64_tr_b16 a[56:57], v47 offset:57344
    ds_read_b64_tr_b16 a[58:59], v47 offset:58368
    ds_read_b64_tr_b16 a[60:61], v48 offset:57344
    ds_read_b64_tr_b16 a[62:63], v48 offset:58368
    s_waitcnt lgkmcnt(0)
    v_mfma_f32_32x32x16_bf16 v[96:111], a[0:3], a[160:163], 0
    v_mfma_f32_32x32x16_bf16 v[112:127], a[4:7], a[160:163], 0
    s_and_b32 s57, s94, 0xc00
    s_lshl4_add_u32 s57, s57, 524288
    s_add_u32 m0, s60, 24576
    s_nop 0
    buffer_load_dwordx4 v21, s[24:27], s57 offen offset:0  lds
    v_mfma_f32_32x32x16_bf16 v[128:143], a[0:3], a[164:167], 0
    buffer_load_dwordx4 v23, s[24:27], s57 offen offset:1024  lds
    v_mfma_f32_32x32x16_bf16 v[144:159], a[4:7], a[164:167], 0
    ds_read_b64_tr_b16 a[64:65], v45 offset:16384
    ds_read_b64_tr_b16 a[66:67], v45 offset:17408
    ds_read_b64_tr_b16 a[68:69], v46 offset:16384
    ds_read_b64_tr_b16 a[70:71], v46 offset:17408
    s_waitcnt lgkmcnt(0)
    v_mfma_f32_32x32x16_bf16 v[96:111], a[8:11], a[168:171], v[96:111]
    v_mfma_f32_32x32x16_bf16 v[112:127], a[12:15], a[168:171], v[112:127]
    s_and_b32 s57, s95, 0xc00
    s_lshl4_add_u32 s57, s57, 524288
    s_add_u32 m0, s60, 122880
    s_nop 0
    buffer_load_dwordx4 v21, s[24:27], s57 offen offset:0  lds
    v_mfma_f32_32x32x16_bf16 v[128:143], a[8:11], a[172:175], v[128:143]
    buffer_load_dwordx4 v23, s[24:27], s57 offen offset:1024  lds
    v_mfma_f32_32x32x16_bf16 v[144:159], a[12:15], a[172:175], v[144:159]
    ds_read_b64_tr_b16 a[72:73], v47 offset:49152
    ds_read_b64_tr_b16 a[74:75], v47 offset:50176
    ds_read_b64_tr_b16 a[76:77], v48 offset:49152
    ds_read_b64_tr_b16 a[78:79], v48 offset:50176
    s_waitcnt lgkmcnt(0)
    v_mfma_f32_32x32x16_bf16 v[96:111], a[16:19], a[176:179], v[96:111]
    v_mfma_f32_32x32x16_bf16 v[112:127], a[20:23], a[176:179], v[112:127]
    s_and_b32 s57, s96, 0xc00
    s_lshl4_add_u32 s57, s57, 524288
    s_add_u32 m0, s60, 147456
    s_nop 0
    buffer_load_dwordx4 v21, s[24:27], s57 offen offset:0  lds
    v_mfma_f32_32x32x16_bf16 v[128:143], a[16:19], a[180:183], v[128:143]
    buffer_load_dwordx4 v23, s[24:27], s57 offen offset:1024  lds
    v_mfma_f32_32x32x16_bf16 v[144:159], a[20:23], a[180:183], v[144:159]
    ds_read_b64_tr_b16 a[80:81], v47 offset:16384
    ds_read_b64_tr_b16 a[82:83], v47 offset:17408
    ds_read_b64_tr_b16 a[84:85], v48 offset:16384
    ds_read_b64_tr_b16 a[86:87], v48 offset:17408
    s_waitcnt lgkmcnt(0)
    v_mfma_f32_32x32x16_bf16 v[96:111], a[24:27], a[184:187], v[96:111]
    v_mfma_f32_32x32x16_bf16 v[112:127], a[28:31], a[184:187], v[112:127]
    s_lshl4_add_u32 s57, s93, 0
    s_add_u32 m0, s60, 114688
    s_nop 0
    buffer_load_dwordx4 v22, s[28:31], s57 offen offset:0  lds
    v_mfma_f32_32x32x16_bf16 v[128:143], a[24:27], a[188:191], v[128:143]
    buffer_load_dwordx4 v24, s[28:31], s57 offen offset:1024  lds
    buffer_load_dword v38, v31, s[32:35], 0 offen offset:256 sc1
    v_mfma_f32_32x32x16_bf16 v[144:159], a[28:31], a[188:191], v[144:159]
    ds_read_b64_tr_b16 a[88:89], v47 offset:40960
    ds_read_b64_tr_b16 a[90:91], v47 offset:41984
    ds_read_b64_tr_b16 a[92:93], v48 offset:40960
    ds_read_b64_tr_b16 a[94:95], v48 offset:41984
    s_waitcnt lgkmcnt(0)
    v_mfma_f32_32x32x16_bf16 v[96:111], a[32:35], a[192:195], v[96:111]
    v_mfma_f32_32x32x16_bf16 v[112:127], a[36:39], a[192:195], v[112:127]
    s_lshl4_add_u32 s57, s94, 0
    s_add_u32 m0, s60, 81920
    s_nop 0
    buffer_load_dwordx4 v22, s[28:31], s57 offen offset:0  lds
    v_mfma_f32_32x32x16_bf16 v[128:143], a[32:35], a[196:199], v[128:143]
    buffer_load_dwordx4 v24, s[28:31], s57 offen offset:1024  lds
    v_mfma_f32_32x32x16_bf16 v[144:159], a[36:39], a[196:199], v[144:159]
    ds_read_b64_tr_b16 a[96:97], v47 offset:32768
    ds_read_b64_tr_b16 a[98:99], v47 offset:33792
    ds_read_b64_tr_b16 a[100:101], v48 offset:32768
    ds_read_b64_tr_b16 a[102:103], v48 offset:33792
    s_waitcnt lgkmcnt(0)
    v_mfma_f32_32x32x16_bf16 v[96:111], a[40:43], a[200:203], v[96:111]
    v_mfma_f32_32x32x16_bf16 v[112:127], a[44:47], a[200:203], v[112:127]
    s_lshl4_add_u32 s57, s95, 0
    s_add_u32 m0, s60, 106496
    s_nop 0
    buffer_load_dwordx4 v22, s[28:31], s57 offen offset:0  lds
    v_mfma_f32_32x32x16_bf16 v[128:143], a[40:43], a[204:207], v[128:143]
    buffer_load_dwordx4 v24, s[28:31], s57 offen offset:1024  lds
    v_mfma_f32_32x32x16_bf16 v[144:159], a[44:47], a[204:207], v[144:159]
    ds_read_b64_tr_b16 a[104:105], v18 offset:40960
    ds_read_b64_tr_b16 a[106:107], v18 offset:41984
    ds_read_b64_tr_b16 a[108:109], v19 offset:40960
    ds_read_b64_tr_b16 a[110:111], v19 offset:41984
    s_waitcnt lgkmcnt(0)
    v_mfma_f32_32x32x16_bf16 v[96:111], a[48:51], a[208:211], v[96:111]
    v_mfma_f32_32x32x16_bf16 v[112:127], a[52:55], a[208:211], v[112:127]
    v_mfma_f32_32x32x16_bf16 v[128:143], a[48:51], a[212:215], v[128:143]
    s_lshl4_add_u32 s57, s96, 0
    s_add_u32 m0, s60, 98304
    s_nop 0
    buffer_load_dwordx4 v22, s[28:31], s57 offen offset:0  lds
    v_mfma_f32_32x32x16_bf16 v[144:159], a[52:55], a[212:215], v[144:159]
    buffer_load_dwordx4 v24, s[28:31], s57 offen offset:1024  lds
    v_mfma_f32_32x32x16_bf16 v[96:111], a[56:59], a[216:219], v[96:111]
    v_mfma_f32_32x32x16_bf16 v[112:127], a[60:63], a[216:219], v[112:127]
    ds_read_b64_tr_b16 a[112:113], v18 offset:32768
    ds_read_b64_tr_b16 a[114:115], v18 offset:33792
    ds_read_b64_tr_b16 a[116:117], v19 offset:32768
    ds_read_b64_tr_b16 a[118:119], v19 offset:33792
    v_mfma_f32_32x32x16_bf16 v[128:143], a[56:59], a[220:223], v[128:143]
    s_waitcnt vmcnt(6)
    v_cmp_ne_u32 vcc, s49, v38
    s_cbranch_vccnz L_B_again_12
L_B_ok_11:
    buffer_load_dword v38, v31, s[32:35], 0 offen offset:128 sc1
    v_mfma_f32_32x32x16_bf16 v[144:159], a[60:63], a[220:223], v[144:159]
    s_lshl4_add_u32 s57, s97, 0
    s_add_u32 m0, s60, 40960
    s_nop 0
    s_nop 0
    buffer_load_dwordx4 v22, s[28:31], s57 offen offset:0  lds
    s_add_u32 s73, s93, 81920
    buffer_load_dwordx4 a[224:227], v27, s[32:35], s73 offen sc1
    buffer_load_dwordx4 a[228:231], v28, s[32:35], s73 offen sc1
    s_add_u32 s73, s94, 81920
    buffer_load_dwordx4 a[232:235], v27, s[32:35], s73 offen sc1
    buffer_load_dwordx4 a[236:239], v28, s[32:35], s73 offen sc1
    s_add_u32 s73, s95, 81920
    buffer_load_dwordx4 a[240:243], v27, s[32:35], s73 offen sc1
    buffer_load_dwordx4 a[244:247], v28, s[32:35], s73 offen sc1
    s_add_u32 s73, s96, 81920
    buffer_load_dwordx4 a[248:251], v27, s[32:35], s73 offen sc1
    buffer_load_dwordx4 a[252:255], v28, s[32:35], s73 offen sc1
    s_add_u32 s73, s97, 81920
    buffer_load_dwordx4 a[160:163], v27, s[32:35], s73 offen sc1
    buffer_load_dwordx4 a[164:167], v28, s[32:35], s73 offen sc1
    s_waitcnt lgkmcnt(0)
    s_waitcnt vmcnt(9)
    v_mfma_f32_32x32x16_bf16 v[96:111], a[64:67], a[224:227], v[96:111]
    v_mfma_f32_32x32x16_bf16 v[112:127], a[68:71], a[224:227], v[112:127]
    buffer_load_dwordx4 v24, s[28:31], s57 offen offset:1024  lds
    s_waitcnt vmcnt(9)
    v_mfma_f32_32x32x16_bf16 v[128:143], a[64:67], a[228:231], v[128:143]
    ds_read_b64_tr_b16 a[120:121], v47 offset:8192
    ds_read_b64_tr_b16 a[122:123], v47 offset:9216
    ds_read_b64_tr_b16 a[124:125], v48 offset:8192
    ds_read_b64_tr_b16 a[126:127], v48 offset:9216
    v_mfma_f32_32x32x16_bf16 v[144:159], a[68:71], a[228:231], v[144:159]
    s_add_u32 s73, s98, 81920
    buffer_load_dwordx4 a[168:171], v27, s[32:35], s73 offen sc1
    buffer_load_dwordx4 a[172:175], v28, s[32:35], s73 offen sc1
    s_waitcnt lgkmcnt(0)
    s_waitcnt vmcnt(10)
    v_mfma_f32_32x32x16_bf16 v[96:111], a[72:75], a[232:235], v[96:111]
    v_mfma_f32_32x32x16_bf16 v[112:127], a[76:79], a[232:235], v[112:127]
    s_lshl4_add_u32 s57, s98, 0
    s_add_u32 m0, s60, 32768
    s_nop 0
    buffer_load_dwordx4 v22, s[28:31], s57 offen offset:0  lds
L_islB4:
    s_cbranch_execz L_retB
    s_waitcnt vmcnt(10)
    v_mfma_f32_32x32x16_bf16 v[128:143], a[72:75], a[236:239], v[128:143]
    buffer_load_dwordx4 v24, s[28:31], s57 offen offset:1024  lds
    v_mfma_f32_32x32x16_bf16 v[144:159], a[76:79], a[236:239], v[144:159]
    s_nop 0
    ds_read_b64_tr_b16 a[128:129], v47 offset:0
    ds_read_b64_tr_b16 a[130:131], v47 offset:1024
    ds_read_b64_tr_b16 a[132:133], v48 offset:0
    ds_read_b64_tr_b16 a[134:135], v48 offset:1024
    s_add_u32 s73, s99, 81920
    buffer_load_dwordx4 a[176:179], v27, s[32:35], s73 offen sc1
    buffer_load_dwordx4 a[180:183], v28, s[32:35], s73 offen sc1
    s_waitcnt lgkmcnt(0)
    s_waitcnt vmcnt(12)
    v_mfma_f32_32x32x16_bf16 v[96:111], a[80:83], a[240:243], v[96:111]
    v_mfma_f32_32x32x16_bf16 v[112:127], a[84:87], a[240:243], v[112:127]
    s_waitcnt vmcnt(11)
    v_mfma_f32_32x32x16_bf16 v[128:143], a[80:83], a[244:247], v[128:143]
    s_lshl4_add_u32 s57, s99, 0
    s_add_u32 m0, s60, 73728
    s_nop 0
    buffer_load_dwordx4 v22, s[28:31], s57 offen offset:0  lds
    v_mfma_f32_32x32x16_bf16 v[144:159], a[84:87], a[244:247], v[144:159]
    buffer_load_dwordx4 v24, s[28:31], s57 offen offset:1024  lds
    s_add_u32 s73, s100, 81920
    buffer_load_dwordx4 a[184:187], v27, s[32:35], s73 offen sc1
    buffer_load_dwordx4 a[188:191], v28, s[32:35], s73 offen sc1
    s_waitcnt vmcnt(14)
    v_mfma_f32_32x32x16_bf16 v[96:111], a[88:91], a[248:251], v[96:111]
    v_mfma_f32_32x32x16_bf16 v[112:127], a[92:95], a[248:251], v[112:127]
    s_waitcnt vmcnt(13)
    v_mfma_f32_32x32x16_bf16 v[128:143], a[88:91], a[252:255], v[128:143]
    s_lshl4_add_u32 s57, s100, 0
    s_add_u32 m0, s60, 65536
    s_nop 0
    buffer_load_dwordx4 v22, s[28:31], s57 offen offset:0  lds
    v_cmp_ne_u32 vcc, s49, v38
    s_cbranch_vccnz L_B_again_14
L_B_ok_13:
    v_mfma_f32_32x32x16_bf16 v[144:159], a[92:95], a[252:255], v[144:159]
    buffer_load_dwordx4 v24, s[28:31], s57 offen offset:1024  lds
    s_add_u32 s73, s93, 49152
    buffer_load_dwordx4 a[192:195], v27, s[32:35], s73 offen sc1
    buffer_load_dwordx4 a[196:199], v28, s[32:35], s73 offen sc1
    s_waitcnt vmcnt(16)
    v_mfma_f32_32x32x16_bf16 v[96:111], a[96:99], a[160:163], v[96:111]
    v_mfma_f32_32x32x16_bf16 v[112:127], a[100:103], a[160:163], v[112:127]
    s_waitcnt vmcnt(15)
    v_mfma_f32_32x32x16_bf16 v[128:143], a[96:99], a[164:167], v[128:143]
    v_mfma_f32_32x32x16_bf16 v[144:159], a[100:103], a[164:167], v[144:159]
    s_add_u32 s73, s94, 49152
    buffer_load_dwordx4 a[200:203], v27, s[32:35], s73 offen sc1
    buffer_load_dwordx4 a[204:207], v28, s[32:35], s73 offen sc1
    s_waitcnt vmcnt(15)
    v_mfma_f32_32x32x16_bf16 v[96:111], a[104:107], a[168:171], v[96:111]
    v_mfma_f32_32x32x16_bf16 v[112:127], a[108:111], a[168:171], v[112:127]
    s_waitcnt vmcnt(14)
    v_mfma_f32_32x32x16_bf16 v[128:143], a[104:107], a[172:175], v[128:143]
    v_mfma_f32_32x32x16_bf16 v[144:159], a[108:111], a[172:175], v[144:159]
    s_add_u32 s73, s95, 49152
    buffer_load_dwordx4 a[208:211], v27, s[32:35], s73 offen sc1
    buffer_load_dwordx4 a[212:215], v28, s[32:35], s73 offen sc1
    s_waitcnt vmcnt(13)
    v_mfma_f32_32x32x16_bf16 v[96:111], a[112:115], a[176:179], v[96:111]
    v_mfma_f32_32x32x16_bf16 v[112:127], a[116:119], a[176:179], v[112:127]
    s_waitcnt vmcnt(12)
    v_mfma_f32_32x32x16_bf16 v[128:143], a[112:115], a[180:183], v[128:143]
    v_mfma_f32_32x32x16_bf16 v[144:159], a[116:119], a[180:183], v[144:159]
    s_add_u32 s73, s96, 49152
    buffer_load_dwordx4 a[216:219], v27, s[32:35], s73 offen sc1
    buffer_load_dwordx4 a[220:223], v28, s[32:35], s73 offen sc1
    s_waitcnt vmcnt(11)
    v_mfma_f32_32x32x16_bf16 v[96:111], a[120:123], a[184:187], v[96:111]
    v_mfma_f32_32x32x16_bf16 v[112:127], a[124:127], a[184:187], v[112:127]
    s_waitcnt vmcnt(10)
    v_mfma_f32_32x32x16_bf16 v[128:143], a[120:123], a[188:191], v[128:143]
    v_mfma_f32_32x32x16_bf16 v[144:159], a[124:127], a[188:191], v[144:159]
    s_add_u32 s73, s97, 49152
    buffer_load_dwordx4 a[224:227], v27, s[32:35], s73 offen sc1
    buffer_load_dwordx4 a[228:231], v28, s[32:35], s73 offen sc1
    s_waitcnt vmcnt(9)
    v_mfma_f32_32x32x16_bf16 v[96:111], a[128:131], a[192:195], v[96:111]
    ds_read_b64_tr_b16 v[80:81], v18 offset:0
    ds_read_b64_tr_b16 v[82:83], v18 offset:1024
    v_mfma_f32_32x32x16_bf16 v[112:127], a[132:135], a[192:195], v[112:127]
    ds_read_b64_tr_b16 v[84:85], v19 offset:0
    ds_read_b64_tr_b16 v[86:87], v19 offset:1024
    s_waitcnt vmcnt(8)
    v_mfma_f32_32x32x16_bf16 v[128:143], a[128:131], a[196:199], v[128:143]
    v_mfma_f32_32x32x16_bf16 v[144:159], a[132:135], a[196:199], v[144:159]
    s_add_u32 s73, s98, 49152
    buffer_load_dwordx4 a[232:235], v27, s[32:35], s73 offen sc1
    buffer_load_dwordx4 a[236:239], v28, s[32:35], s73 offen sc1
    s_waitcnt lgkmcnt(0)
    s_waitcnt vmcnt(9)
    v_mfma_f32_32x32x16_bf16 v[96:111], v[80:83], a[200:203], v[96:111]
    ds_read_b64_tr_b16 v[64:65], v18 offset:8192
    ds_read_b64_tr_b16 v[66:67], v18 offset:9216
    v_mfma_f32_32x32x16_bf16 v[112:127], v[84:87], a[200:203], v[112:127]
    ds_read_b64_tr_b16 v[68:69], v19 offset:8192
    ds_read_b64_tr_b16 v[70:71], v19 offset:9216
    s_waitcnt vmcnt(8)
    v_mfma_f32_32x32x16_bf16 v[128:143], v[80:83], a[204:207], v[128:143]
    v_mfma_f32_32x32x16_bf16 v[144:159], v[84:87], a[204:207], v[144:159]
    s_add_u32 s73, s99, 49152
    buffer_load_dwordx4 a[240:243], v27, s[32:35], s73 offen sc1
    buffer_load_dwordx4 a[244:247], v28, s[32:35], s73 offen sc1
    s_waitcnt lgkmcnt(0)
    s_waitcnt vmcnt(9)
    v_mfma_f32_32x32x16_bf16 v[96:111], v[64:67], a[208:211], v[96:111]
    ds_read_b64_tr_b16 v[80:81], v18 offset:57344
    ds_read_b64_tr_b16 v[82:83], v18 offset:58368
    v_mfma_f32_32x32x16_bf16 v[112:127], v[68:71], a[208:211], v[112:127]
    ds_read_b64_tr_b16 v[84:85], v19 offset:57344
    ds_read_b64_tr_b16 v[86:87], v19 offset:58368
    s_waitcnt vmcnt(8)
    v_mfma_f32_32x32x16_bf16 v[128:143], v[64:67], a[212:215], v[128:143]
    v_mfma_f32_32x32x16_bf16 v[144:159], v[68:71], a[212:215], v[144:159]
    s_add_u32 s73, s100, 49152
    buffer_load_dwordx4 a[248:251], v27, s[32:35], s73 offen sc1
    buffer_load_dwordx4 a[252:255], v28, s[32:35], s73 offen sc1
    s_waitcnt lgkmcnt(0)
    s_waitcnt vmcnt(9)
    v_mfma_f32_32x32x16_bf16 v[96:111], v[80:83], a[216:219], v[96:111]
    ds_read_b64_tr_b16 v[64:65], v45 offset:8192
    ds_read_b64_tr_b16 v[66:67], v45 offset:9216
    v_mfma_f32_32x32x16_bf16 v[112:127], v[84:87], a[216:219], v[112:127]
    ds_read_b64_tr_b16 v[68:69], v46 offset:8192
    ds_read_b64_tr_b16 v[70:71], v46 offset:9216
    s_waitcnt vmcnt(8)
    v_mfma_f32_32x32x16_bf16 v[128:143], v[80:83], a[220:223], v[128:143]
    buffer_load_dword v38, v31, s[32:35], 0 offen offset:384 sc1
    v_mfma_f32_32x32x16_bf16 v[144:159], v[84:87], a[220:223], v[144:159]
    s_and_b32 s73, s93, 0xc00
    s_add_u32 s73, s73, 32768
    buffer_load_dwordx4 a[160:163], v25, s[32:35], s73 offen sc1
    buffer_load_dwordx4 a[164:167], v26, s[32:35], s73 offen sc1
    s_waitcnt lgkmcnt(0)
    s_waitcnt vmcnt(10)
    v_mfma_f32_32x32x16_bf16 v[96:111], v[64:67], a[224:227], v[96:111]
    ds_read_b64_tr_b16 v[80:81], v45 offset:0
    ds_read_b64_tr_b16 v[82:83], v45 offset:1024
    v_mfma_f32_32x32x16_bf16 v[112:127], v[68:71], a[224:227], v[112:127]
    ds_read_b64_tr_b16 v[84:85], v46 offset:0
    ds_read_b64_tr_b16 v[86:87], v46 offset:1024
    s_waitcnt vmcnt(9)
    v_mfma_f32_32x32x16_bf16 v[128:143], v[64:67], a[228:231], v[128:143]
    v_mfma_f32_32x32x16_bf16 v[144:159], v[68:71], a[228:231], v[144:159]
    s_and_b32 s73, s94, 0xc00
    s_add_u32 s73, s73, 32768
    buffer_load_dwordx4 a[168:171], v25, s[32:35], s73 offen sc1
    buffer_load_dwordx4 a[172:175], v26, s[32:35], s73 offen sc1
    s_waitcnt lgkmcnt(0)
    s_waitcnt vmcnt(10)
    v_mfma_f32_32x32x16_bf16 v[96:111], v[80:83], a[232:235], v[96:111]
    ds_read_b64_tr_b16 v[64:65], v47 offset:24576
    ds_read_b64_tr_b16 v[66:67], v47 offset:25600
    v_mfma_f32_32x32x16_bf16 v[112:127], v[84:87], a[232:235], v[112:127]
    ds_read_b64_tr_b16 v[68:69], v48 offset:24576
    ds_read_b64_tr_b16 v[70:71], v48 offset:25600
    s_waitcnt vmcnt(9)
    v_mfma_f32_32x32x16_bf16 v[128:143], v[80:83], a[236:239], v[128:143]
    v_mfma_f32_32x32x16_bf16 v[144:159], v[84:87], a[236:239], v[144:159]
    s_and_b32 s73, s95, 0xc00
    s_add_u32 s73, s73, 32768
    buffer_load_dwordx4 a[176:179], v25, s[32:35], s73 offen sc1
    buffer_load_dwordx4 a[180:183], v26, s[32:35], s73 offen sc1
    s_waitcnt lgkmcnt(0)
    s_waitcnt vmcnt(10)
    v_mfma_f32_32x32x16_bf16 v[96:111], v[64:67], a[240:243], v[96:111]
    ds_read_b64_tr_b16 v[80:81], v18 offset:16384
    ds_read_b64_tr_b16 v[82:83], v18 offset:17408
    v_mfma_f32_32x32x16_bf16 v[112:127], v[68:71], a[240:243], v[112:127]
    ds_read_b64_tr_b16 v[84:85], v19 offset:16384
    ds_read_b64_tr_b16 v[86:87], v19 offset:17408
    s_waitcnt vmcnt(9)
    v_mfma_f32_32x32x16_bf16 v[128:143], v[64:67], a[244:247], v[128:143]
    v_mfma_f32_32x32x16_bf16 v[144:159], v[68:71], a[244:247], v[144:159]
    s_and_b32 s73, s96, 0xc00
    s_add_u32 s73, s73, 32768
    buffer_load_dwordx4 a[184:187], v25, s[32:35], s73 offen sc1
    buffer_load_dwordx4 a[188:191], v26, s[32:35], s73 offen sc1
    s_waitcnt lgkmcnt(0)
    s_waitcnt vmcnt(10)
    v_mfma_f32_32x32x16_bf16 v[96:111], v[80:83], a[248:251], v[96:111]
    ds_read_b64_tr_b16 v[64:65], v18 offset:49152
    ds_read_b64_tr_b16 v[66:67], v18 offset:50176
    v_mfma_f32_32x32x16_bf16 v[112:127], v[84:87], a[248:251], v[112:127]
    ds_read_b64_tr_b16 v[68:69], v19 offset:49152
    ds_read_b64_tr_b16 v[70:71], v19 offset:50176
    s_waitcnt vmcnt(9)
    v_mfma_f32_32x32x16_bf16 v[128:143], v[80:83], a[252:255], v[128:143]
    s_waitcnt vmcnt(8)
    v_cmp_ne_u32 vcc, s49, v38
    s_cbranch_vccnz L_B_again_16
L_B_ok_15:
    v_mfma_f32_32x32x16_bf16 v[144:159], v[84:87], a[252:255], v[144:159]
    s_add_u32 s73, s93, 114688
    buffer_load_dwordx4 a[192:195], v27, s[32:35], s73 offen sc1
    s_add_u32 s73, s94, 114688
    buffer_load_dwordx4 a[200:203], v27, s[32:35], s73 offen sc1
    s_waitcnt lgkmcnt(0)
    v_mbcnt_lo_u32_b32 v2, -1, 0
    v_mbcnt_hi_u32_b32 v2, -1, v2
    v_and_b32 v3, 7, v2
    v_lshrrev_b32 v4, 5, v2
    v_xor_b32 v4, v4, v3
    v_lshlrev_b32 v4, 4, v4
    v_lshl_add_u32 v4, v3, 8, v4
    v_bfe_u32 v5, v2, 3, 2
    v_lshl_add_u32 v4, v5, 13, v4
    s_mul_i32 s52, s45, 32768
    s_lshl_b32 s53, s46, 7
    s_add_u32 s52, s52, s53
    s_add_u32 s52, s52, s60
    v_add_u32 v160, s52, v4
    v_xor_b32 v161, 32, v160
    v_xor_b32 v162, 64, v160
    v_xor_b32 v163, 96, v160
    v_xor_b32 v164, 128, v160
    v_xor_b32 v165, 160, v160
    v_xor_b32 v166, 192, v160
    v_xor_b32 v167, 224, v160
    v_xor_b32 v168, 32768, v160
    v_xor_b32 v169, 32800, v160
    v_xor_b32 v170, 32832, v160
    v_xor_b32 v171, 32864, v160
    v_xor_b32 v172, 32896, v160
    v_xor_b32 v173, 32928, v160
    v_xor_b32 v174, 32960, v160
    v_xor_b32 v175, 32992, v160
    v_lshrrev_b32 v5, 3, v2
    v_lshlrev_b32 v6, 1, v3
    v_xor_b32 v6, v6, v5
    v_lshlrev_b32 v6, 4, v6
    v_lshl_add_u32 v6, v5, 8, v6
    s_lshl_b32 s52, s44, 14
    v_add_u32 v6, s52, v6
    v_xor_b32 v7, 16, v6
    v_lshlrev_b32 v3, 4, v3
    v_lshl_add_u32 v3, v5, 10, v3
    s_lshl2_add_u32 s52, s50, s44
    s_lshl_b32 s52, s52, 14
    s_lshl_b32 s53, s51, 7
    s_add_u32 s52, s52, s53
    v_add_u32_e64 v3, s52, v3
    s_mov_b32 s54, 8192
    s_waitcnt vmcnt(9)
    v_mfma_f32_32x32x16_bf16 v[96:111], v[64:67], a[160:163], v[96:111]
    ds_read_b64_tr_b16 v[80:81], v18 offset:24576
    ds_read_b64_tr_b16 v[82:83], v18 offset:25600
    v_mfma_f32_32x32x16_bf16 v[112:127], v[68:71], a[160:163], v[112:127]
    ds_read_b64_tr_b16 v[84:85], v19 offset:24576
    ds_read_b64_tr_b16 v[86:87], v19 offset:25600
    s_waitcnt vmcnt(8)
    v_mfma_f32_32x32x16_bf16 v[128:143], v[64:67], a[164:167], v[128:143]
    v_mfma_f32_32x32x16_bf16 v[144:159], v[68:71], a[164:167], v[144:159]
    s_add_u32 s73, s95, 114688
    buffer_load_dwordx4 a[208:211], v27, s[32:35], s73 offen sc1
    s_add_u32 s73, s96, 114688
    buffer_load_dwordx4 a[216:219], v27, s[32:35], s73 offen sc1
    s_waitcnt lgkmcnt(0)
    s_waitcnt vmcnt(9)
    v_mfma_f32_32x32x16_bf16 v[96:111], v[80:83], a[168:171], v[96:111]
    ds_read_b64_tr_b16 v[64:65], v47 offset:57344
    ds_read_b64_tr_b16 v[66:67], v47 offset:58368
    v_mfma_f32_32x32x16_bf16 v[112:127], v[84:87], a[168:171], v[112:127]
    ds_read_b64_tr_b16 v[68:69], v48 offset:57344
    ds_read_b64_tr_b16 v[70:71], v48 offset:58368
    s_waitcnt vmcnt(8)
    v_mfma_f32_32x32x16_bf16 v[128:143], v[80:83], a[172:175], v[128:143]
    v_mfma_f32_32x32x16_bf16 v[144:159], v[84:87], a[172:175], v[144:159]
    s_add_u32 s73, s97, 114688
    buffer_load_dwordx4 a[224:227], v27, s[32:35], s73 offen sc1
    s_add_u32 s73, s98, 114688
    buffer_load_dwordx4 a[232:235], v27, s[32:35], s73 offen sc1
    s_waitcnt lgkmcnt(0)
    s_waitcnt vmcnt(9)
    v_mfma_f32_32x32x16_bf16 v[96:111], v[64:67], a[176:179], v[96:111]
    ds_read_b64_tr_b16 v[80:81], v45 offset:16384
    ds_read_b64_tr_b16 v[82:83], v45 offset:17408
    v_mfma_f32_32x32x16_bf16 v[112:127], v[68:71], a[176:179], v[112:127]
    ds_read_b64_tr_b16 v[84:85], v46 offset:16384
    ds_read_b64_tr_b16 v[86:87], v46 offset:17408
    s_waitcnt vmcnt(8)
    v_mfma_f32_32x32x16_bf16 v[128:143], v[64:67], a[180:183], v[128:143]
    v_mfma_f32_32x32x16_bf16 v[144:159], v[68:71], a[180:183], v[144:159]
    s_add_u32 s73, s99, 114688
    buffer_load_dwordx4 a[240:243], v27, s[32:35], s73 offen sc1
    s_add_u32 s73, s100, 114688
    buffer_load_dwordx4 a[248:251], v27, s[32:35], s73 offen sc1
    s_waitcnt lgkmcnt(0)
    s_waitcnt vmcnt(9)
    v_mfma_f32_32x32x16_bf16 v[96:111], v[80:83], a[184:187], v[96:111]
    ds_read_b64_tr_b16 a[0:1], v47 offset:49152
    ds_read_b64_tr_b16 a[2:3], v47 offset:50176
    ds_read_b64_tr_b16 a[4:5], v48 offset:49152
    v_mfma_f32_32x32x16_bf16 v[112:127], v[84:87], a[184:187], v[112:127]
    ds_read_b64_tr_b16 a[6:7], v48 offset:50176
    ds_read_b64_tr_b16 a[8:9], v47 offset:16384
    ds_read_b64_tr_b16 a[10:11], v47 offset:17408
    s_waitcnt vmcnt(8)
    v_mfma_f32_32x32x16_bf16 v[128:143], v[80:83], a[188:191], v[128:143]
    ds_read_b64_tr_b16 a[12:13], v48 offset:16384
    ds_read_b64_tr_b16 a[14:15], v48 offset:17408
    v_mfma_f32_32x32x16_bf16 v[144:159], v[84:87], a[188:191], v[144:159]
    s_add_u32 s73, s93, 114688
    buffer_load_dwordx4 a[196:199], v28, s[32:35], s73 offen sc1
    s_add_u32 s73, s94, 114688
    buffer_load_dwordx4 a[204:207], v28, s[32:35], s73 offen sc1
    s_waitcnt lgkmcnt(0)
    s_waitcnt vmcnt(9)
    v_mfma_f32_32x32x16_bf16 v[96:111], a[0:3], a[192:195], v[96:111]
    ds_read_b64_tr_b16 a[16:17], v47 offset:40960
    ds_read_b64_tr_b16 a[18:19], v47 offset:41984
    ds_read_b64_tr_b16 a[20:21], v48 offset:40960
    v_mfma_f32_32x32x16_bf16 v[112:127], a[4:7], a[192:195], v[112:127]
    ds_read_b64_tr_b16 a[22:23], v48 offset:41984
    ds_read_b64_tr_b16 a[24:25], v47 offset:32768
    ds_read_b64_tr_b16 a[26:27], v47 offset:33792
    s_waitcnt vmcnt(8)
    v_mfma_f32_32x32x16_bf16 v[96:111], a[8:11], a[200:203], v[96:111]
    ds_read_b64_tr_b16 a[28:29], v48 offset:32768
    ds_read_b64_tr_b16 a[30:31], v48 offset:33792
    v_mfma_f32_32x32x16_bf16 v[112:127], a[12:15], a[200:203], v[112:127]
    s_add_u32 s73, s95, 114688
    buffer_load_dwordx4 a[212:215], v28, s[32:35], s73 offen sc1
    s_add_u32 s73, s96, 114688
    buffer_load_dwordx4 a[220:223], v28, s[32:35], s73 offen sc1
    s_waitcnt lgkmcnt(0)
    s_waitcnt vmcnt(9)
    v_mfma_f32_32x32x16_bf16 v[96:111], a[16:19], a[208:211], v[96:111]
    ds_read_b64_tr_b16 a[32:33], v18 offset:40960
    ds_read_b64_tr_b16 a[34:35], v18 offset:41984
    ds_read_b64_tr_b16 a[36:37], v19 offset:40960
    v_mfma_f32_32x32x16_bf16 v[112:127], a[20:23], a[208:211], v[112:127]
    ds_read_b64_tr_b16 a[38:39], v19 offset:41984
    ds_read_b64_tr_b16 a[40:41], v18 offset:32768
    ds_read_b64_tr_b16 a[42:43], v18 offset:33792
    s_waitcnt vmcnt(8)
    v_mfma_f32_32x32x16_bf16 v[96:111], a[24:27], a[216:219], v[96:111]
    ds_read_b64_tr_b16 a[44:45], v19 offset:32768
    ds_read_b64_tr_b16 a[46:47], v19 offset:33792
    v_mfma_f32_32x32x16_bf16 v[112:127], a[28:31], a[216:219], v[112:127]
    s_add_u32 s73, s97, 114688
    buffer_load_dwordx4 a[228:231], v28, s[32:35], s73 offen sc1
    s_add_u32 s73, s98, 114688
    buffer_load_dwordx4 a[236:239], v28, s[32:35], s73 offen sc1
    s_waitcnt lgkmcnt(0)
    s_waitcnt vmcnt(9)
    v_mfma_f32_32x32x16_bf16 v[96:111], a[32:35], a[224:227], v[96:111]
    ds_read_b64_tr_b16 a[48:49], v47 offset:8192
    ds_read_b64_tr_b16 a[50:51], v47 offset:9216
    ds_read_b64_tr_b16 a[52:53], v48 offset:8192
    v_mfma_f32_32x32x16_bf16 v[112:127], a[36:39], a[224:227], v[112:127]
    ds_read_b64_tr_b16 a[54:55], v48 offset:9216
    ds_read_b64_tr_b16 a[56:57], v47 offset:0
    ds_read_b64_tr_b16 a[58:59], v47 offset:1024
    s_waitcnt vmcnt(8)
    v_mfma_f32_32x32x16_bf16 v[96:111], a[40:43], a[232:235], v[96:111]
    ds_read_b64_tr_b16 a[60:61], v48 offset:0
    ds_read_b64_tr_b16 a[62:63], v48 offset:1024
    v_mfma_f32_32x32x16_bf16 v[112:127], a[44:47], a[232:235], v[112:127]
    s_add_u32 s73, s99, 114688
    buffer_load_dwordx4 a[244:247], v28, s[32:35], s73 offen sc1
    s_add_u32 s73, s100, 114688
    buffer_load_dwordx4 a[252:255], v28, s[32:35], s73 offen sc1
    s_waitcnt lgkmcnt(0)
    s_waitcnt vmcnt(9)
    v_mfma_f32_32x32x16_bf16 v[96:111], a[48:51], a[240:243], v[96:111]
    v_mfma_f32_32x32x16_bf16 v[112:127], a[52:55], a[240:243], v[112:127]
    s_waitcnt vmcnt(8)
    v_mfma_f32_32x32x16_bf16 v[96:111], a[56:59], a[248:251], v[96:111]
    v_mfma_f32_32x32x16_bf16 v[112:127], a[60:63], a[248:251], v[112:127]
    s_waitcnt vmcnt(7)
    v_mfma_f32_32x32x16_bf16 v[128:143], a[0:3], a[196:199], v[128:143]
    v_mfma_f32_32x32x16_bf16 v[144:159], a[4:7], a[196:199], v[144:159]
    s_nop 7
    ds_write_b128 v160, v[96:99]
    s_waitcnt vmcnt(6)
    v_mfma_f32_32x32x16_bf16 v[128:143], a[8:11], a[204:207], v[128:143]
    v_mfma_f32_32x32x16_bf16 v[144:159], a[12:15], a[204:207], v[144:159]
    ds_write_b128 v161, v[100:103]
    s_waitcnt vmcnt(5)
    v_mfma_f32_32x32x16_bf16 v[128:143], a[16:19], a[212:215], v[128:143]
    v_mfma_f32_32x32x16_bf16 v[144:159], a[20:23], a[212:215], v[144:159]
    ds_write_b128 v162, v[104:107]
    s_waitcnt vmcnt(4)
    v_mfma_f32_32x32x16_bf16 v[128:143], a[24:27], a[220:223], v[128:143]
    v_mfma_f32_32x32x16_bf16 v[144:159], a[28:31], a[220:223], v[144:159]
    ds_write_b128 v163, v[108:111]
    s_waitcnt vmcnt(3)
    v_mfma_f32_32x32x16_bf16 v[128:143], a[32:35], a[228:231], v[128:143]
    v_mfma_f32_32x32x16_bf16 v[144:159], a[36:39], a[228:231], v[144:159]
    ds_write_b128 v164, v[112:115]
    s_waitcnt vmcnt(2)
    v_mfma_f32_32x32x16_bf16 v[128:143], a[40:43], a[236:239], v[128:143]
    v_mfma_f32_32x32x16_bf16 v[144:159], a[44:47], a[236:239], v[144:159]
    ds_write_b128 v165, v[116:119]
    s_waitcnt vmcnt(1)
    v_mfma_f32_32x32x16_bf16 v[128:143], a[48:51], a[244:247], v[128:143]
    v_mfma_f32_32x32x16_bf16 v[144:159], a[52:55], a[244:247], v[144:159]
    ds_write_b128 v166, v[120:123]
    s_waitcnt vmcnt(0)
    v_mfma_f32_32x32x16_bf16 v[128:143], a[56:59], a[252:255], v[128:143]
    v_mfma_f32_32x32x16_bf16 v[144:159], a[60:63], a[252:255], v[144:159]
    ds_write_b128 v167, v[124:127]
    s_nop 9
    s_nop 0
    ds_write_b128 v168, v[128:131]
    ds_write_b128 v169, v[132:135]
    ds_write_b128 v170, v[136:139]
    ds_write_b128 v171, v[140:143]
    ds_write_b128 v172, v[144:147]
    ds_write_b128 v173, v[148:151]
    ds_write_b128 v174, v[152:155]
    ds_write_b128 v175, v[156:159]
    s_waitcnt lgkmcnt(0)
    s_barrier
    ds_read_b128 v[96:99], v6 offset:0
    ds_read_b128 v[100:103], v7 offset:0
    ds_read_b128 v[104:107], v6 offset:2048
    ds_read_b128 v[108:111], v7 offset:2048
    ds_read_b128 v[112:115], v6 offset:4096
    ds_read_b128 v[116:119], v7 offset:4096
    ds_read_b128 v[120:123], v6 offset:6144
    ds_read_b128 v[124:127], v7 offset:6144
    ds_read_b128 v[128:131], v6 offset:8192
    ds_read_b128 v[132:135], v7 offset:8192
    ds_read_b128 v[136:139], v6 offset:10240
    ds_read_b128 v[140:143], v7 offset:10240
    ds_read_b128 v[144:147], v6 offset:12288
    ds_read_b128 v[148:151], v7 offset:12288
    ds_read_b128 v[152:155], v6 offset:14336
    ds_read_b128 v[156:159], v7 offset:14336
    s_waitcnt lgkmcnt(13)
    v_pk_add_f32 v[96:97], v[96:97], v[104:105]
    v_pk_add_f32 v[98:99], v[98:99], v[106:107]
    s_waitcnt lgkmcnt(12)
    v_pk_add_f32 v[100:101], v[100:101], v[108:109]
    v_pk_add_f32 v[102:103], v[102:103], v[110:111]
    s_waitcnt lgkmcnt(9)
    v_pk_add_f32 v[112:113], v[112:113], v[120:121]
    v_pk_add_f32 v[114:115], v[114:115], v[122:123]
    s_waitcnt lgkmcnt(8)
    v_pk_add_f32 v[116:117], v[116:117], v[124:125]
    v_pk_add_f32 v[118:119], v[118:119], v[126:127]
    v_pk_add_f32 v[96:97], v[96:97], v[112:113]
    v_pk_add_f32 v[98:99], v[98:99], v[114:115]
    v_pk_add_f32 v[100:101], v[100:101], v[116:117]
    v_pk_add_f32 v[102:103], v[102:103], v[118:119]
    v_cvt_pk_bf16_f32 v176, v96, v97
    v_cvt_pk_bf16_f32 v177, v98, v99
    v_cvt_pk_bf16_f32 v178, v100, v101
    v_cvt_pk_bf16_f32 v179, v102, v103
    buffer_store_dwordx4 v[176:179], v3, s[36:39], 0 offen sc1
    s_waitcnt lgkmcnt(5)
    v_pk_add_f32 v[128:129], v[128:129], v[136:137]
    v_pk_add_f32 v[130:131], v[130:131], v[138:139]
    s_waitcnt lgkmcnt(4)
    v_pk_add_f32 v[132:133], v[132:133], v[140:141]
    v_pk_add_f32 v[134:135], v[134:135], v[142:143]
    s_waitcnt lgkmcnt(1)
    v_pk_add_f32 v[144:145], v[144:145], v[152:153]
    v_pk_add_f32 v[146:147], v[146:147], v[154:155]
    s_waitcnt lgkmcnt(0)
    v_pk_add_f32 v[148:149], v[148:149], v[156:157]
    v_pk_add_f32 v[150:151], v[150:151], v[158:159]
    v_pk_add_f32 v[128:129], v[128:129], v[144:145]
    v_pk_add_f32 v[130:131], v[130:131], v[146:147]
    v_pk_add_f32 v[132:133], v[132:133], v[148:149]
    v_pk_add_f32 v[134:135], v[134:135], v[150:151]
    v_cvt_pk_bf16_f32 v180, v128, v129
    v_cvt_pk_bf16_f32 v181, v130, v131
    v_cvt_pk_bf16_f32 v182, v132, v133
    v_cvt_pk_bf16_f32 v183, v134, v135
    buffer_store_dwordx4 v[180:183], v3, s[36:39], s54 offen sc1
    s_or_b32 s52, s2, s44
    s_cmp_eq_u32 s52, 0
    s_cbranch_scc1 L_B_noep_17_go
L_B_noep_17:
    s_endpgm
L_stopB:
L_B_again_6:
    s_sleep 2
    buffer_load_dwordx2 v[40:41], v230, s[32:35], 0 offen offset:0 sc1
    s_add_u32 s75, s75, 1
    s_waitcnt vmcnt(0)
    v_cmp_ne_u32 vcc, s49, v41
    s_cmp_lt_u32 s75, 0x40000
    s_cbranch_scc0 L_B_ok_5
    s_cbranch_vccnz L_B_again_6
    s_branch L_B_ok_5
L_B_again_8:
    s_sleep 2
    buffer_load_dwordx2 v[42:43], v230, s[32:35], 0 offen offset:256 sc1
    s_add_u32 s75, s75, 1
    s_waitcnt vmcnt(0)
    v_cmp_ne_u32 vcc, s49, v43
    s_cmp_lt_u32 s75, 0x40000
    s_cbranch_scc0 L_B_ok_7
    s_cbranch_vccnz L_B_again_8
    s_branch L_B_ok_7
L_B_again_10:
    s_sleep 2
    buffer_load_dword v39, v31, s[32:35], 0 offen offset:0 sc1
    s_add_u32 s75, s75, 1
    s_waitcnt vmcnt(0)
    v_cmp_ne_u32 vcc, s49, v39
    s_cmp_lt_u32 s75, 0x40000
    s_cbranch_scc0 L_B_ok_9
    s_cbranch_vccnz L_B_again_10
    s_branch L_B_ok_9
L_B_again_12:
    s_sleep 2
    buffer_load_dword v38, v31, s[32:35], 0 offen offset:256 sc1
    s_add_u32 s75, s75, 1
    s_waitcnt vmcnt(0)
    v_cmp_ne_u32 vcc, s49, v38
    s_cmp_lt_u32 s75, 0x40000
    s_cbranch_scc0 L_B_ok_11
    s_cbranch_vccnz L_B_again_12
    s_branch L_B_ok_11
L_B_again_14:
    s_sleep 2
    buffer_load_dword v38, v31, s[32:35], 0 offen offset:128 sc1
    s_add_u32 s75, s75, 1
    s_waitcnt vmcnt(0)
    v_cmp_ne_u32 vcc, s49, v38
    s_cmp_lt_u32 s75, 0x40000
    s_cbranch_scc0 L_B_ok_13
    s_cbranch_vccnz L_B_again_14
    s_branch L_B_ok_13
L_B_again_16:
    s_sleep 2
    buffer_load_dword v38, v31, s[32:35], 0 offen offset:384 sc1
    s_add_u32 s75, s75, 1
    s_waitcnt vmcnt(0)
    v_cmp_ne_u32 vcc, s49, v38
    s_cmp_lt_u32 s75, 0x40000
    s_cbranch_scc0 L_B_ok_15
    s_cbranch_vccnz L_B_again_16
    s_branch L_B_ok_15
L_B_noep_17_go:
    s_mov_b64 exec, 1
    buffer_store_dword v44, off, s[32:35], 0 offset:0 sc1
    s_branch L_B_noep_17
L_endB:
L_end:
    s_endpgm
.section .rodata,"a"
.p2align 6
.amdhsa_kernel gated_mix__linear_attn_block__geglu_ffn__prompt_kernel
  .amdhsa_next_free_vgpr 512
  .amdhsa_next_free_sgpr 102
  .amdhsa_accum_offset 256
  .amdhsa_group_segment_fixed_size 0
  .amdhsa_kernarg_size 88
  .amdhsa_user_sgpr_count 2
  .amdhsa_user_sgpr_kernarg_segment_ptr 1
  .amdhsa_system_sgpr_workgroup_id_x 1
  .amdhsa_float_denorm_mode_32 3
.end_amdhsa_kernel
```
